```python
import torch

def _softmax(x, axis=-1):
    return torch.softmax(x, dim=axis)
def _gelu(x):
    return torch.nn.functional.gelu(x, approximate="tanh")
def _silu(x):
    return torch.nn.functional.silu(x)
def _sigmoid(x):
    return torch.sigmoid(x)
def _layernorm(x, axis=-1, eps=1e-5):
    m = x.mean(dim=axis, keepdim=True)
    v = x.var(dim=axis, keepdim=True, unbiased=False)
    return (x - m) / torch.sqrt(v + eps)
def _scatter_add(tgt, idx, src, axis=0):
    return tgt.clone().index_add_(axis, idx, src)
def _segment_sum(src, seg, n):
    out = torch.zeros((n,) + src.shape[1:], dtype=src.dtype)
    return out.index_add_(0, seg, src)
def _pad(x, pw):
    flat = tuple(v for pair in reversed(pw) for v in pair)
    return torch.nn.functional.pad(x, flat)

kernel_name = 'sequential_preLN__softmax_full_mha__swiglu_ffn__prompt'

def setup_inputs():

    _w = (lambda a: (lambda t: t.to(torch.bfloat16) if t.is_floating_point() else t)(torch.as_tensor(a)))
    def _A_setup():
        B, S, D = 1, 2048, 640
        return {
            "x": _w((lambda *s: torch.randn(*s, dtype=torch.bfloat16) * 0.05)(B, S, D)),
            "wqkv": _w((lambda *s: torch.randn(*s, dtype=torch.bfloat16) * 0.05)(D, 3 * D)),
            "wo": _w((lambda *s: torch.randn(*s, dtype=torch.bfloat16) * 0.05)(D, D)),
        }
    _A_in = _A_setup()

    def _B_setup():
        B, S, D, F = 1, 2048, 640, 1728
        return {
            "x": _w((lambda *s: torch.randn(*s, dtype=torch.bfloat16) * 0.05)(B, S, D)),
            "w_gate": _w((lambda *s: torch.randn(*s, dtype=torch.bfloat16) * 0.05)(D, F)),
            "w_up": _w((lambda *s: torch.randn(*s, dtype=torch.bfloat16) * 0.05)(D, F)),
            "w_down": _w((lambda *s: torch.randn(*s, dtype=torch.bfloat16) * 0.05)(F, D)),
        }
    _B_in = _B_setup()

    return {
        "A_x": _A_in["x"],
        "A_wqkv": _A_in["wqkv"],
        "A_wo": _A_in["wo"],
        "B_x": _B_in["x"],
        "B_w_gate": _B_in["w_gate"],
        "B_w_up": _B_in["w_up"],
        "B_w_down": _B_in["w_down"],
    }

def reference(A_x, A_wqkv, A_wo, B_x, B_w_gate, B_w_up, B_w_down):
    def _A_ref(x, wqkv, wo):
        B, S, D = x.shape
        H = 32; Dh = D // H
        qkv = (lambda x, *d: x.permute(*d))((x @ wqkv).reshape(B, S, 3, H, Dh), 2, 0, 3, 1, 4)
        q, k, v = qkv[0], qkv[1], qkv[2]
        scale = Dh ** -0.5
        scores = torch.einsum("bhqd,bhkd->bhqk", q, k) * scale
        p = _softmax(scores, axis=-1)
        o = torch.einsum("bhqk,bhkd->bhqd", p, v)
        return (lambda x, *d: x.permute(*d))(o, 0, 2, 1, 3).reshape(B, S, D) @ wo

    def _B_ref(x, w_gate, w_up, w_down):
        g = _silu(x @ w_gate)
        u = x @ w_up
        return (g * u) @ w_down

    x = A_x
    h = x + _A_ref(_layernorm(x, axis=-1), A_wqkv, A_wo)
    h2 = h + _B_ref(_layernorm(h, axis=-1), B_w_gate, B_w_up, B_w_down)
    return h2
```

```asm
; @launch grid=(256,1,1) block=(512,1,1) lds=163328
.amdgcn_target "amdgcn-amd-amdhsa--gfx950"
.text
.globl sequential_preLN__softmax_full_mha__swiglu_ffn__prompt_kernel
.p2align 8
.type sequential_preLN__softmax_full_mha__swiglu_ffn__prompt_kernel,@function
sequential_preLN__softmax_full_mha__swiglu_ffn__prompt_kernel:
    s_load_dwordx4 s[40:43], s[0:1], 0
    s_load_dwordx4 s[16:19], s[0:1], 64
    s_cmp_ge_u32 s2, 256
    s_cbranch_scc1 L_sequential_preLN__softmax_full_mha__swiglu_ffn__prompt_kernel_end_1
    v_lshrrev_b32 v5, 6, v0
    v_and_b32 v1, 63, v0
    v_readfirstlane_b32 s12, v5
    s_and_b32 s58, s2, 3
    s_lshl_b32 s58, s58, 2
    s_bfe_u32 s36, s2, 0x20003
    s_add_u32 s56, s58, s36
    s_bfe_u32 s58, s2, 0x10002
    s_lshr_b32 s36, s2, 5
    s_sub_u32 s36, s36, s58
    s_and_b32 s36, s36, 7
    s_lshl_b32 s58, s58, 3
    s_add_u32 s57, s58, s36
    s_and_b32 s13, s12, 3
    s_cmp_eq_u32 s57, 15
    s_cbranch_scc1 L_sequential_preLN__softmax_full_mha__swiglu_ffn__prompt_kernel_spare_2
    s_cmp_ge_u32 s12, 4
    s_cbranch_scc1 L_sequential_preLN__softmax_full_mha__swiglu_ffn__prompt_kernel_comp_5
    v_lshrrev_b32 v5, 3, v1
    v_lshl_add_u32 v5, s12, 5, v5
    v_mul_u32_u24 v5, 1280, v5
    v_lshrrev_b32 v6, 4, v1
    v_and_b32 v7, 7, v1
    v_xor_b32 v7, v7, v6
    v_lshl_add_u32 v17, v7, 4, v5
    v_xor_b32 v18, 64, v17
    v_add_u32 v19, 18432, v17
    v_add_u32 v18, 9216, v18
    v_add_u32 v20, 18432, v18
    v_lshl_add_u32 v5, s12, 4, v6
    v_mul_u32_u24 v5, 3840, v5
    v_and_b32 v7, 15, v1
    v_lshlrev_b32 v8, 2, v6
    v_xor_b32 v7, v7, v8
    v_lshl_add_u32 v21, v7, 4, v5
    v_add_u32 v22, 14336, v21
    v_add_u32 v23, 28672, v21
    v_add_u32 v24, 43008, v21
    s_mul_i32 s58, s56, 163840
    s_lshl_b32 s36, s57, 8
    s_lshl_b32 s33, s12, 12
    s_mov_b32 s26, 163840
    s_mov_b32 s27, 0x20000
    s_sub_u32 s30, 2457600, s36
    s_mov_b32 s31, 0x20000
    s_mov_b32 s60, 0
    s_mov_b32 s32, 0
    s_waitcnt lgkmcnt(0)
    s_add_u32 s24, s40, s58
    s_addc_u32 s25, s41, 0
    s_add_u32 s28, s42, s36
    s_addc_u32 s29, s43, 0
    s_add_u32 m0, s33, 0
    s_add_u32 s58, s60, 128
    buffer_load_dwordx4 v17, s[24:27], s60 offen offset:0 lds
    buffer_load_dwordx4 v18, s[24:27], s60 offen offset:1024 lds
    buffer_load_dwordx4 v19, s[24:27], s60 offen offset:2048 lds
    buffer_load_dwordx4 v20, s[24:27], s60 offen offset:3072 lds
    s_add_u32 m0, m0, 16384
    s_add_u32 s36, s32, 245760
    buffer_load_dwordx4 v21, s[28:31], s32 offen offset:0 lds
    buffer_load_dwordx4 v22, s[28:31], s32 offen offset:1024 lds
    buffer_load_dwordx4 v23, s[28:31], s32 offen offset:2048 lds
    buffer_load_dwordx4 v24, s[28:31], s32 offen offset:3072 lds
    s_and_b32 s59, s2, 7
    s_add_u32 s59, s59, 1
    s_lshl_b32 s60, s59, 7
    s_mul_i32 s32, s59, 245760
    s_add_u32 m0, s33, 32768
    s_add_u32 s58, s60, 128
    buffer_load_dwordx4 v17, s[24:27], s60 offen offset:0 lds
    buffer_load_dwordx4 v18, s[24:27], s60 offen offset:1024 lds
    buffer_load_dwordx4 v19, s[24:27], s60 offen offset:2048 lds
    buffer_load_dwordx4 v20, s[24:27], s60 offen offset:3072 lds
    s_add_u32 m0, m0, 16384
    s_add_u32 s36, s32, 245760
    buffer_load_dwordx4 v21, s[28:31], s32 offen offset:0 lds
    buffer_load_dwordx4 v22, s[28:31], s32 offen offset:1024 lds
    buffer_load_dwordx4 v23, s[28:31], s32 offen offset:2048 lds
    buffer_load_dwordx4 v24, s[28:31], s32 offen offset:3072 lds
    s_cmp_eq_u32 s58, 1280
    s_cselect_b32 s60, 128, s58
    s_cselect_b32 s32, 245760, s36
    s_mov_b64 s[4:5], s[18:19]
    s_movk_i32 s18, 256
    s_mov_b32 s19, 0x20000
    v_lshlrev_b32 v2, 4, v1
    s_mov_b32 s8, s4
    s_mov_b32 s9, s5
    s_mov_b32 s10, 29884416
    s_mov_b32 s11, 0x20000
    s_load_dwordx8 s[44:51], s[0:1], 16
    s_load_dwordx2 s[52:53], s[0:1], 48
    s_mov_b32 s62, 98304
    s_waitcnt vmcnt(8)
    s_barrier
    s_add_u32 m0, s33, 65536
    s_add_u32 s58, s60, 128
    buffer_load_dwordx4 v17, s[24:27], s60 offen offset:0 lds
    buffer_load_dwordx4 v18, s[24:27], s60 offen offset:1024 lds
    buffer_load_dwordx4 v19, s[24:27], s60 offen offset:2048 lds
    buffer_load_dwordx4 v20, s[24:27], s60 offen offset:3072 lds
    s_add_u32 m0, m0, 16384
    s_add_u32 s36, s32, 245760
    buffer_load_dwordx4 v21, s[28:31], s32 offen offset:0 lds
    buffer_load_dwordx4 v22, s[28:31], s32 offen offset:1024 lds
    buffer_load_dwordx4 v23, s[28:31], s32 offen offset:2048 lds
    buffer_load_dwordx4 v24, s[28:31], s32 offen offset:3072 lds
    s_cmp_eq_u32 s58, 1280
    s_cselect_b32 s60, 128, s58
    s_cselect_b32 s32, 245760, s36
    s_mov_b32 s61, 7
L_sequential_preLN__softmax_full_mha__swiglu_ffn__prompt_kernel_hloop_10:
    s_waitcnt vmcnt(8)
    s_barrier
    s_add_u32 m0, s33, s62
    s_add_u32 s58, s60, 128
    buffer_load_dwordx4 v17, s[24:27], s60 offen offset:0 lds
    buffer_load_dwordx4 v18, s[24:27], s60 offen offset:1024 lds
    buffer_load_dwordx4 v19, s[24:27], s60 offen offset:2048 lds
    buffer_load_dwordx4 v20, s[24:27], s60 offen offset:3072 lds
    s_add_u32 m0, m0, 16384
    s_add_u32 s36, s32, 245760
    buffer_load_dwordx4 v21, s[28:31], s32 offen offset:0 lds
    buffer_load_dwordx4 v22, s[28:31], s32 offen offset:1024 lds
    buffer_load_dwordx4 v23, s[28:31], s32 offen offset:2048 lds
    buffer_load_dwordx4 v24, s[28:31], s32 offen offset:3072 lds
    s_cmp_eq_u32 s58, 1280
    s_cselect_b32 s60, 128, s58
    s_cselect_b32 s32, 245760, s36
    s_add_u32 s62, s62, 32768
    s_and_b32 s62, s62, 131071
    s_sub_u32 s61, s61, 1
    s_cmp_lg_u32 s61, 0
    s_cbranch_scc1 L_sequential_preLN__softmax_full_mha__swiglu_ffn__prompt_kernel_hloop_10
    s_cmp_eq_u32 s12, 0
    s_cbranch_scc1 L_sequential_preLN__softmax_full_mha__swiglu_ffn__prompt_kernel_hw0_11
    s_waitcnt vmcnt(8)
    s_barrier
    s_waitcnt vmcnt(0)
    s_barrier
    s_branch L_sequential_preLN__softmax_full_mha__swiglu_ffn__prompt_kernel_hnz_9
L_sequential_preLN__softmax_full_mha__swiglu_ffn__prompt_kernel_hw0_11:
    v_and_b32 v8, 15, v1
    v_lshlrev_b32 v8, 4, v8
    buffer_load_dword v9, v8, s[16:19], 0 offen sc1
    s_waitcnt vmcnt(9)
    s_barrier
    s_waitcnt vmcnt(1)
    s_barrier
    s_mov_b32 s36, 0
L_sequential_preLN__softmax_full_mha__swiglu_ffn__prompt_kernel_hz_7:
    s_waitcnt vmcnt(0)
    v_cmp_ne_u32 vcc, 0, v9
    s_add_u32 s36, s36, 1
    s_cmp_eq_u64 vcc, -1
    s_cbranch_scc1 L_sequential_preLN__softmax_full_mha__swiglu_ffn__prompt_kernel_hzx_8
    s_cmp_gt_u32 s36, 0x40000
    s_cbranch_scc1 L_sequential_preLN__softmax_full_mha__swiglu_ffn__prompt_kernel_hzx_8
    buffer_load_dword v9, v8, s[16:19], 0 offen sc1
    s_branch L_sequential_preLN__softmax_full_mha__swiglu_ffn__prompt_kernel_hz_7
L_sequential_preLN__softmax_full_mha__swiglu_ffn__prompt_kernel_hzx_8:
    s_mov_b32 m0, 131072
    s_lshl_b32 s58, s56, 10
    s_add_u32 s58, s58, 13828096
    buffer_load_dwordx4 v2, s[8:11], s58 offen sc1 lds
L_sequential_preLN__softmax_full_mha__swiglu_ffn__prompt_kernel_hnz_9:
    s_waitcnt vmcnt(0)
    s_barrier
    s_branch L_sequential_preLN__softmax_full_mha__swiglu_ffn__prompt_kernel_J0_4
L_sequential_preLN__softmax_full_mha__swiglu_ffn__prompt_kernel_comp_5:
    s_getpc_b64 s[54:55]
L_pf_here:
    s_lshr_b32 s58, s2, 3
    s_add_u32 s58, s58, 28
    s_and_b32 s58, s58, 31
    s_lshl_b32 s58, s58, 2
    s_add_u32 s58, s58, s13
    s_lshl_b32 s58, s58, 10
    s_sub_u32 s54, s54, L_pf_here - sequential_preLN__softmax_full_mha__swiglu_ffn__prompt_kernel
    s_subb_u32 s55, s55, 0
    s_cmp_gt_u32 s58, L_code_end - sequential_preLN__softmax_full_mha__swiglu_ffn__prompt_kernel - 1024
    s_cbranch_scc1 L_pf_skip
    v_lshl_add_u32 v5, v1, 4, s58
    global_load_dwordx4 v[144:147], v5, s[54:55]
L_pf_skip:
    s_waitcnt lgkmcnt(0)
    s_mov_b64 s[4:5], s[18:19]
    s_movk_i32 s18, 256
    s_mov_b32 s19, 0x20000
    v_lshlrev_b32 v2, 4, v1
    s_mov_b32 s8, s4
    s_mov_b32 s9, s5
    s_mov_b32 s10, 29884416
    s_mov_b32 s11, 0x20000
    s_load_dwordx8 s[44:51], s[0:1], 16
    s_load_dwordx2 s[52:53], s[0:1], 48
    v_and_b32 v5, 31, v1
    v_lshrrev_b32 v6, 5, v1
    v_bfe_u32 v7, v1, 1, 3
    v_xor_b32 v7, v7, v6
    v_lshlrev_b32 v7, 4, v7
    v_lshl_add_u32 v7, v5, 7, v7
    s_lshr_b32 s58, s13, 1
    s_and_b32 s36, s13, 1
    s_lshl_b32 s59, s58, 13
    v_add_u32 v11, s59, v7
    v_xor_b32 v12, 32, v11
    v_xor_b32 v13, 64, v11
    v_xor_b32 v14, 96, v11
    v_bfe_u32 v7, v1, 2, 2
    v_lshl_add_u32 v8, v6, 3, v7
    v_lshlrev_b32 v8, 8, v8
    s_lshl_b32 s59, s36, 1
    s_add_u32 s59, s59, s58
    v_xor_b32 v7, s59, v7
    v_lshl_add_u32 v8, v7, 6, v8
    v_bfe_u32 v7, v1, 4, 1
    v_lshl_add_u32 v8, v7, 5, v8
    v_and_b32 v7, 3, v1
    v_lshl_add_u32 v8, v7, 3, v8
    v_add_u32 v15, 16384, v8
    v_xor_b32 v16, 64, v15
    s_mov_b32 s34, 0
    v_mov_b32 v140, 0x3f803f80
    v_mov_b32 v141, 0x3f803f80
    v_mov_b32 v142, 0x3f803f80
    v_mov_b32 v143, 0x3f803f80
    s_cmp_ge_u32 s57, 10
    s_cbranch_scc1 L_sequential_preLN__softmax_full_mha__swiglu_ffn__prompt_kernel_vpath_3
    s_barrier
    ds_read_b64_tr_b16 v[108:109], v15 offset:0
    ds_read_b64_tr_b16 v[110:111], v15 offset:1024
    ds_read_b128 v[92:95], v11 offset:0
    ds_read_b128 v[96:99], v11 offset:4096
    ds_read_b64_tr_b16 v[112:113], v16 offset:0
    ds_read_b64_tr_b16 v[114:115], v16 offset:1024
    s_waitcnt lgkmcnt(0)
    v_mfma_f32_32x32x16_bf16 v[28:43], v[108:111], v[92:95], 0
    ds_read_b64_tr_b16 v[116:117], v15 offset:4096
    ds_read_b64_tr_b16 v[118:119], v15 offset:5120
    v_mfma_f32_32x32x16_bf16 v[44:59], v[108:111], v[96:99], 0
    ds_read_b128 v[100:103], v12 offset:0
    ds_read_b128 v[104:107], v12 offset:4096
    v_mfma_f32_32x32x16_bf16 v[60:75], v[112:115], v[92:95], 0
    ds_read_b64_tr_b16 v[120:121], v16 offset:4096
    ds_read_b64_tr_b16 v[122:123], v16 offset:5120
    v_mfma_f32_32x32x16_bf16 v[76:91], v[112:115], v[96:99], 0
    s_cmp_eq_u32 s34, 98304
    s_mov_b32 s35, 32768
    s_cselect_b32 s35, 4294868992, s35
    s_add_u32 s34, s34, s35
    v_add_u32 v11, s35, v11
    v_mfma_f32_32x32x16_bf16 v[124:139], v[140:143], v[108:111], 0
    s_waitcnt lgkmcnt(0)
    v_mfma_f32_32x32x16_bf16 v[28:43], v[116:119], v[100:103], v[28:43]
    ds_read_b64_tr_b16 v[108:109], v15 offset:8192
    ds_read_b64_tr_b16 v[110:111], v15 offset:9216
    v_mfma_f32_32x32x16_bf16 v[44:59], v[116:119], v[104:107], v[44:59]
    ds_read_b128 v[92:95], v13 offset:0
    ds_read_b128 v[96:99], v13 offset:4096
    v_mfma_f32_32x32x16_bf16 v[60:75], v[120:123], v[100:103], v[60:75]
    ds_read_b64_tr_b16 v[112:113], v16 offset:8192
    ds_read_b64_tr_b16 v[114:115], v16 offset:9216
    v_mfma_f32_32x32x16_bf16 v[76:91], v[120:123], v[104:107], v[76:91]
    v_add_u32 v12, s35, v12
    v_mfma_f32_32x32x16_bf16 v[124:139], v[140:143], v[116:119], v[124:139]
    s_waitcnt lgkmcnt(0)
    v_mfma_f32_32x32x16_bf16 v[28:43], v[108:111], v[92:95], v[28:43]
    ds_read_b64_tr_b16 v[116:117], v15 offset:12288
    ds_read_b64_tr_b16 v[118:119], v15 offset:13312
    v_mfma_f32_32x32x16_bf16 v[44:59], v[108:111], v[96:99], v[44:59]
    ds_read_b128 v[100:103], v14 offset:0
    ds_read_b128 v[104:107], v14 offset:4096
    v_mfma_f32_32x32x16_bf16 v[60:75], v[112:115], v[92:95], v[60:75]
    ds_read_b64_tr_b16 v[120:121], v16 offset:12288
    ds_read_b64_tr_b16 v[122:123], v16 offset:13312
    v_mfma_f32_32x32x16_bf16 v[76:91], v[112:115], v[96:99], v[76:91]
    v_add_u32 v13, s35, v13
    v_mfma_f32_32x32x16_bf16 v[124:139], v[140:143], v[108:111], v[124:139]
    s_waitcnt lgkmcnt(0)
    v_mfma_f32_32x32x16_bf16 v[28:43], v[116:119], v[100:103], v[28:43]
    v_add_u32 v14, s35, v14
    v_add_u32 v15, s35, v15
    v_add_u32 v16, s35, v16
    v_mfma_f32_32x32x16_bf16 v[44:59], v[116:119], v[104:107], v[44:59]
    s_barrier
    ds_read_b64_tr_b16 v[108:109], v15 offset:0
    ds_read_b64_tr_b16 v[110:111], v15 offset:1024
    ds_read_b128 v[92:95], v11 offset:0
    v_mfma_f32_32x32x16_bf16 v[60:75], v[120:123], v[100:103], v[60:75]
    ds_read_b128 v[96:99], v11 offset:4096
    ds_read_b64_tr_b16 v[112:113], v16 offset:0
    ds_read_b64_tr_b16 v[114:115], v16 offset:1024
    v_mfma_f32_32x32x16_bf16 v[76:91], v[120:123], v[104:107], v[76:91]
    v_mfma_f32_32x32x16_bf16 v[124:139], v[140:143], v[116:119], v[124:139]
    s_mov_b32 s61, 8
L_sequential_preLN__softmax_full_mha__swiglu_ffn__prompt_kernel_loop_12:
    s_waitcnt lgkmcnt(0)
    v_mfma_f32_32x32x16_bf16 v[28:43], v[108:111], v[92:95], v[28:43]
    ds_read_b64_tr_b16 v[116:117], v15 offset:4096
    ds_read_b64_tr_b16 v[118:119], v15 offset:5120
    v_mfma_f32_32x32x16_bf16 v[44:59], v[108:111], v[96:99], v[44:59]
    ds_read_b128 v[100:103], v12 offset:0
    ds_read_b128 v[104:107], v12 offset:4096
    v_mfma_f32_32x32x16_bf16 v[60:75], v[112:115], v[92:95], v[60:75]
    ds_read_b64_tr_b16 v[120:121], v16 offset:4096
    ds_read_b64_tr_b16 v[122:123], v16 offset:5120
    v_mfma_f32_32x32x16_bf16 v[76:91], v[112:115], v[96:99], v[76:91]
    s_cmp_eq_u32 s34, 98304
    s_mov_b32 s35, 32768
    s_cselect_b32 s35, 4294868992, s35
    s_add_u32 s34, s34, s35
    v_add_u32 v11, s35, v11
    v_mfma_f32_32x32x16_bf16 v[124:139], v[140:143], v[108:111], v[124:139]
    s_waitcnt lgkmcnt(0)
    v_mfma_f32_32x32x16_bf16 v[28:43], v[116:119], v[100:103], v[28:43]
    ds_read_b64_tr_b16 v[108:109], v15 offset:8192
    ds_read_b64_tr_b16 v[110:111], v15 offset:9216
    v_mfma_f32_32x32x16_bf16 v[44:59], v[116:119], v[104:107], v[44:59]
    ds_read_b128 v[92:95], v13 offset:0
    ds_read_b128 v[96:99], v13 offset:4096
    v_mfma_f32_32x32x16_bf16 v[60:75], v[120:123], v[100:103], v[60:75]
    ds_read_b64_tr_b16 v[112:113], v16 offset:8192
    ds_read_b64_tr_b16 v[114:115], v16 offset:9216
    v_mfma_f32_32x32x16_bf16 v[76:91], v[120:123], v[104:107], v[76:91]
    v_add_u32 v12, s35, v12
    v_mfma_f32_32x32x16_bf16 v[124:139], v[140:143], v[116:119], v[124:139]
    s_waitcnt lgkmcnt(0)
    v_mfma_f32_32x32x16_bf16 v[28:43], v[108:111], v[92:95], v[28:43]
    ds_read_b64_tr_b16 v[116:117], v15 offset:12288
    ds_read_b64_tr_b16 v[118:119], v15 offset:13312
    v_mfma_f32_32x32x16_bf16 v[44:59], v[108:111], v[96:99], v[44:59]
    ds_read_b128 v[100:103], v14 offset:0
    ds_read_b128 v[104:107], v14 offset:4096
    v_mfma_f32_32x32x16_bf16 v[60:75], v[112:115], v[92:95], v[60:75]
    ds_read_b64_tr_b16 v[120:121], v16 offset:12288
    ds_read_b64_tr_b16 v[122:123], v16 offset:13312
    v_mfma_f32_32x32x16_bf16 v[76:91], v[112:115], v[96:99], v[76:91]
    v_add_u32 v13, s35, v13
    v_mfma_f32_32x32x16_bf16 v[124:139], v[140:143], v[108:111], v[124:139]
    s_waitcnt lgkmcnt(0)
    v_mfma_f32_32x32x16_bf16 v[28:43], v[116:119], v[100:103], v[28:43]
    v_add_u32 v14, s35, v14
    v_add_u32 v15, s35, v15
    v_add_u32 v16, s35, v16
    v_mfma_f32_32x32x16_bf16 v[44:59], v[116:119], v[104:107], v[44:59]
    s_barrier
    ds_read_b64_tr_b16 v[108:109], v15 offset:0
    ds_read_b64_tr_b16 v[110:111], v15 offset:1024
    ds_read_b128 v[92:95], v11 offset:0
    v_mfma_f32_32x32x16_bf16 v[60:75], v[120:123], v[100:103], v[60:75]
    ds_read_b128 v[96:99], v11 offset:4096
    ds_read_b64_tr_b16 v[112:113], v16 offset:0
    ds_read_b64_tr_b16 v[114:115], v16 offset:1024
    v_mfma_f32_32x32x16_bf16 v[76:91], v[120:123], v[104:107], v[76:91]
    v_mfma_f32_32x32x16_bf16 v[124:139], v[140:143], v[116:119], v[124:139]
    s_sub_u32 s61, s61, 1
    s_cmp_lg_u32 s61, 0
    s_cbranch_scc1 L_sequential_preLN__softmax_full_mha__swiglu_ffn__prompt_kernel_loop_12
    s_waitcnt lgkmcnt(0)
    v_mfma_f32_32x32x16_bf16 v[28:43], v[108:111], v[92:95], v[28:43]
    ds_read_b64_tr_b16 v[116:117], v15 offset:4096
    ds_read_b64_tr_b16 v[118:119], v15 offset:5120
    v_mfma_f32_32x32x16_bf16 v[44:59], v[108:111], v[96:99], v[44:59]
    ds_read_b128 v[100:103], v12 offset:0
    ds_read_b128 v[104:107], v12 offset:4096
    v_mfma_f32_32x32x16_bf16 v[60:75], v[112:115], v[92:95], v[60:75]
    ds_read_b64_tr_b16 v[120:121], v16 offset:4096
    ds_read_b64_tr_b16 v[122:123], v16 offset:5120
    v_mfma_f32_32x32x16_bf16 v[76:91], v[112:115], v[96:99], v[76:91]
    v_mfma_f32_32x32x16_bf16 v[124:139], v[140:143], v[108:111], v[124:139]
    s_waitcnt lgkmcnt(0)
    v_mfma_f32_32x32x16_bf16 v[28:43], v[116:119], v[100:103], v[28:43]
    ds_read_b64_tr_b16 v[108:109], v15 offset:8192
    ds_read_b64_tr_b16 v[110:111], v15 offset:9216
    v_mfma_f32_32x32x16_bf16 v[44:59], v[116:119], v[104:107], v[44:59]
    ds_read_b128 v[92:95], v13 offset:0
    ds_read_b128 v[96:99], v13 offset:4096
    v_mfma_f32_32x32x16_bf16 v[60:75], v[120:123], v[100:103], v[60:75]
    ds_read_b64_tr_b16 v[112:113], v16 offset:8192
    ds_read_b64_tr_b16 v[114:115], v16 offset:9216
    v_mfma_f32_32x32x16_bf16 v[76:91], v[120:123], v[104:107], v[76:91]
    v_mfma_f32_32x32x16_bf16 v[124:139], v[140:143], v[116:119], v[124:139]
    s_waitcnt lgkmcnt(0)
    v_mfma_f32_32x32x16_bf16 v[28:43], v[108:111], v[92:95], v[28:43]
    ds_read_b64_tr_b16 v[116:117], v15 offset:12288
    ds_read_b64_tr_b16 v[118:119], v15 offset:13312
    v_mfma_f32_32x32x16_bf16 v[44:59], v[108:111], v[96:99], v[44:59]
    ds_read_b128 v[100:103], v14 offset:0
    ds_read_b128 v[104:107], v14 offset:4096
    v_mfma_f32_32x32x16_bf16 v[60:75], v[112:115], v[92:95], v[60:75]
    ds_read_b64_tr_b16 v[120:121], v16 offset:12288
    ds_read_b64_tr_b16 v[122:123], v16 offset:13312
    v_mfma_f32_32x32x16_bf16 v[76:91], v[112:115], v[96:99], v[76:91]
    v_mfma_f32_32x32x16_bf16 v[124:139], v[140:143], v[108:111], v[124:139]
    s_waitcnt lgkmcnt(0)
    v_mfma_f32_32x32x16_bf16 v[28:43], v[116:119], v[100:103], v[28:43]
    v_mfma_f32_32x32x16_bf16 v[44:59], v[116:119], v[104:107], v[44:59]
    v_mfma_f32_32x32x16_bf16 v[60:75], v[120:123], v[100:103], v[60:75]
    v_mfma_f32_32x32x16_bf16 v[76:91], v[120:123], v[104:107], v[76:91]
    v_mfma_f32_32x32x16_bf16 v[124:139], v[140:143], v[116:119], v[124:139]
    v_and_b32 v5, 31, v1
    s_lshl_b32 s59, s59, 7
    s_add_u32 s60, s59, 131072
    v_lshl_add_u32 v7, v5, 2, s60
    s_lshl_b32 s32, s58, 8
    s_add_u32 s32, s32, 131072
    v_lshl_add_u32 v6, v5, 2, s32
    v_lshrrev_b32 v8, 5, v1
    v_lshlrev_b32 v8, 4, v8
    s_cmp_lt_u32 s57, 5
    s_cselect_b32 s61, 0x3ea52b5c, 1.0
    s_nop 0
    ds_write_b32 v7, v124 offset:1024
    s_waitcnt lgkmcnt(0)
    s_barrier
    ds_read_b32 v92, v6 offset:0
    ds_read_b32 v94, v6 offset:512
    ds_read_b32 v96, v6 offset:128
    ds_read_b32 v98, v6 offset:640
    v_add_u32 v10, s60, v8
    v_xor_b32 v9, 128, v10
    ds_read_b128 v[160:163], v10 offset:1024
    ds_read_b128 v[164:167], v10 offset:1056
    ds_read_b128 v[168:171], v10 offset:1088
    ds_read_b128 v[172:175], v10 offset:1120
    ds_read_b128 v[176:179], v9 offset:1024
    ds_read_b128 v[180:183], v9 offset:1056
    ds_read_b128 v[184:187], v9 offset:1088
    ds_read_b128 v[188:191], v9 offset:1120
    v_lshlrev_b32 v5, 4, v5
    v_lshl_add_u32 v5, v8, 11, v5
    s_lshl_b32 s60, s57, 19
    s_lshl_b32 s32, s59, 10
    s_add_u32 s60, s60, s32
    s_lshl_b32 s32, s56, 11
    s_add_u32 s60, s60, s32
    s_lshl_b32 s32, s58, 10
    s_add_u32 s60, s60, s32
    s_waitcnt lgkmcnt(4)
    v_mov_b32 v93, v92
    v_mul_f32 v95, s61, v94
    v_mul_f32 v94, s61, v94
    v_mov_b32 v97, v96
    v_mul_f32 v99, s61, v98
    v_mul_f32 v98, s61, v98
    v_pk_fma_f32 v[28:29], v[160:161], v[92:93], v[28:29]
    v_pk_fma_f32 v[30:31], v[162:163], v[92:93], v[30:31]
    v_pk_fma_f32 v[32:33], v[164:165], v[92:93], v[32:33]
    v_pk_fma_f32 v[34:35], v[166:167], v[92:93], v[34:35]
    v_pk_fma_f32 v[36:37], v[168:169], v[92:93], v[36:37]
    v_pk_fma_f32 v[38:39], v[170:171], v[92:93], v[38:39]
    v_pk_fma_f32 v[40:41], v[172:173], v[92:93], v[40:41]
    v_pk_fma_f32 v[42:43], v[174:175], v[92:93], v[42:43]
    v_pk_mul_f32 v[28:29], v[28:29], v[94:95]
    v_pk_mul_f32 v[30:31], v[30:31], v[94:95]
    v_pk_mul_f32 v[32:33], v[32:33], v[94:95]
    v_pk_mul_f32 v[34:35], v[34:35], v[94:95]
    v_pk_mul_f32 v[36:37], v[36:37], v[94:95]
    v_pk_mul_f32 v[38:39], v[38:39], v[94:95]
    v_pk_mul_f32 v[40:41], v[40:41], v[94:95]
    v_pk_mul_f32 v[42:43], v[42:43], v[94:95]
    v_cvt_pk_bf16_f32 v28, v28, v29
    v_cvt_pk_bf16_f32 v29, v30, v31
    v_cvt_pk_bf16_f32 v30, v32, v33
    v_cvt_pk_bf16_f32 v31, v34, v35
    v_cvt_pk_bf16_f32 v32, v36, v37
    v_cvt_pk_bf16_f32 v33, v38, v39
    v_cvt_pk_bf16_f32 v34, v40, v41
    v_cvt_pk_bf16_f32 v35, v42, v43
    s_xor_b32 s32, s60, 0
    s_add_u32 s62, s32, 65536
    v_permlane32_swap_b32 v28, v30
    v_permlane32_swap_b32 v29, v31
    v_permlane32_swap_b32 v32, v34
    v_permlane32_swap_b32 v33, v35
    buffer_store_dwordx4 v[28:31], v5, s[8:11], s32 offen sc1
    buffer_store_dwordx4 v[32:35], v5, s[8:11], s62 offen sc1
    v_pk_fma_f32 v[44:45], v[160:161], v[96:97], v[44:45]
    v_pk_fma_f32 v[46:47], v[162:163], v[96:97], v[46:47]
    v_pk_fma_f32 v[48:49], v[164:165], v[96:97], v[48:49]
    v_pk_fma_f32 v[50:51], v[166:167], v[96:97], v[50:51]
    v_pk_fma_f32 v[52:53], v[168:169], v[96:97], v[52:53]
    v_pk_fma_f32 v[54:55], v[170:171], v[96:97], v[54:55]
    v_pk_fma_f32 v[56:57], v[172:173], v[96:97], v[56:57]
    v_pk_fma_f32 v[58:59], v[174:175], v[96:97], v[58:59]
    v_pk_mul_f32 v[44:45], v[44:45], v[98:99]
    v_pk_mul_f32 v[46:47], v[46:47], v[98:99]
    v_pk_mul_f32 v[48:49], v[48:49], v[98:99]
    v_pk_mul_f32 v[50:51], v[50:51], v[98:99]
    v_pk_mul_f32 v[52:53], v[52:53], v[98:99]
    v_pk_mul_f32 v[54:55], v[54:55], v[98:99]
    v_pk_mul_f32 v[56:57], v[56:57], v[98:99]
    v_pk_mul_f32 v[58:59], v[58:59], v[98:99]
    v_cvt_pk_bf16_f32 v44, v44, v45
    v_cvt_pk_bf16_f32 v45, v46, v47
    v_cvt_pk_bf16_f32 v46, v48, v49
    v_cvt_pk_bf16_f32 v47, v50, v51
    v_cvt_pk_bf16_f32 v48, v52, v53
    v_cvt_pk_bf16_f32 v49, v54, v55
    v_cvt_pk_bf16_f32 v50, v56, v57
    v_cvt_pk_bf16_f32 v51, v58, v59
    s_xor_b32 s32, s60, 512
    s_add_u32 s62, s32, 65536
    v_permlane32_swap_b32 v44, v46
    v_permlane32_swap_b32 v45, v47
    v_permlane32_swap_b32 v48, v50
    v_permlane32_swap_b32 v49, v51
    buffer_store_dwordx4 v[44:47], v5, s[8:11], s32 offen sc1
    buffer_store_dwordx4 v[48:51], v5, s[8:11], s62 offen sc1
    s_waitcnt lgkmcnt(0)
    v_pk_fma_f32 v[60:61], v[176:177], v[92:93], v[60:61]
    v_pk_fma_f32 v[62:63], v[178:179], v[92:93], v[62:63]
    v_pk_fma_f32 v[64:65], v[180:181], v[92:93], v[64:65]
    v_pk_fma_f32 v[66:67], v[182:183], v[92:93], v[66:67]
    v_pk_fma_f32 v[68:69], v[184:185], v[92:93], v[68:69]
    v_pk_fma_f32 v[70:71], v[186:187], v[92:93], v[70:71]
    v_pk_fma_f32 v[72:73], v[188:189], v[92:93], v[72:73]
    v_pk_fma_f32 v[74:75], v[190:191], v[92:93], v[74:75]
    v_pk_mul_f32 v[60:61], v[60:61], v[94:95]
    v_pk_mul_f32 v[62:63], v[62:63], v[94:95]
    v_pk_mul_f32 v[64:65], v[64:65], v[94:95]
    v_pk_mul_f32 v[66:67], v[66:67], v[94:95]
    v_pk_mul_f32 v[68:69], v[68:69], v[94:95]
    v_pk_mul_f32 v[70:71], v[70:71], v[94:95]
    v_pk_mul_f32 v[72:73], v[72:73], v[94:95]
    v_pk_mul_f32 v[74:75], v[74:75], v[94:95]
    v_cvt_pk_bf16_f32 v60, v60, v61
    v_cvt_pk_bf16_f32 v61, v62, v63
    v_cvt_pk_bf16_f32 v62, v64, v65
    v_cvt_pk_bf16_f32 v63, v66, v67
    v_cvt_pk_bf16_f32 v64, v68, v69
    v_cvt_pk_bf16_f32 v65, v70, v71
    v_cvt_pk_bf16_f32 v66, v72, v73
    v_cvt_pk_bf16_f32 v67, v74, v75
    s_xor_b32 s32, s60, 131072
    s_add_u32 s62, s32, 65536
    v_permlane32_swap_b32 v60, v62
    v_permlane32_swap_b32 v61, v63
    v_permlane32_swap_b32 v64, v66
    v_permlane32_swap_b32 v65, v67
    buffer_store_dwordx4 v[60:63], v5, s[8:11], s32 offen sc1
    buffer_store_dwordx4 v[64:67], v5, s[8:11], s62 offen sc1
    v_pk_fma_f32 v[76:77], v[176:177], v[96:97], v[76:77]
    v_pk_fma_f32 v[78:79], v[178:179], v[96:97], v[78:79]
    v_pk_fma_f32 v[80:81], v[180:181], v[96:97], v[80:81]
    v_pk_fma_f32 v[82:83], v[182:183], v[96:97], v[82:83]
    v_pk_fma_f32 v[84:85], v[184:185], v[96:97], v[84:85]
    v_pk_fma_f32 v[86:87], v[186:187], v[96:97], v[86:87]
    v_pk_fma_f32 v[88:89], v[188:189], v[96:97], v[88:89]
    v_pk_fma_f32 v[90:91], v[190:191], v[96:97], v[90:91]
    v_pk_mul_f32 v[76:77], v[76:77], v[98:99]
    v_pk_mul_f32 v[78:79], v[78:79], v[98:99]
    v_pk_mul_f32 v[80:81], v[80:81], v[98:99]
    v_pk_mul_f32 v[82:83], v[82:83], v[98:99]
    v_pk_mul_f32 v[84:85], v[84:85], v[98:99]
    v_pk_mul_f32 v[86:87], v[86:87], v[98:99]
    v_pk_mul_f32 v[88:89], v[88:89], v[98:99]
    v_pk_mul_f32 v[90:91], v[90:91], v[98:99]
    v_cvt_pk_bf16_f32 v76, v76, v77
    v_cvt_pk_bf16_f32 v77, v78, v79
    v_cvt_pk_bf16_f32 v78, v80, v81
    v_cvt_pk_bf16_f32 v79, v82, v83
    v_cvt_pk_bf16_f32 v80, v84, v85
    v_cvt_pk_bf16_f32 v81, v86, v87
    v_cvt_pk_bf16_f32 v82, v88, v89
    v_cvt_pk_bf16_f32 v83, v90, v91
    s_xor_b32 s32, s60, 131584
    s_add_u32 s62, s32, 65536
    v_permlane32_swap_b32 v76, v78
    v_permlane32_swap_b32 v77, v79
    v_permlane32_swap_b32 v80, v82
    v_permlane32_swap_b32 v81, v83
    buffer_store_dwordx4 v[76:79], v5, s[8:11], s32 offen sc1
    buffer_store_dwordx4 v[80:83], v5, s[8:11], s62 offen sc1
    s_branch L_sequential_preLN__softmax_full_mha__swiglu_ffn__prompt_kernel_J0_4
L_sequential_preLN__softmax_full_mha__swiglu_ffn__prompt_kernel_vpath_3:
    s_barrier
    ds_read_b64_tr_b16 v[108:109], v15 offset:0
    ds_read_b64_tr_b16 v[110:111], v15 offset:1024
    ds_read_b128 v[92:95], v11 offset:0
    ds_read_b128 v[96:99], v11 offset:4096
    ds_read_b64_tr_b16 v[112:113], v16 offset:0
    ds_read_b64_tr_b16 v[114:115], v16 offset:1024
    s_waitcnt lgkmcnt(0)
    v_mfma_f32_32x32x16_bf16 v[28:43], v[92:95], v[108:111], 0
    ds_read_b64_tr_b16 v[116:117], v15 offset:4096
    ds_read_b64_tr_b16 v[118:119], v15 offset:5120
    v_mfma_f32_32x32x16_bf16 v[44:59], v[96:99], v[108:111], 0
    ds_read_b128 v[100:103], v12 offset:0
    ds_read_b128 v[104:107], v12 offset:4096
    v_mfma_f32_32x32x16_bf16 v[60:75], v[92:95], v[112:115], 0
    ds_read_b64_tr_b16 v[120:121], v16 offset:4096
    ds_read_b64_tr_b16 v[122:123], v16 offset:5120
    v_mfma_f32_32x32x16_bf16 v[76:91], v[96:99], v[112:115], 0
    s_cmp_eq_u32 s34, 98304
    s_mov_b32 s35, 32768
    s_cselect_b32 s35, 4294868992, s35
    s_add_u32 s34, s34, s35
    v_add_u32 v11, s35, v11
    v_mfma_f32_32x32x16_bf16 v[124:139], v[140:143], v[108:111], 0
    s_waitcnt lgkmcnt(0)
    v_mfma_f32_32x32x16_bf16 v[28:43], v[100:103], v[116:119], v[28:43]
    ds_read_b64_tr_b16 v[108:109], v15 offset:8192
    ds_read_b64_tr_b16 v[110:111], v15 offset:9216
    v_mfma_f32_32x32x16_bf16 v[44:59], v[104:107], v[116:119], v[44:59]
    ds_read_b128 v[92:95], v13 offset:0
    ds_read_b128 v[96:99], v13 offset:4096
    v_mfma_f32_32x32x16_bf16 v[60:75], v[100:103], v[120:123], v[60:75]
    ds_read_b64_tr_b16 v[112:113], v16 offset:8192
    ds_read_b64_tr_b16 v[114:115], v16 offset:9216
    v_mfma_f32_32x32x16_bf16 v[76:91], v[104:107], v[120:123], v[76:91]
    v_add_u32 v12, s35, v12
    v_mfma_f32_32x32x16_bf16 v[124:139], v[140:143], v[116:119], v[124:139]
    s_waitcnt lgkmcnt(0)
    v_mfma_f32_32x32x16_bf16 v[28:43], v[92:95], v[108:111], v[28:43]
    ds_read_b64_tr_b16 v[116:117], v15 offset:12288
    ds_read_b64_tr_b16 v[118:119], v15 offset:13312
    v_mfma_f32_32x32x16_bf16 v[44:59], v[96:99], v[108:111], v[44:59]
    ds_read_b128 v[100:103], v14 offset:0
    ds_read_b128 v[104:107], v14 offset:4096
    v_mfma_f32_32x32x16_bf16 v[60:75], v[92:95], v[112:115], v[60:75]
    ds_read_b64_tr_b16 v[120:121], v16 offset:12288
    ds_read_b64_tr_b16 v[122:123], v16 offset:13312
    v_mfma_f32_32x32x16_bf16 v[76:91], v[96:99], v[112:115], v[76:91]
    v_add_u32 v13, s35, v13
    v_mfma_f32_32x32x16_bf16 v[124:139], v[140:143], v[108:111], v[124:139]
    s_waitcnt lgkmcnt(0)
    v_mfma_f32_32x32x16_bf16 v[28:43], v[100:103], v[116:119], v[28:43]
    v_add_u32 v14, s35, v14
    v_add_u32 v15, s35, v15
    v_add_u32 v16, s35, v16
    v_mfma_f32_32x32x16_bf16 v[44:59], v[104:107], v[116:119], v[44:59]
    s_barrier
    ds_read_b64_tr_b16 v[108:109], v15 offset:0
    ds_read_b64_tr_b16 v[110:111], v15 offset:1024
    ds_read_b128 v[92:95], v11 offset:0
    v_mfma_f32_32x32x16_bf16 v[60:75], v[100:103], v[120:123], v[60:75]
    ds_read_b128 v[96:99], v11 offset:4096
    ds_read_b64_tr_b16 v[112:113], v16 offset:0
    ds_read_b64_tr_b16 v[114:115], v16 offset:1024
    v_mfma_f32_32x32x16_bf16 v[76:91], v[104:107], v[120:123], v[76:91]
    v_mfma_f32_32x32x16_bf16 v[124:139], v[140:143], v[116:119], v[124:139]
    s_mov_b32 s61, 8
L_sequential_preLN__softmax_full_mha__swiglu_ffn__prompt_kernel_loop_13:
    s_waitcnt lgkmcnt(0)
    v_mfma_f32_32x32x16_bf16 v[28:43], v[92:95], v[108:111], v[28:43]
    ds_read_b64_tr_b16 v[116:117], v15 offset:4096
    ds_read_b64_tr_b16 v[118:119], v15 offset:5120
    v_mfma_f32_32x32x16_bf16 v[44:59], v[96:99], v[108:111], v[44:59]
    ds_read_b128 v[100:103], v12 offset:0
    ds_read_b128 v[104:107], v12 offset:4096
    v_mfma_f32_32x32x16_bf16 v[60:75], v[92:95], v[112:115], v[60:75]
    ds_read_b64_tr_b16 v[120:121], v16 offset:4096
    ds_read_b64_tr_b16 v[122:123], v16 offset:5120
    v_mfma_f32_32x32x16_bf16 v[76:91], v[96:99], v[112:115], v[76:91]
    s_cmp_eq_u32 s34, 98304
    s_mov_b32 s35, 32768
    s_cselect_b32 s35, 4294868992, s35
    s_add_u32 s34, s34, s35
    v_add_u32 v11, s35, v11
    v_mfma_f32_32x32x16_bf16 v[124:139], v[140:143], v[108:111], v[124:139]
    s_waitcnt lgkmcnt(0)
    v_mfma_f32_32x32x16_bf16 v[28:43], v[100:103], v[116:119], v[28:43]
    ds_read_b64_tr_b16 v[108:109], v15 offset:8192
    ds_read_b64_tr_b16 v[110:111], v15 offset:9216
    v_mfma_f32_32x32x16_bf16 v[44:59], v[104:107], v[116:119], v[44:59]
    ds_read_b128 v[92:95], v13 offset:0
    ds_read_b128 v[96:99], v13 offset:4096
    v_mfma_f32_32x32x16_bf16 v[60:75], v[100:103], v[120:123], v[60:75]
    ds_read_b64_tr_b16 v[112:113], v16 offset:8192
    ds_read_b64_tr_b16 v[114:115], v16 offset:9216
    v_mfma_f32_32x32x16_bf16 v[76:91], v[104:107], v[120:123], v[76:91]
    v_add_u32 v12, s35, v12
    v_mfma_f32_32x32x16_bf16 v[124:139], v[140:143], v[116:119], v[124:139]
    s_waitcnt lgkmcnt(0)
    v_mfma_f32_32x32x16_bf16 v[28:43], v[92:95], v[108:111], v[28:43]
    ds_read_b64_tr_b16 v[116:117], v15 offset:12288
    ds_read_b64_tr_b16 v[118:119], v15 offset:13312
    v_mfma_f32_32x32x16_bf16 v[44:59], v[96:99], v[108:111], v[44:59]
    ds_read_b128 v[100:103], v14 offset:0
    ds_read_b128 v[104:107], v14 offset:4096
    v_mfma_f32_32x32x16_bf16 v[60:75], v[92:95], v[112:115], v[60:75]
    ds_read_b64_tr_b16 v[120:121], v16 offset:12288
    ds_read_b64_tr_b16 v[122:123], v16 offset:13312
    v_mfma_f32_32x32x16_bf16 v[76:91], v[96:99], v[112:115], v[76:91]
    v_add_u32 v13, s35, v13
    v_mfma_f32_32x32x16_bf16 v[124:139], v[140:143], v[108:111], v[124:139]
    s_waitcnt lgkmcnt(0)
    v_mfma_f32_32x32x16_bf16 v[28:43], v[100:103], v[116:119], v[28:43]
    v_add_u32 v14, s35, v14
    v_add_u32 v15, s35, v15
    v_add_u32 v16, s35, v16
    v_mfma_f32_32x32x16_bf16 v[44:59], v[104:107], v[116:119], v[44:59]
    s_barrier
    ds_read_b64_tr_b16 v[108:109], v15 offset:0
    ds_read_b64_tr_b16 v[110:111], v15 offset:1024
    ds_read_b128 v[92:95], v11 offset:0
    v_mfma_f32_32x32x16_bf16 v[60:75], v[100:103], v[120:123], v[60:75]
    ds_read_b128 v[96:99], v11 offset:4096
    ds_read_b64_tr_b16 v[112:113], v16 offset:0
    ds_read_b64_tr_b16 v[114:115], v16 offset:1024
    v_mfma_f32_32x32x16_bf16 v[76:91], v[104:107], v[120:123], v[76:91]
    v_mfma_f32_32x32x16_bf16 v[124:139], v[140:143], v[116:119], v[124:139]
    s_sub_u32 s61, s61, 1
    s_cmp_lg_u32 s61, 0
    s_cbranch_scc1 L_sequential_preLN__softmax_full_mha__swiglu_ffn__prompt_kernel_loop_13
    s_waitcnt lgkmcnt(0)
    v_mfma_f32_32x32x16_bf16 v[28:43], v[92:95], v[108:111], v[28:43]
    ds_read_b64_tr_b16 v[116:117], v15 offset:4096
    ds_read_b64_tr_b16 v[118:119], v15 offset:5120
    v_mfma_f32_32x32x16_bf16 v[44:59], v[96:99], v[108:111], v[44:59]
    ds_read_b128 v[100:103], v12 offset:0
    ds_read_b128 v[104:107], v12 offset:4096
    v_mfma_f32_32x32x16_bf16 v[60:75], v[92:95], v[112:115], v[60:75]
    ds_read_b64_tr_b16 v[120:121], v16 offset:4096
    ds_read_b64_tr_b16 v[122:123], v16 offset:5120
    v_mfma_f32_32x32x16_bf16 v[76:91], v[96:99], v[112:115], v[76:91]
    v_mfma_f32_32x32x16_bf16 v[124:139], v[140:143], v[108:111], v[124:139]
    s_waitcnt lgkmcnt(0)
    v_mfma_f32_32x32x16_bf16 v[28:43], v[100:103], v[116:119], v[28:43]
    ds_read_b64_tr_b16 v[108:109], v15 offset:8192
    ds_read_b64_tr_b16 v[110:111], v15 offset:9216
    v_mfma_f32_32x32x16_bf16 v[44:59], v[104:107], v[116:119], v[44:59]
    ds_read_b128 v[92:95], v13 offset:0
    ds_read_b128 v[96:99], v13 offset:4096
    v_mfma_f32_32x32x16_bf16 v[60:75], v[100:103], v[120:123], v[60:75]
    ds_read_b64_tr_b16 v[112:113], v16 offset:8192
    ds_read_b64_tr_b16 v[114:115], v16 offset:9216
    v_mfma_f32_32x32x16_bf16 v[76:91], v[104:107], v[120:123], v[76:91]
    v_mfma_f32_32x32x16_bf16 v[124:139], v[140:143], v[116:119], v[124:139]
    s_waitcnt lgkmcnt(0)
    v_mfma_f32_32x32x16_bf16 v[28:43], v[92:95], v[108:111], v[28:43]
    ds_read_b64_tr_b16 v[116:117], v15 offset:12288
    ds_read_b64_tr_b16 v[118:119], v15 offset:13312
    v_mfma_f32_32x32x16_bf16 v[44:59], v[96:99], v[108:111], v[44:59]
    ds_read_b128 v[100:103], v14 offset:0
    ds_read_b128 v[104:107], v14 offset:4096
    v_mfma_f32_32x32x16_bf16 v[60:75], v[92:95], v[112:115], v[60:75]
    ds_read_b64_tr_b16 v[120:121], v16 offset:12288
    ds_read_b64_tr_b16 v[122:123], v16 offset:13312
    v_mfma_f32_32x32x16_bf16 v[76:91], v[96:99], v[112:115], v[76:91]
    v_mfma_f32_32x32x16_bf16 v[124:139], v[140:143], v[108:111], v[124:139]
    s_waitcnt lgkmcnt(0)
    v_mfma_f32_32x32x16_bf16 v[28:43], v[100:103], v[116:119], v[28:43]
    v_mfma_f32_32x32x16_bf16 v[44:59], v[104:107], v[116:119], v[44:59]
    v_mfma_f32_32x32x16_bf16 v[60:75], v[100:103], v[120:123], v[60:75]
    v_mfma_f32_32x32x16_bf16 v[76:91], v[104:107], v[120:123], v[76:91]
    v_mfma_f32_32x32x16_bf16 v[124:139], v[140:143], v[116:119], v[124:139]
    v_and_b32 v5, 31, v1
    s_lshl_b32 s59, s59, 7
    s_add_u32 s60, s59, 131072
    v_lshl_add_u32 v7, v5, 2, s60
    s_lshl_b32 s32, s58, 8
    s_add_u32 s32, s32, 131072
    v_lshl_add_u32 v6, v5, 2, s32
    v_lshrrev_b32 v8, 5, v1
    v_lshlrev_b32 v8, 4, v8
    s_cmp_lt_u32 s57, 5
    s_cselect_b32 s61, 0x3ea52b5c, 1.0
    s_nop 0
    ds_write_b32 v7, v124 offset:1024
    s_waitcnt lgkmcnt(0)
    s_barrier
    v_xor_b32 v9, 128, v7
    ds_read_b32 v94, v9 offset:1024
    v_add_u32 v10, s32, v8
    ds_read_b128 v[160:163], v10 offset:0
    ds_read_b128 v[192:195], v10 offset:512
    ds_read_b128 v[164:167], v10 offset:32
    ds_read_b128 v[196:199], v10 offset:544
    ds_read_b128 v[168:171], v10 offset:64
    ds_read_b128 v[200:203], v10 offset:576
    ds_read_b128 v[172:175], v10 offset:96
    ds_read_b128 v[204:207], v10 offset:608
    ds_read_b128 v[176:179], v10 offset:128
    ds_read_b128 v[208:211], v10 offset:640
    ds_read_b128 v[180:183], v10 offset:160
    ds_read_b128 v[212:215], v10 offset:672
    ds_read_b128 v[184:187], v10 offset:192
    ds_read_b128 v[216:219], v10 offset:704
    ds_read_b128 v[188:191], v10 offset:224
    ds_read_b128 v[220:223], v10 offset:736
    s_sub_u32 s60, s57, 10
    s_lshl_b32 s60, s60, 7
    s_lshr_b32 s32, s59, 2
    s_add_u32 s60, s60, s32
    v_add_u32 v5, s60, v5
    v_mul_u32_u24 v8, 640, v8
    v_lshl_add_u32 v96, v5, 4, v8
    v_xor_b32 v5, 32, v5
    v_lshl_add_u32 v97, v5, 4, v8
    s_lshl_b32 s60, s56, 1
    s_add_u32 s60, s60, s58
    s_mul_i32 s60, s60, 81920
    s_add_u32 s60, s60, 5242880
    v_mov_b32 v92, v124
    v_mov_b32 v93, v124
    s_waitcnt lgkmcnt(8)
    v_mov_b32 v95, v94
    v_pk_fma_f32 v[28:29], v[160:161], v[92:93], v[28:29]
    v_pk_fma_f32 v[30:31], v[162:163], v[92:93], v[30:31]
    v_pk_fma_f32 v[32:33], v[164:165], v[92:93], v[32:33]
    v_pk_fma_f32 v[34:35], v[166:167], v[92:93], v[34:35]
    v_pk_fma_f32 v[36:37], v[168:169], v[92:93], v[36:37]
    v_pk_fma_f32 v[38:39], v[170:171], v[92:93], v[38:39]
    v_pk_fma_f32 v[40:41], v[172:173], v[92:93], v[40:41]
    v_pk_fma_f32 v[42:43], v[174:175], v[92:93], v[42:43]
    v_pk_mul_f32 v[28:29], v[28:29], v[192:193]
    v_pk_mul_f32 v[30:31], v[30:31], v[194:195]
    v_pk_mul_f32 v[32:33], v[32:33], v[196:197]
    v_pk_mul_f32 v[34:35], v[34:35], v[198:199]
    v_pk_mul_f32 v[36:37], v[36:37], v[200:201]
    v_pk_mul_f32 v[38:39], v[38:39], v[202:203]
    v_pk_mul_f32 v[40:41], v[40:41], v[204:205]
    v_pk_mul_f32 v[42:43], v[42:43], v[206:207]
    v_cvt_pk_bf16_f32 v28, v28, v29
    v_cvt_pk_bf16_f32 v29, v30, v31
    v_cvt_pk_bf16_f32 v30, v32, v33
    v_cvt_pk_bf16_f32 v31, v34, v35
    v_cvt_pk_bf16_f32 v32, v36, v37
    v_cvt_pk_bf16_f32 v33, v38, v39
    v_cvt_pk_bf16_f32 v34, v40, v41
    v_cvt_pk_bf16_f32 v35, v42, v43
    s_add_u32 s32, s60, 0
    s_add_u32 s62, s60, 20480
    buffer_store_dwordx4 v[28:31], v96, s[8:11], s32 offen sc1
    buffer_store_dwordx4 v[32:35], v96, s[8:11], s62 offen sc1
    v_pk_fma_f32 v[60:61], v[160:161], v[94:95], v[60:61]
    v_pk_fma_f32 v[62:63], v[162:163], v[94:95], v[62:63]
    v_pk_fma_f32 v[64:65], v[164:165], v[94:95], v[64:65]
    v_pk_fma_f32 v[66:67], v[166:167], v[94:95], v[66:67]
    v_pk_fma_f32 v[68:69], v[168:169], v[94:95], v[68:69]
    v_pk_fma_f32 v[70:71], v[170:171], v[94:95], v[70:71]
    v_pk_fma_f32 v[72:73], v[172:173], v[94:95], v[72:73]
    v_pk_fma_f32 v[74:75], v[174:175], v[94:95], v[74:75]
    v_pk_mul_f32 v[60:61], v[60:61], v[192:193]
    v_pk_mul_f32 v[62:63], v[62:63], v[194:195]
    v_pk_mul_f32 v[64:65], v[64:65], v[196:197]
    v_pk_mul_f32 v[66:67], v[66:67], v[198:199]
    v_pk_mul_f32 v[68:69], v[68:69], v[200:201]
    v_pk_mul_f32 v[70:71], v[70:71], v[202:203]
    v_pk_mul_f32 v[72:73], v[72:73], v[204:205]
    v_pk_mul_f32 v[74:75], v[74:75], v[206:207]
    v_cvt_pk_bf16_f32 v60, v60, v61
    v_cvt_pk_bf16_f32 v61, v62, v63
    v_cvt_pk_bf16_f32 v62, v64, v65
    v_cvt_pk_bf16_f32 v63, v66, v67
    v_cvt_pk_bf16_f32 v64, v68, v69
    v_cvt_pk_bf16_f32 v65, v70, v71
    v_cvt_pk_bf16_f32 v66, v72, v73
    v_cvt_pk_bf16_f32 v67, v74, v75
    s_add_u32 s32, s60, 0
    s_add_u32 s62, s60, 20480
    buffer_store_dwordx4 v[60:63], v97, s[8:11], s32 offen sc1
    buffer_store_dwordx4 v[64:67], v97, s[8:11], s62 offen sc1
    s_waitcnt lgkmcnt(0)
    v_pk_fma_f32 v[44:45], v[176:177], v[92:93], v[44:45]
    v_pk_fma_f32 v[46:47], v[178:179], v[92:93], v[46:47]
    v_pk_fma_f32 v[48:49], v[180:181], v[92:93], v[48:49]
    v_pk_fma_f32 v[50:51], v[182:183], v[92:93], v[50:51]
    v_pk_fma_f32 v[52:53], v[184:185], v[92:93], v[52:53]
    v_pk_fma_f32 v[54:55], v[186:187], v[92:93], v[54:55]
    v_pk_fma_f32 v[56:57], v[188:189], v[92:93], v[56:57]
    v_pk_fma_f32 v[58:59], v[190:191], v[92:93], v[58:59]
    v_pk_mul_f32 v[44:45], v[44:45], v[208:209]
    v_pk_mul_f32 v[46:47], v[46:47], v[210:211]
    v_pk_mul_f32 v[48:49], v[48:49], v[212:213]
    v_pk_mul_f32 v[50:51], v[50:51], v[214:215]
    v_pk_mul_f32 v[52:53], v[52:53], v[216:217]
    v_pk_mul_f32 v[54:55], v[54:55], v[218:219]
    v_pk_mul_f32 v[56:57], v[56:57], v[220:221]
    v_pk_mul_f32 v[58:59], v[58:59], v[222:223]
    v_cvt_pk_bf16_f32 v44, v44, v45
    v_cvt_pk_bf16_f32 v45, v46, v47
    v_cvt_pk_bf16_f32 v46, v48, v49
    v_cvt_pk_bf16_f32 v47, v50, v51
    v_cvt_pk_bf16_f32 v48, v52, v53
    v_cvt_pk_bf16_f32 v49, v54, v55
    v_cvt_pk_bf16_f32 v50, v56, v57
    v_cvt_pk_bf16_f32 v51, v58, v59
    s_add_u32 s32, s60, 40960
    s_add_u32 s62, s60, 61440
    buffer_store_dwordx4 v[44:47], v96, s[8:11], s32 offen sc1
    buffer_store_dwordx4 v[48:51], v96, s[8:11], s62 offen sc1
    v_pk_fma_f32 v[76:77], v[176:177], v[94:95], v[76:77]
    v_pk_fma_f32 v[78:79], v[178:179], v[94:95], v[78:79]
    v_pk_fma_f32 v[80:81], v[180:181], v[94:95], v[80:81]
    v_pk_fma_f32 v[82:83], v[182:183], v[94:95], v[82:83]
    v_pk_fma_f32 v[84:85], v[184:185], v[94:95], v[84:85]
    v_pk_fma_f32 v[86:87], v[186:187], v[94:95], v[86:87]
    v_pk_fma_f32 v[88:89], v[188:189], v[94:95], v[88:89]
    v_pk_fma_f32 v[90:91], v[190:191], v[94:95], v[90:91]
    v_pk_mul_f32 v[76:77], v[76:77], v[208:209]
    v_pk_mul_f32 v[78:79], v[78:79], v[210:211]
    v_pk_mul_f32 v[80:81], v[80:81], v[212:213]
    v_pk_mul_f32 v[82:83], v[82:83], v[214:215]
    v_pk_mul_f32 v[84:85], v[84:85], v[216:217]
    v_pk_mul_f32 v[86:87], v[86:87], v[218:219]
    v_pk_mul_f32 v[88:89], v[88:89], v[220:221]
    v_pk_mul_f32 v[90:91], v[90:91], v[222:223]
    v_cvt_pk_bf16_f32 v76, v76, v77
    v_cvt_pk_bf16_f32 v77, v78, v79
    v_cvt_pk_bf16_f32 v78, v80, v81
    v_cvt_pk_bf16_f32 v79, v82, v83
    v_cvt_pk_bf16_f32 v80, v84, v85
    v_cvt_pk_bf16_f32 v81, v86, v87
    v_cvt_pk_bf16_f32 v82, v88, v89
    v_cvt_pk_bf16_f32 v83, v90, v91
    s_add_u32 s32, s60, 40960
    s_add_u32 s62, s60, 61440
    buffer_store_dwordx4 v[76:79], v97, s[8:11], s32 offen sc1
    buffer_store_dwordx4 v[80:83], v97, s[8:11], s62 offen sc1
L_sequential_preLN__softmax_full_mha__swiglu_ffn__prompt_kernel_J0_4:
    s_setprio 0
    s_lshl_b32 s58, s2, 2
    s_add_u32 s58, s58, s13
    s_mov_b32 s34, 8
    s_mov_b32 s35, 4
    v_bfe_u32 v7, v1, 4, 1
    v_lshrrev_b32 v6, 5, v1
    s_waitcnt lgkmcnt(0)
    s_cmp_ge_u32 s58, 560
    s_cbranch_scc1 L_sequential_preLN__softmax_full_mha__swiglu_ffn__prompt_kernel_pd_14
    s_mul_i32 s36, s58, 4682
    s_lshr_b32 s36, s36, 16
    s_mul_i32 s59, s36, 14
    s_sub_u32 s59, s58, s59
    s_mul_i32 s20, s36, 114688
    s_add_u32 s20, s20, 21889024
    s_mov_b32 s21, 13500416
    v_lshlrev_b32 v7, 11, v7
    v_lshl_add_u32 v8, v6, 9, v7
    s_lshl_b32 s32, s36, 4
    s_mov_b32 s33, 0
    s_movk_i32 s60, 3456
    s_mov_b64 s[24:25], s[48:49]
    s_mov_b64 s[28:29], s[50:51]
    s_mov_b32 s26, 2211840
    s_branch L_sequential_preLN__softmax_full_mha__swiglu_ffn__prompt_kernel_pg_15
L_sequential_preLN__softmax_full_mha__swiglu_ffn__prompt_kernel_pd_14:
    s_min_u32 s58, s58, 929
    s_cmp_lt_u32 s58, 830
    s_movk_i32 s59, 830
    s_cselect_b32 s59, 560, s59
    s_mov_b32 s20, 20971520
    s_cselect_b32 s20, 26476544, s20
    s_cselect_b64 s[24:25], s[52:53], s[44:45]
    s_cselect_b32 s33, 16, 20
    s_cselect_b32 s32, 32, 40
    s_mov_b32 s26, 819200
    s_cselect_b32 s26, 2211840, s26
    s_sub_u32 s59, s58, s59
    s_mul_i32 s36, s59, 13108
    s_lshr_b32 s36, s36, 16
    s_mul_i32 s60, s36, 5
    s_sub_u32 s59, s59, s60
    s_mul_i32 s60, s36, 40960
    s_add_u32 s20, s20, s60
    s_mov_b32 s21, 29884416
    v_lshlrev_b32 v7, 9, v7
    v_lshl_add_u32 v8, v6, 11, v7
    s_mul_i32 s32, s32, s36
    s_mul_i32 s60, s36, 160
    s_sub_u32 s60, s60, 2544
    s_cmp_ge_u32 s58, 910
    s_cselect_b32 s32, s60, s32
    s_cselect_b32 s33, 80, s33
    s_cselect_b32 s34, 20, 8
    s_cselect_b32 s35, 40, 4
    s_movk_i32 s60, 1280
    s_mov_b64 s[28:29], s[24:25]
L_sequential_preLN__softmax_full_mha__swiglu_ffn__prompt_kernel_pg_15:
    s_lshl_b32 s59, s59, 1
    s_lshr_b32 s58, s12, 2
    s_add_u32 s58, s58, s59
    s_lshl_b32 s36, s58, 12
    s_add_u32 s20, s20, s36
    s_lshl_b32 s36, s58, 9
    s_add_u32 s21, s21, s36
    v_bfe_u32 v7, v1, 2, 2
    v_lshl_add_u32 v8, v7, 7, v8
    v_and_b32 v7, 3, v1
    v_lshl_add_u32 v8, v7, 3, v8
    s_lshl_b32 s36, s12, 12
    s_add_u32 s36, s36, 73728
    v_add_u32 v3, s36, v8
    s_mov_b32 s30, s26
    s_mov_b32 s27, 0x20000
    s_mov_b32 s31, 0x20000
    v_mul_u32_u24 v7, s35, v6
    v_bfe_u32 v8, v1, 3, 2
    v_add_u32 v7, v7, v8
    v_mul_u32_u24 v7, s60, v7
    v_and_b32 v8, 7, v1
    v_lshl_add_u32 v4, v8, 4, v7
    s_mul_i32 s32, s32, s60
    s_lshl_b32 s59, s58, 7
    s_add_u32 s32, s32, s59
    s_mul_i32 s33, s33, s60
    s_mul_i32 s34, s34, s60
    s_add_u32 s33, s33, s32
    s_add_u32 s35, s33, s34
    s_add_u32 s34, s34, s32
    s_mov_b32 s15, s57
    s_lshl_b32 s14, s57, 5
    s_add_u32 s14, s14, s56
    s_lshl_b32 s14, s14, 6
    s_add_u32 s14, s14, 13598720
    s_and_b32 s42, s2, 7
    s_lshl_b32 s42, s42, 2
    s_bfe_u32 s43, s2, 0x20003
    s_add_u32 s37, s42, s43
    s_lshr_b32 s52, s37, 1
    s_mul_i32 s42, s52, 5
    s_and_b32 s43, s37, 1
    s_lshl_b32 s40, s43, 3
    s_mul_i32 s43, s43, 3
    s_add_u32 s38, s42, s43
    s_lshl_b32 s38, s38, 15
    s_add_u32 s39, s42, 2
    s_lshl_b32 s39, s39, 15
    s_lshr_b32 s53, s13, 1
    s_and_b32 s45, s12, 1
    s_mul_i32 s50, s53, 6144
    s_cmp_ge_u32 s12, 4
    s_cbranch_scc1 L_sequential_preLN__softmax_full_mha__swiglu_ffn__prompt_kernel_dv_19
    s_lshl_b32 s42, s53, 14
    s_lshl_b32 s43, s45, 10
    s_add_u32 s50, s50, s43
    s_add_u32 s42, s42, s43
    s_add_u32 s42, s42, 2621440
    s_add_u32 s43, s38, s42
    s_add_u32 s44, s39, s42
    v_add_u32 v216, s43, v2
    v_add_u32 v217, 32768, v216
    v_add_u32 v218, s44, v2
    v_mov_b32 v219, 2048
    v_mov_b32 v220, 2048
    v_mov_b32 v221, 2048
    s_movk_i32 s51, 2048
    s_branch L_sequential_preLN__softmax_full_mha__swiglu_ffn__prompt_kernel_dd_20
L_sequential_preLN__softmax_full_mha__swiglu_ffn__prompt_kernel_dv_19:
    s_mul_i32 s43, s45, 3072
    s_add_u32 s50, s50, s43
    s_add_u32 s50, s50, 36864
    s_mul_i32 s42, s53, 1310720
    s_mul_i32 s43, s37, 320
    s_add_u32 s42, s42, s43
    s_add_u32 s42, s42, 5242880
    s_mul_i32 s45, s45, 192
    s_movk_i32 s51, 1024
    v_mov_b32 v16, 7929856
    v_mov_b32 v17, 163840
    v_add_u32 v12, s45, v1
    s_add_u32 s45, s45, 64
    v_mul_u32_u24 v13, 3121, v12
    v_lshrrev_b32 v13, 16, v13
    v_mul_u32_u24 v14, 21, v13
    v_sub_u32 v14, v12, v14
    v_cmp_gt_u32 vcc, 20, v14
    v_cmp_gt_u32 s[56:57], 16, v13
    v_mul_u32_u24 v13, 10240, v13
    v_lshl_add_u32 v13, v14, 4, v13
    s_and_b64 vcc, vcc, s[56:57]
    v_add_u32 v13, s42, v13
    v_cndmask_b32 v216, v16, v13, vcc
    v_cndmask_b32 v219, 0, v17, vcc
    v_add_u32 v12, s45, v1
    s_add_u32 s45, s45, 64
    v_mul_u32_u24 v13, 3121, v12
    v_lshrrev_b32 v13, 16, v13
    v_mul_u32_u24 v14, 21, v13
    v_sub_u32 v14, v12, v14
    v_cmp_gt_u32 vcc, 20, v14
    v_cmp_gt_u32 s[56:57], 16, v13
    v_mul_u32_u24 v13, 10240, v13
    v_lshl_add_u32 v13, v14, 4, v13
    s_and_b64 vcc, vcc, s[56:57]
    v_add_u32 v13, s42, v13
    v_cndmask_b32 v217, v16, v13, vcc
    v_cndmask_b32 v220, 0, v17, vcc
    v_add_u32 v12, s45, v1
    s_add_u32 s45, s45, 64
    v_mul_u32_u24 v13, 3121, v12
    v_lshrrev_b32 v13, 16, v13
    v_mul_u32_u24 v14, 21, v13
    v_sub_u32 v14, v12, v14
    v_cmp_gt_u32 vcc, 20, v14
    v_cmp_gt_u32 s[56:57], 16, v13
    v_mul_u32_u24 v13, 10240, v13
    v_lshl_add_u32 v13, v14, 4, v13
    s_and_b64 vcc, vcc, s[56:57]
    v_add_u32 v13, s42, v13
    v_cndmask_b32 v218, v16, v13, vcc
    v_cndmask_b32 v221, 0, v17, vcc
L_sequential_preLN__softmax_full_mha__swiglu_ffn__prompt_kernel_dd_20:
    s_lshr_b32 s45, s12, 2
    s_mul_i32 s42, s45, 6144
    v_and_b32 v6, 31, v1
    v_lshlrev_b32 v6, 4, v6
    v_lshrrev_b32 v13, 5, v1
    v_lshl_add_u32 v5, v13, 15, v6
    v_add_u32 v14, s42, v6
    v_lshl_add_u32 v7, v13, 11, v14
    v_add_u32 v8, s40, v14
    v_add_u32 v8, 4096, v8
    v_mul_u32_u24 v12, 336, v13
    v_add_u32 v12, v12, v14
    v_add_u32 v9, 36864, v12
    v_cmp_lt_u32 vcc, 320, v6
    v_mov_b32 v12, 0x40000
    v_xor_b32 v13, s45, v13
    v_cndmask_b32 v9, v9, v12, vcc
    v_lshl_add_u32 v10, v13, 9, v6
    s_lshr_b32 s41, s2, 5
    s_lshl_b32 s41, s41, 8
    s_lshl_b32 s42, s13, 6
    s_add_u32 s41, s41, s42
    s_lshl_b32 s42, s45, 5
    s_add_u32 s41, s41, s42
    v_lshlrev_b32 v204, 2, v1
    v_mov_b32 v12, 0x3f803f80
    v_cmp_eq_u32 vcc, 0, v6
    s_nop 1
    v_cndmask_b32 v188, 0, v12, vcc
    v_mov_b32 v189, v188
    v_mov_b32 v190, v188
    v_mov_b32 v191, v188
    v_cmp_eq_u32 vcc, 64, v6
    s_nop 1
    v_cndmask_b32 v192, 0, v12, vcc
    v_mov_b32 v193, v192
    v_mov_b32 v194, v192
    v_mov_b32 v195, v192
    v_cmp_eq_u32 vcc, 16, v6
    s_nop 1
    v_cndmask_b32 v196, 0, v12, vcc
    v_mov_b32 v197, v196
    v_mov_b32 v198, v196
    v_mov_b32 v199, v196
    v_cmp_eq_u32 vcc, 80, v6
    s_nop 1
    v_cndmask_b32 v200, 0, v12, vcc
    v_mov_b32 v201, v200
    v_mov_b32 v202, v200
    v_mov_b32 v203, v200
    v_bfe_u32 v213, v1, 4, 1
    v_mul_u32_u24 v213, 20480, v213
    v_and_b32 v14, 15, v1
    v_lshl_add_u32 v212, v14, 4, v213
    v_lshl_add_u32 v213, v14, 3, v213
    v_lshrrev_b32 v14, 5, v1
    v_lshl_add_u32 v212, v14, 8, v212
    s_lshr_b32 s42, s41, 4
    s_mul_i32 s42, s42, 20480
    s_add_u32 s42, s42, 8126464
    s_lshl_b32 s58, s37, 9
    s_add_u32 s58, s58, s42
    s_lshl_b32 s59, s37, 7
    s_add_u32 s59, s59, s42
    s_add_u32 s59, s59, 16384
    s_mul_i32 s42, s13, 3072
    s_add_u32 s42, s42, 24576
    s_add_u32 s43, s42, 36864
    s_cmp_lt_u32 s12, 4
    s_cselect_b32 s44, s42, s43
    s_cselect_b32 s43, s43, s42
    v_add_u32 v214, s44, v2
    v_add_u32 v215, s43, v2
    s_mul_i32 s42, s52, 40
    s_add_u32 s43, s42, 39
    s_lshr_b32 s42, s42, 7
    s_lshr_b32 s43, s43, 7
    s_lshl_b32 s54, s42, 11
    s_lshl_b32 s55, s43, 11
    s_add_u32 s54, s54, 13598720
    s_add_u32 s55, s55, 13598720
    v_lshrrev_b32 v14, 4, v1
    v_min_u32 v14, 2, v14
    v_mul_u32_u24 v14, 160, v14
    v_and_b32 v15, 15, v1
    v_add_u32 v15, v15, v14
    v_lshlrev_b32 v222, 6, v15
    s_sub_u32 s43, s43, s42
    v_and_b32 v14, 1, v1
    v_mul_u32_u24 v14, s43, v14
    v_bfe_u32 v15, v1, 1, 1
    v_bfe_u32 v16, v1, 2, 1
    v_bfe_u32 v17, v1, 3, 1
    v_lshl_add_u32 v16, v17, 3, v16
    v_mad_u32_u24 v17, v15, 5, 5
    s_lshr_b32 s43, s2, 5
    s_lshl_b32 s43, s43, 1
    v_add_u32 v15, s43, v15
    v_cmp_gt_u32 vcc, 16, v1
    s_nop 1
    v_cndmask_b32 v17, 0, v17, vcc
    v_cndmask_b32 v16, v15, v16, vcc
    v_add_u32 v14, v14, v17
    v_lshl_add_u32 v14, v14, 5, v16
    v_lshlrev_b32 v223, 6, v14
    s_cmp_lg_u32 s12, 0
    s_cbranch_scc1 L_sequential_preLN__softmax_full_mha__swiglu_ffn__prompt_kernel_jzx_24
    s_cmp_lg_u32 s15, 15
    s_cbranch_scc1 L_sequential_preLN__softmax_full_mha__swiglu_ffn__prompt_kernel_jzx_24
    v_and_b32 v15, 15, v1
    v_lshlrev_b32 v15, 4, v15
    s_mov_b32 s43, 0
L_sequential_preLN__softmax_full_mha__swiglu_ffn__prompt_kernel_jz_23:
    buffer_load_dword v16, v15, s[16:19], 0 offen sc1
    s_add_u32 s43, s43, 1
    s_cmp_gt_u32 s43, 0x40000
    s_cbranch_scc1 L_sequential_preLN__softmax_full_mha__swiglu_ffn__prompt_kernel_jzx_24
    s_waitcnt vmcnt(0)
    v_cmp_ne_u32 vcc, 0, v16
    s_nop 0
    s_cmp_eq_u64 vcc, -1
    s_cbranch_scc0 L_sequential_preLN__softmax_full_mha__swiglu_ffn__prompt_kernel_jz_23
L_sequential_preLN__softmax_full_mha__swiglu_ffn__prompt_kernel_jzx_24:
    s_waitcnt vmcnt(0)
    s_barrier
    s_cmp_lg_u32 s12, 0
    s_cbranch_scc1 L_sequential_preLN__softmax_full_mha__swiglu_ffn__prompt_kernel_jx_21
    v_mov_b32 v14, 1
    v_mov_b32 v15, 0
    s_mov_b64 exec, 1
    buffer_store_dword v14, v15, s[8:11], s14 offen sc1
    s_mov_b64 exec, -1
    s_mov_b32 s44, 0
L_sequential_preLN__softmax_full_mha__swiglu_ffn__prompt_kernel_jp_22:
    buffer_load_dword v224, v223, s[8:11], s54 offen sc1
    s_add_u32 s44, s44, 1
    s_cmp_gt_u32 s44, 0x40000
    s_cbranch_scc1 L_sequential_preLN__softmax_full_mha__swiglu_ffn__prompt_kernel_jx_21
    s_waitcnt vmcnt(0)
    v_cmp_ne_u32 vcc, 0, v224
    s_nop 0
    s_cmp_eq_u64 vcc, -1
    s_cbranch_scc0 L_sequential_preLN__softmax_full_mha__swiglu_ffn__prompt_kernel_jp_22
L_sequential_preLN__softmax_full_mha__swiglu_ffn__prompt_kernel_jx_21:
    s_lshl_b32 s42, s41, 4
    s_add_u32 s52, s42, s38
    s_xor_b32 s45, s52, 512
    s_andn2_b32 s53, s42, 512
    s_add_u32 s53, s53, s39
    s_add_u32 s53, s53, s40
    s_barrier
    s_add_u32 m0, s50, 0
    s_nop 0
    buffer_load_dwordx4 v216, s[8:11], 0 offen sc1 lds
    s_add_u32 m0, m0, s51
    v_add_u32 v216, v216, v219
    buffer_load_dwordx4 v217, s[8:11], 0 offen sc1 lds
    s_add_u32 m0, m0, s51
    v_add_u32 v217, v217, v220
    buffer_load_dwordx4 v218, s[8:11], 0 offen sc1 lds
    v_add_u32 v218, v218, v221
    buffer_load_dwordx4 v[124:127], v5, s[8:11], s52 offen
    buffer_load_dwordx4 v[128:131], v5, s[8:11], s45 offen
    buffer_load_dwordx2 v[132:133], v10, s[8:11], s53 offen
    s_add_u32 m0, s50, 12288
    s_nop 0
    buffer_load_dwordx4 v216, s[8:11], 0 offen sc1 lds
    s_add_u32 m0, m0, s51
    v_add_u32 v216, v216, v219
    buffer_load_dwordx4 v217, s[8:11], 0 offen sc1 lds
    s_add_u32 m0, m0, s51
    v_add_u32 v217, v217, v220
    buffer_load_dwordx4 v218, s[8:11], 0 offen sc1 lds
    v_add_u32 v218, v218, v221
    s_waitcnt vmcnt(3)
    s_barrier
    ds_read_b128 v[136:139], v7 offset:0
    ds_read_b64 v[140:141], v8 offset:0
    s_waitcnt lgkmcnt(0)
    v_mfma_f32_32x32x4_2b_bf16 v[20:51], v[140:141], v[132:133], 0
    s_nop 1
    s_nop 15
    v_mfma_f32_32x32x16_bf16 v[20:35], v[136:139], v[124:127], v[20:35]
    v_mfma_f32_32x32x16_bf16 v[36:51], v[136:139], v[128:131], v[36:51]
    ds_read_b128 v[136:139], v7 offset:512
    ds_read_b64 v[140:141], v8 offset:512
    ds_read_b128 v[144:147], v9 offset:0
    ds_read_b128 v[148:151], v9 offset:672
    s_setprio 3
    s_nop 5
    v_exp_f32 v20, v20
    v_exp_f32 v21, v21
    v_exp_f32 v22, v22
    v_exp_f32 v23, v23
    s_waitcnt lgkmcnt(2)
    v_mfma_f32_32x32x4_2b_bf16 v[52:83], v[140:141], v[132:133], 0
    v_exp_f32 v24, v24
    v_cvt_pk_bf16_f32 v116, v20, v21
    v_exp_f32 v25, v25
    v_cvt_pk_bf16_f32 v117, v22, v23
    v_exp_f32 v26, v26
    v_exp_f32 v27, v27
    v_cvt_pk_bf16_f32 v118, v24, v25
    v_exp_f32 v28, v28
    v_cvt_pk_bf16_f32 v119, v26, v27
    v_exp_f32 v29, v29
    v_exp_f32 v30, v30
    s_waitcnt lgkmcnt(0)
    v_mfma_f32_32x32x16_bf16 v[84:99], v[144:147], v[116:119], 0
    v_exp_f32 v31, v31
    v_cvt_pk_bf16_f32 v120, v28, v29
    v_exp_f32 v32, v32
    v_cvt_pk_bf16_f32 v121, v30, v31
    v_exp_f32 v33, v33
    v_exp_f32 v34, v34
    v_mfma_f32_32x32x16_bf16 v[52:67], v[136:139], v[124:127], v[52:67]
    v_exp_f32 v35, v35
    v_cvt_pk_bf16_f32 v122, v32, v33
    v_exp_f32 v36, v36
    v_cvt_pk_bf16_f32 v123, v34, v35
    v_exp_f32 v37, v37
    v_exp_f32 v38, v38
    v_mfma_f32_32x32x16_bf16 v[84:99], v[148:151], v[120:123], v[84:99]
    v_exp_f32 v39, v39
    v_cvt_pk_bf16_f32 v116, v36, v37
    v_exp_f32 v40, v40
    v_cvt_pk_bf16_f32 v117, v38, v39
    v_exp_f32 v41, v41
    v_exp_f32 v42, v42
    v_mfma_f32_32x32x16_bf16 v[68:83], v[136:139], v[128:131], v[68:83]
    ds_read_b128 v[136:139], v7 offset:1024
    ds_read_b64 v[140:141], v8 offset:1024
    v_exp_f32 v43, v43
    v_cvt_pk_bf16_f32 v118, v40, v41
    v_exp_f32 v44, v44
    v_cvt_pk_bf16_f32 v119, v42, v43
    v_exp_f32 v45, v45
    v_exp_f32 v46, v46
    v_mfma_f32_32x32x16_bf16 v[100:115], v[144:147], v[116:119], 0
    v_exp_f32 v47, v47
    v_cvt_pk_bf16_f32 v120, v44, v45
    v_exp_f32 v48, v48
    v_cvt_pk_bf16_f32 v121, v46, v47
    v_exp_f32 v49, v49
    v_exp_f32 v50, v50
    v_exp_f32 v51, v51
    v_cvt_pk_bf16_f32 v122, v48, v49
    ds_read_b128 v[144:147], v9 offset:1344
    v_cvt_pk_bf16_f32 v123, v50, v51
    ds_read_b128 v[152:155], v9 offset:2016
    s_nop 0
    v_mfma_f32_32x32x16_bf16 v[100:115], v[148:151], v[120:123], v[100:115]
    v_exp_f32 v52, v52
    v_exp_f32 v53, v53
    v_exp_f32 v54, v54
    v_exp_f32 v55, v55
    s_waitcnt lgkmcnt(2)
    v_mfma_f32_32x32x4_2b_bf16 v[20:51], v[140:141], v[132:133], 0
    v_exp_f32 v56, v56
    v_cvt_pk_bf16_f32 v116, v52, v53
    v_exp_f32 v57, v57
    v_cvt_pk_bf16_f32 v117, v54, v55
    v_exp_f32 v58, v58
    v_exp_f32 v59, v59
    v_cvt_pk_bf16_f32 v118, v56, v57
    v_exp_f32 v60, v60
    v_cvt_pk_bf16_f32 v119, v58, v59
    v_exp_f32 v61, v61
    v_exp_f32 v62, v62
    s_waitcnt lgkmcnt(0)
    v_mfma_f32_32x32x16_bf16 v[84:99], v[144:147], v[116:119], v[84:99]
    s_setprio 2
    v_exp_f32 v63, v63
    v_cvt_pk_bf16_f32 v120, v60, v61
    v_exp_f32 v64, v64
    v_cvt_pk_bf16_f32 v121, v62, v63
    v_exp_f32 v65, v65
    v_exp_f32 v66, v66
    v_mfma_f32_32x32x16_bf16 v[20:35], v[136:139], v[124:127], v[20:35]
    v_exp_f32 v67, v67
    v_cvt_pk_bf16_f32 v122, v64, v65
    v_exp_f32 v68, v68
    v_cvt_pk_bf16_f32 v123, v66, v67
    v_exp_f32 v69, v69
    v_exp_f32 v70, v70
    v_mfma_f32_32x32x16_bf16 v[84:99], v[152:155], v[120:123], v[84:99]
    v_exp_f32 v71, v71
    v_cvt_pk_bf16_f32 v116, v68, v69
    v_exp_f32 v72, v72
    v_cvt_pk_bf16_f32 v117, v70, v71
    v_exp_f32 v73, v73
    v_exp_f32 v74, v74
    v_mfma_f32_32x32x16_bf16 v[36:51], v[136:139], v[128:131], v[36:51]
    s_cmp_lg_u32 s12, 0
    s_cbranch_scc1 L_sequential_preLN__softmax_full_mha__swiglu_ffn__prompt_kernel_nq_26
    buffer_load_dword v224, v222, s[8:11], s54 offen sc1
    buffer_load_dword v225, v222, s[8:11], s55 offen sc1
L_sequential_preLN__softmax_full_mha__swiglu_ffn__prompt_kernel_nq_26:
    ds_read_b128 v[136:139], v7 offset:1536
    ds_read_b64 v[140:141], v8 offset:1536
    v_exp_f32 v75, v75
    v_cvt_pk_bf16_f32 v118, v72, v73
    v_exp_f32 v76, v76
    v_cvt_pk_bf16_f32 v119, v74, v75
    v_exp_f32 v77, v77
    v_exp_f32 v78, v78
    v_mfma_f32_32x32x16_bf16 v[100:115], v[144:147], v[116:119], v[100:115]
    v_exp_f32 v79, v79
    v_cvt_pk_bf16_f32 v120, v76, v77
    v_exp_f32 v80, v80
    v_cvt_pk_bf16_f32 v121, v78, v79
    v_exp_f32 v81, v81
    v_exp_f32 v82, v82
    v_exp_f32 v83, v83
    v_cvt_pk_bf16_f32 v122, v80, v81
    ds_read_b128 v[144:147], v9 offset:2688
    v_cvt_pk_bf16_f32 v123, v82, v83
    ds_read_b128 v[148:151], v9 offset:3360
    s_nop 0
    v_mfma_f32_32x32x16_bf16 v[100:115], v[152:155], v[120:123], v[100:115]
    v_exp_f32 v20, v20
    v_exp_f32 v21, v21
    v_exp_f32 v22, v22
    v_exp_f32 v23, v23
    s_waitcnt lgkmcnt(2)
    v_mfma_f32_32x32x4_2b_bf16 v[52:83], v[140:141], v[132:133], 0
    s_setprio 1
    v_exp_f32 v24, v24
    v_cvt_pk_bf16_f32 v116, v20, v21
    v_exp_f32 v25, v25
    v_cvt_pk_bf16_f32 v117, v22, v23
    v_exp_f32 v26, v26
    v_exp_f32 v27, v27
    v_cvt_pk_bf16_f32 v118, v24, v25
    v_exp_f32 v28, v28
    v_cvt_pk_bf16_f32 v119, v26, v27
    v_exp_f32 v29, v29
    v_exp_f32 v30, v30
    s_waitcnt lgkmcnt(0)
    v_mfma_f32_32x32x16_bf16 v[84:99], v[144:147], v[116:119], v[84:99]
    v_exp_f32 v31, v31
    v_cvt_pk_bf16_f32 v120, v28, v29
    v_exp_f32 v32, v32
    v_cvt_pk_bf16_f32 v121, v30, v31
    v_exp_f32 v33, v33
    v_exp_f32 v34, v34
    v_mfma_f32_32x32x16_bf16 v[52:67], v[136:139], v[124:127], v[52:67]
    v_exp_f32 v35, v35
    v_cvt_pk_bf16_f32 v122, v32, v33
    v_exp_f32 v36, v36
    v_cvt_pk_bf16_f32 v123, v34, v35
    v_exp_f32 v37, v37
    v_exp_f32 v38, v38
    v_mfma_f32_32x32x16_bf16 v[84:99], v[148:151], v[120:123], v[84:99]
    s_setprio 0
    v_exp_f32 v39, v39
    v_cvt_pk_bf16_f32 v116, v36, v37
    v_exp_f32 v40, v40
    v_cvt_pk_bf16_f32 v117, v38, v39
    v_exp_f32 v41, v41
    v_exp_f32 v42, v42
    v_mfma_f32_32x32x16_bf16 v[68:83], v[136:139], v[128:131], v[68:83]
    s_waitcnt vmcnt(0)
    s_cmp_lg_u32 s12, 0
    s_cbranch_scc1 L_sequential_preLN__softmax_full_mha__swiglu_ffn__prompt_kernel_nq_27
    s_mov_b32 s44, 0
L_sequential_preLN__softmax_full_mha__swiglu_ffn__prompt_kernel_q_28:
    v_min_u32 v224, v224, v225
    s_add_u32 s44, s44, 1
    v_cmp_ne_u32 vcc, 0, v224
    s_nop 0
    s_cmp_eq_u64 vcc, -1
    s_cbranch_scc1 L_sequential_preLN__softmax_full_mha__swiglu_ffn__prompt_kernel_nq_27
    s_cmp_gt_u32 s44, 0x40000
    s_cbranch_scc1 L_sequential_preLN__softmax_full_mha__swiglu_ffn__prompt_kernel_nq_27
    buffer_load_dword v224, v222, s[8:11], s54 offen sc1
    buffer_load_dword v225, v222, s[8:11], s55 offen sc1
    s_waitcnt vmcnt(0)
    s_branch L_sequential_preLN__softmax_full_mha__swiglu_ffn__prompt_kernel_q_28
L_sequential_preLN__softmax_full_mha__swiglu_ffn__prompt_kernel_nq_27:
    s_barrier
    s_setprio 3
    ds_read_b128 v[136:139], v7 offset:12288
    ds_read_b64 v[140:141], v8 offset:12288
    v_exp_f32 v43, v43
    s_add_u32 m0, s50, 24576
    v_cvt_pk_bf16_f32 v118, v40, v41
    v_exp_f32 v44, v44
    s_nop 0
    v_cvt_pk_bf16_f32 v119, v42, v43
    v_exp_f32 v45, v45
    buffer_load_dwordx4 v216, s[8:11], 0 offen sc1 lds
    v_exp_f32 v46, v46
    s_add_u32 m0, m0, s51
    v_mfma_f32_32x32x16_bf16 v[100:115], v[144:147], v[116:119], v[100:115]
    v_exp_f32 v47, v47
    v_add_u32 v216, v216, v219
    v_cvt_pk_bf16_f32 v120, v44, v45
    v_exp_f32 v48, v48
    buffer_load_dwordx4 v217, s[8:11], 0 offen sc1 lds
    v_cvt_pk_bf16_f32 v121, v46, v47
    v_exp_f32 v49, v49
    s_add_u32 m0, m0, s51
    v_exp_f32 v50, v50
    v_add_u32 v217, v217, v220
    v_exp_f32 v51, v51
    buffer_load_dwordx4 v218, s[8:11], 0 offen sc1 lds
    v_cvt_pk_bf16_f32 v122, v48, v49
    ds_read_b128 v[144:147], v9 offset:4032
    v_cvt_pk_bf16_f32 v123, v50, v51
    ds_read_b128 v[152:155], v9 offset:4704
    s_nop 0
    v_mfma_f32_32x32x16_bf16 v[100:115], v[148:151], v[120:123], v[100:115]
    v_exp_f32 v52, v52
    v_add_u32 v218, v218, v221
    v_exp_f32 v53, v53
    v_exp_f32 v54, v54
    v_exp_f32 v55, v55
    s_waitcnt lgkmcnt(2)
    v_mfma_f32_32x32x4_2b_bf16 v[20:51], v[140:141], v[132:133], 0
    v_exp_f32 v56, v56
    v_cvt_pk_bf16_f32 v116, v52, v53
    v_exp_f32 v57, v57
    v_cvt_pk_bf16_f32 v117, v54, v55
    v_exp_f32 v58, v58
    v_exp_f32 v59, v59
    v_cvt_pk_bf16_f32 v118, v56, v57
    v_exp_f32 v60, v60
    v_cvt_pk_bf16_f32 v119, v58, v59
    v_exp_f32 v61, v61
    v_exp_f32 v62, v62
    s_waitcnt lgkmcnt(0)
    v_mfma_f32_32x32x16_bf16 v[84:99], v[144:147], v[116:119], v[84:99]
    v_exp_f32 v63, v63
    v_cvt_pk_bf16_f32 v120, v60, v61
    v_exp_f32 v64, v64
    v_cvt_pk_bf16_f32 v121, v62, v63
    v_exp_f32 v65, v65
    v_exp_f32 v66, v66
    v_mfma_f32_32x32x16_bf16 v[20:35], v[136:139], v[124:127], v[20:35]
    v_exp_f32 v67, v67
    v_cvt_pk_bf16_f32 v122, v64, v65
    v_exp_f32 v68, v68
    v_cvt_pk_bf16_f32 v123, v66, v67
    v_exp_f32 v69, v69
    v_exp_f32 v70, v70
    v_mfma_f32_32x32x16_bf16 v[84:99], v[152:155], v[120:123], v[84:99]
    v_exp_f32 v71, v71
    v_cvt_pk_bf16_f32 v116, v68, v69
    v_exp_f32 v72, v72
    v_cvt_pk_bf16_f32 v117, v70, v71
    v_exp_f32 v73, v73
    v_exp_f32 v74, v74
    v_mfma_f32_32x32x16_bf16 v[36:51], v[136:139], v[128:131], v[36:51]
    ds_read_b128 v[136:139], v7 offset:12800
    ds_read_b64 v[140:141], v8 offset:12800
    v_exp_f32 v75, v75
    s_mov_b32 m0, s36
    v_cvt_pk_bf16_f32 v118, v72, v73
    v_exp_f32 v76, v76
    s_nop 0
    v_cvt_pk_bf16_f32 v119, v74, v75
    v_exp_f32 v77, v77
    buffer_load_dwordx4 v4, s[24:27], s32 offen lds
    v_exp_f32 v78, v78
    s_add_u32 m0, m0, 1024
    v_mfma_f32_32x32x16_bf16 v[100:115], v[144:147], v[116:119], v[100:115]
    v_exp_f32 v79, v79
    s_nop 0
    v_cvt_pk_bf16_f32 v120, v76, v77
    v_exp_f32 v80, v80
    buffer_load_dwordx4 v4, s[24:27], s34 offen lds
    v_cvt_pk_bf16_f32 v121, v78, v79
    v_exp_f32 v81, v81
    s_add_u32 m0, m0, 1024
    v_exp_f32 v82, v82
    s_nop 0
    v_exp_f32 v83, v83
    buffer_load_dwordx4 v4, s[28:31], s33 offen lds
    v_cvt_pk_bf16_f32 v122, v80, v81
    ds_read_b128 v[144:147], v9 offset:12288
    v_cvt_pk_bf16_f32 v123, v82, v83
    ds_read_b128 v[148:151], v9 offset:12960
    s_nop 0
    v_mfma_f32_32x32x16_bf16 v[100:115], v[152:155], v[120:123], v[100:115]
    v_exp_f32 v20, v20
    s_add_u32 m0, m0, 1024
    v_exp_f32 v21, v21
    s_nop 0
    v_exp_f32 v22, v22
    buffer_load_dwordx4 v4, s[28:31], s35 offen lds
    v_exp_f32 v23, v23
    s_waitcnt lgkmcnt(2)
    v_mfma_f32_32x32x4_2b_bf16 v[52:83], v[140:141], v[132:133], 0
    v_exp_f32 v24, v24
    v_cvt_pk_bf16_f32 v116, v20, v21
    v_exp_f32 v25, v25
    v_cvt_pk_bf16_f32 v117, v22, v23
    v_exp_f32 v26, v26
    v_exp_f32 v27, v27
    v_cvt_pk_bf16_f32 v118, v24, v25
    v_exp_f32 v28, v28
    v_cvt_pk_bf16_f32 v119, v26, v27
    v_exp_f32 v29, v29
    v_exp_f32 v30, v30
    s_waitcnt lgkmcnt(0)
    v_mfma_f32_32x32x16_bf16 v[84:99], v[144:147], v[116:119], v[84:99]
    v_exp_f32 v31, v31
    v_cvt_pk_bf16_f32 v120, v28, v29
    v_exp_f32 v32, v32
    v_cvt_pk_bf16_f32 v121, v30, v31
    v_exp_f32 v33, v33
    v_exp_f32 v34, v34
    v_mfma_f32_32x32x16_bf16 v[52:67], v[136:139], v[124:127], v[52:67]
    v_exp_f32 v35, v35
    v_cvt_pk_bf16_f32 v122, v32, v33
    v_exp_f32 v36, v36
    v_cvt_pk_bf16_f32 v123, v34, v35
    v_exp_f32 v37, v37
    v_exp_f32 v38, v38
    v_mfma_f32_32x32x16_bf16 v[84:99], v[148:151], v[120:123], v[84:99]
    v_exp_f32 v39, v39
    v_cvt_pk_bf16_f32 v116, v36, v37
    v_exp_f32 v40, v40
    v_cvt_pk_bf16_f32 v117, v38, v39
    v_exp_f32 v41, v41
    v_exp_f32 v42, v42
    v_mfma_f32_32x32x16_bf16 v[68:83], v[136:139], v[128:131], v[68:83]
    ds_read_b128 v[136:139], v7 offset:13312
    ds_read_b64 v[140:141], v8 offset:13312
    v_exp_f32 v43, v43
    v_cvt_pk_bf16_f32 v118, v40, v41
    v_exp_f32 v44, v44
    v_cvt_pk_bf16_f32 v119, v42, v43
    v_exp_f32 v45, v45
    v_exp_f32 v46, v46
    v_mfma_f32_32x32x16_bf16 v[100:115], v[144:147], v[116:119], v[100:115]
    v_exp_f32 v47, v47
    v_cvt_pk_bf16_f32 v120, v44, v45
    v_exp_f32 v48, v48
    v_cvt_pk_bf16_f32 v121, v46, v47
    v_exp_f32 v49, v49
    v_exp_f32 v50, v50
    v_exp_f32 v51, v51
    v_cvt_pk_bf16_f32 v122, v48, v49
    ds_read_b128 v[144:147], v9 offset:13632
    v_cvt_pk_bf16_f32 v123, v50, v51
    ds_read_b128 v[152:155], v9 offset:14304
    s_nop 0
    v_mfma_f32_32x32x16_bf16 v[100:115], v[148:151], v[120:123], v[100:115]
    v_exp_f32 v52, v52
    v_exp_f32 v53, v53
    v_exp_f32 v54, v54
    v_exp_f32 v55, v55
    s_waitcnt lgkmcnt(2)
    v_mfma_f32_32x32x4_2b_bf16 v[20:51], v[140:141], v[132:133], 0
    v_exp_f32 v56, v56
    v_cvt_pk_bf16_f32 v116, v52, v53
    v_exp_f32 v57, v57
    v_cvt_pk_bf16_f32 v117, v54, v55
    v_exp_f32 v58, v58
    v_exp_f32 v59, v59
    v_cvt_pk_bf16_f32 v118, v56, v57
    v_exp_f32 v60, v60
    v_cvt_pk_bf16_f32 v119, v58, v59
    v_exp_f32 v61, v61
    v_exp_f32 v62, v62
    s_waitcnt lgkmcnt(0)
    v_mfma_f32_32x32x16_bf16 v[84:99], v[144:147], v[116:119], v[84:99]
    s_setprio 2
    v_exp_f32 v63, v63
    v_cvt_pk_bf16_f32 v120, v60, v61
    v_exp_f32 v64, v64
    v_cvt_pk_bf16_f32 v121, v62, v63
    v_exp_f32 v65, v65
    v_exp_f32 v66, v66
    v_mfma_f32_32x32x16_bf16 v[20:35], v[136:139], v[124:127], v[20:35]
    v_exp_f32 v67, v67
    v_cvt_pk_bf16_f32 v122, v64, v65
    v_exp_f32 v68, v68
    v_cvt_pk_bf16_f32 v123, v66, v67
    v_exp_f32 v69, v69
    v_exp_f32 v70, v70
    v_mfma_f32_32x32x16_bf16 v[84:99], v[152:155], v[120:123], v[84:99]
    v_exp_f32 v71, v71
    v_cvt_pk_bf16_f32 v116, v68, v69
    v_exp_f32 v72, v72
    v_cvt_pk_bf16_f32 v117, v70, v71
    v_exp_f32 v73, v73
    v_exp_f32 v74, v74
    v_mfma_f32_32x32x16_bf16 v[36:51], v[136:139], v[128:131], v[36:51]
    ds_read_b128 v[136:139], v7 offset:13824
    ds_read_b64 v[140:141], v8 offset:13824
    v_exp_f32 v75, v75
    v_cvt_pk_bf16_f32 v118, v72, v73
    v_exp_f32 v76, v76
    v_cvt_pk_bf16_f32 v119, v74, v75
    v_exp_f32 v77, v77
    v_exp_f32 v78, v78
    v_mfma_f32_32x32x16_bf16 v[100:115], v[144:147], v[116:119], v[100:115]
    v_exp_f32 v79, v79
    v_cvt_pk_bf16_f32 v120, v76, v77
    v_exp_f32 v80, v80
    v_cvt_pk_bf16_f32 v121, v78, v79
    v_exp_f32 v81, v81
    v_exp_f32 v82, v82
    v_exp_f32 v83, v83
    v_cvt_pk_bf16_f32 v122, v80, v81
    ds_read_b128 v[144:147], v9 offset:14976
    v_cvt_pk_bf16_f32 v123, v82, v83
    ds_read_b128 v[148:151], v9 offset:15648
    s_nop 0
    v_mfma_f32_32x32x16_bf16 v[100:115], v[152:155], v[120:123], v[100:115]
    v_exp_f32 v20, v20
    v_exp_f32 v21, v21
    v_exp_f32 v22, v22
    v_exp_f32 v23, v23
    s_waitcnt lgkmcnt(2)
    v_mfma_f32_32x32x4_2b_bf16 v[52:83], v[140:141], v[132:133], 0
    s_setprio 1
    v_exp_f32 v24, v24
    v_cvt_pk_bf16_f32 v116, v20, v21
    v_exp_f32 v25, v25
    v_cvt_pk_bf16_f32 v117, v22, v23
    v_exp_f32 v26, v26
    v_exp_f32 v27, v27
    v_cvt_pk_bf16_f32 v118, v24, v25
    v_exp_f32 v28, v28
    v_cvt_pk_bf16_f32 v119, v26, v27
    v_exp_f32 v29, v29
    v_exp_f32 v30, v30
    s_waitcnt lgkmcnt(0)
    v_mfma_f32_32x32x16_bf16 v[84:99], v[144:147], v[116:119], v[84:99]
    v_exp_f32 v31, v31
    v_cvt_pk_bf16_f32 v120, v28, v29
    v_exp_f32 v32, v32
    v_cvt_pk_bf16_f32 v121, v30, v31
    v_exp_f32 v33, v33
    v_exp_f32 v34, v34
    v_mfma_f32_32x32x16_bf16 v[52:67], v[136:139], v[124:127], v[52:67]
    v_exp_f32 v35, v35
    v_cvt_pk_bf16_f32 v122, v32, v33
    v_exp_f32 v36, v36
    v_cvt_pk_bf16_f32 v123, v34, v35
    v_exp_f32 v37, v37
    v_exp_f32 v38, v38
    v_mfma_f32_32x32x16_bf16 v[84:99], v[148:151], v[120:123], v[84:99]
    s_setprio 0
    v_exp_f32 v39, v39
    v_cvt_pk_bf16_f32 v116, v36, v37
    v_exp_f32 v40, v40
    v_cvt_pk_bf16_f32 v117, v38, v39
    v_exp_f32 v41, v41
    v_exp_f32 v42, v42
    v_mfma_f32_32x32x16_bf16 v[68:83], v[136:139], v[128:131], v[68:83]
    s_waitcnt vmcnt(4)
    s_barrier
    s_setprio 3
    ds_read_b128 v[136:139], v7 offset:24576
    ds_read_b64 v[140:141], v8 offset:24576
    v_exp_f32 v43, v43
    s_add_u32 m0, s50, 0
    v_cvt_pk_bf16_f32 v118, v40, v41
    v_exp_f32 v44, v44
    s_nop 0
    v_cvt_pk_bf16_f32 v119, v42, v43
    v_exp_f32 v45, v45
    buffer_load_dwordx4 v216, s[8:11], 0 offen sc1 lds
    v_exp_f32 v46, v46
    s_add_u32 m0, m0, s51
    v_mfma_f32_32x32x16_bf16 v[100:115], v[144:147], v[116:119], v[100:115]
    v_exp_f32 v47, v47
    v_add_u32 v216, v216, v219
    v_cvt_pk_bf16_f32 v120, v44, v45
    v_exp_f32 v48, v48
    buffer_load_dwordx4 v217, s[8:11], 0 offen sc1 lds
    v_cvt_pk_bf16_f32 v121, v46, v47
    v_exp_f32 v49, v49
    s_add_u32 m0, m0, s51
    v_exp_f32 v50, v50
    v_add_u32 v217, v217, v220
    v_exp_f32 v51, v51
    buffer_load_dwordx4 v218, s[8:11], 0 offen sc1 lds
    v_cvt_pk_bf16_f32 v122, v48, v49
    ds_read_b128 v[144:147], v9 offset:16320
    v_cvt_pk_bf16_f32 v123, v50, v51
    ds_read_b128 v[152:155], v9 offset:16992
    s_nop 0
    v_mfma_f32_32x32x16_bf16 v[100:115], v[148:151], v[120:123], v[100:115]
    v_exp_f32 v52, v52
    v_add_u32 v218, v218, v221
    v_exp_f32 v53, v53
    v_exp_f32 v54, v54
    v_exp_f32 v55, v55
    s_waitcnt lgkmcnt(2)
    v_mfma_f32_32x32x4_2b_bf16 v[20:51], v[140:141], v[132:133], 0
    v_exp_f32 v56, v56
    v_cvt_pk_bf16_f32 v116, v52, v53
    v_exp_f32 v57, v57
    v_cvt_pk_bf16_f32 v117, v54, v55
    v_exp_f32 v58, v58
    v_exp_f32 v59, v59
    v_cvt_pk_bf16_f32 v118, v56, v57
    v_exp_f32 v60, v60
    v_cvt_pk_bf16_f32 v119, v58, v59
    v_exp_f32 v61, v61
    v_exp_f32 v62, v62
    s_waitcnt lgkmcnt(0)
    v_mfma_f32_32x32x16_bf16 v[84:99], v[144:147], v[116:119], v[84:99]
    v_exp_f32 v63, v63
    v_cvt_pk_bf16_f32 v120, v60, v61
    v_exp_f32 v64, v64
    v_cvt_pk_bf16_f32 v121, v62, v63
    v_exp_f32 v65, v65
    v_exp_f32 v66, v66
    v_mfma_f32_32x32x16_bf16 v[20:35], v[136:139], v[124:127], v[20:35]
    v_exp_f32 v67, v67
    v_cvt_pk_bf16_f32 v122, v64, v65
    v_exp_f32 v68, v68
    v_cvt_pk_bf16_f32 v123, v66, v67
    v_exp_f32 v69, v69
    v_exp_f32 v70, v70
    v_mfma_f32_32x32x16_bf16 v[84:99], v[152:155], v[120:123], v[84:99]
    v_exp_f32 v71, v71
    v_cvt_pk_bf16_f32 v116, v68, v69
    v_exp_f32 v72, v72
    v_cvt_pk_bf16_f32 v117, v70, v71
    v_exp_f32 v73, v73
    v_exp_f32 v74, v74
    v_mfma_f32_32x32x16_bf16 v[36:51], v[136:139], v[128:131], v[36:51]
    ds_read_b128 v[136:139], v7 offset:25088
    ds_read_b64 v[140:141], v8 offset:25088
    v_exp_f32 v75, v75
    v_cvt_pk_bf16_f32 v118, v72, v73
    v_exp_f32 v76, v76
    v_cvt_pk_bf16_f32 v119, v74, v75
    v_exp_f32 v77, v77
    v_exp_f32 v78, v78
    v_mfma_f32_32x32x16_bf16 v[100:115], v[144:147], v[116:119], v[100:115]
    v_exp_f32 v79, v79
    v_cvt_pk_bf16_f32 v120, v76, v77
    v_exp_f32 v80, v80
    v_cvt_pk_bf16_f32 v121, v78, v79
    v_exp_f32 v81, v81
    v_exp_f32 v82, v82
    v_exp_f32 v83, v83
    v_cvt_pk_bf16_f32 v122, v80, v81
    ds_read_b128 v[144:147], v9 offset:24576
    v_cvt_pk_bf16_f32 v123, v82, v83
    ds_read_b128 v[148:151], v9 offset:25248
    s_nop 0
    v_mfma_f32_32x32x16_bf16 v[100:115], v[152:155], v[120:123], v[100:115]
    v_exp_f32 v20, v20
    v_exp_f32 v21, v21
    v_exp_f32 v22, v22
    v_exp_f32 v23, v23
    s_waitcnt lgkmcnt(2)
    v_mfma_f32_32x32x4_2b_bf16 v[52:83], v[140:141], v[132:133], 0
    v_exp_f32 v24, v24
    v_cvt_pk_bf16_f32 v116, v20, v21
    v_exp_f32 v25, v25
    v_cvt_pk_bf16_f32 v117, v22, v23
    v_exp_f32 v26, v26
    v_exp_f32 v27, v27
    v_cvt_pk_bf16_f32 v118, v24, v25
    v_exp_f32 v28, v28
    v_cvt_pk_bf16_f32 v119, v26, v27
    v_exp_f32 v29, v29
    v_exp_f32 v30, v30
    s_waitcnt lgkmcnt(0)
    v_mfma_f32_32x32x16_bf16 v[84:99], v[144:147], v[116:119], v[84:99]
    v_exp_f32 v31, v31
    v_cvt_pk_bf16_f32 v120, v28, v29
    v_exp_f32 v32, v32
    v_cvt_pk_bf16_f32 v121, v30, v31
    v_exp_f32 v33, v33
    v_exp_f32 v34, v34
    v_mfma_f32_32x32x16_bf16 v[52:67], v[136:139], v[124:127], v[52:67]
    v_exp_f32 v35, v35
    v_cvt_pk_bf16_f32 v122, v32, v33
    v_exp_f32 v36, v36
    v_cvt_pk_bf16_f32 v123, v34, v35
    v_exp_f32 v37, v37
    v_exp_f32 v38, v38
    v_mfma_f32_32x32x16_bf16 v[84:99], v[148:151], v[120:123], v[84:99]
    v_exp_f32 v39, v39
    v_cvt_pk_bf16_f32 v116, v36, v37
    v_exp_f32 v40, v40
    v_cvt_pk_bf16_f32 v117, v38, v39
    v_exp_f32 v41, v41
    v_exp_f32 v42, v42
    v_mfma_f32_32x32x16_bf16 v[68:83], v[136:139], v[128:131], v[68:83]
    ds_read_b128 v[136:139], v7 offset:25600
    ds_read_b64 v[140:141], v8 offset:25600
    v_exp_f32 v43, v43
    v_cvt_pk_bf16_f32 v118, v40, v41
    v_exp_f32 v44, v44
    v_cvt_pk_bf16_f32 v119, v42, v43
    v_exp_f32 v45, v45
    v_exp_f32 v46, v46
    v_mfma_f32_32x32x16_bf16 v[100:115], v[144:147], v[116:119], v[100:115]
    v_exp_f32 v47, v47
    v_cvt_pk_bf16_f32 v120, v44, v45
    v_exp_f32 v48, v48
    v_cvt_pk_bf16_f32 v121, v46, v47
    v_exp_f32 v49, v49
    v_exp_f32 v50, v50
    v_exp_f32 v51, v51
    v_cvt_pk_bf16_f32 v122, v48, v49
    ds_read_b128 v[144:147], v9 offset:25920
    v_cvt_pk_bf16_f32 v123, v50, v51
    ds_read_b128 v[152:155], v9 offset:26592
    s_nop 0
    v_mfma_f32_32x32x16_bf16 v[100:115], v[148:151], v[120:123], v[100:115]
    v_exp_f32 v52, v52
    v_exp_f32 v53, v53
    v_exp_f32 v54, v54
    v_exp_f32 v55, v55
    s_waitcnt lgkmcnt(2)
    v_mfma_f32_32x32x4_2b_bf16 v[20:51], v[140:141], v[132:133], 0
    v_exp_f32 v56, v56
    v_cvt_pk_bf16_f32 v116, v52, v53
    v_exp_f32 v57, v57
    v_cvt_pk_bf16_f32 v117, v54, v55
    v_exp_f32 v58, v58
    v_exp_f32 v59, v59
    v_cvt_pk_bf16_f32 v118, v56, v57
    v_exp_f32 v60, v60
    v_cvt_pk_bf16_f32 v119, v58, v59
    v_exp_f32 v61, v61
    v_exp_f32 v62, v62
    s_waitcnt lgkmcnt(0)
    v_mfma_f32_32x32x16_bf16 v[84:99], v[144:147], v[116:119], v[84:99]
    s_setprio 2
    v_exp_f32 v63, v63
    v_cvt_pk_bf16_f32 v120, v60, v61
    v_exp_f32 v64, v64
    v_cvt_pk_bf16_f32 v121, v62, v63
    v_exp_f32 v65, v65
    v_exp_f32 v66, v66
    v_mfma_f32_32x32x16_bf16 v[20:35], v[136:139], v[124:127], v[20:35]
    v_exp_f32 v67, v67
    v_cvt_pk_bf16_f32 v122, v64, v65
    v_exp_f32 v68, v68
    v_cvt_pk_bf16_f32 v123, v66, v67
    v_exp_f32 v69, v69
    v_exp_f32 v70, v70
    v_mfma_f32_32x32x16_bf16 v[84:99], v[152:155], v[120:123], v[84:99]
    v_exp_f32 v71, v71
    v_cvt_pk_bf16_f32 v116, v68, v69
    v_exp_f32 v72, v72
    v_cvt_pk_bf16_f32 v117, v70, v71
    v_exp_f32 v73, v73
    v_exp_f32 v74, v74
    v_mfma_f32_32x32x16_bf16 v[36:51], v[136:139], v[128:131], v[36:51]
    ds_read_b128 v[136:139], v7 offset:26112
    ds_read_b64 v[140:141], v8 offset:26112
    v_exp_f32 v75, v75
    v_cvt_pk_bf16_f32 v118, v72, v73
    v_exp_f32 v76, v76
    v_cvt_pk_bf16_f32 v119, v74, v75
    v_exp_f32 v77, v77
    v_exp_f32 v78, v78
    v_mfma_f32_32x32x16_bf16 v[100:115], v[144:147], v[116:119], v[100:115]
    v_exp_f32 v79, v79
    v_cvt_pk_bf16_f32 v120, v76, v77
    v_exp_f32 v80, v80
    v_cvt_pk_bf16_f32 v121, v78, v79
    v_exp_f32 v81, v81
    v_exp_f32 v82, v82
    v_exp_f32 v83, v83
    v_cvt_pk_bf16_f32 v122, v80, v81
    ds_read_b128 v[144:147], v9 offset:27264
    v_cvt_pk_bf16_f32 v123, v82, v83
    ds_read_b128 v[148:151], v9 offset:27936
    s_nop 0
    v_mfma_f32_32x32x16_bf16 v[100:115], v[152:155], v[120:123], v[100:115]
    v_exp_f32 v20, v20
    v_exp_f32 v21, v21
    v_exp_f32 v22, v22
    v_exp_f32 v23, v23
    s_waitcnt lgkmcnt(2)
    v_mfma_f32_32x32x4_2b_bf16 v[52:83], v[140:141], v[132:133], 0
    s_setprio 1
    v_exp_f32 v24, v24
    v_cvt_pk_bf16_f32 v116, v20, v21
    v_exp_f32 v25, v25
    v_cvt_pk_bf16_f32 v117, v22, v23
    v_exp_f32 v26, v26
    v_exp_f32 v27, v27
    v_cvt_pk_bf16_f32 v118, v24, v25
    v_exp_f32 v28, v28
    v_cvt_pk_bf16_f32 v119, v26, v27
    v_exp_f32 v29, v29
    v_exp_f32 v30, v30
    s_waitcnt lgkmcnt(0)
    v_mfma_f32_32x32x16_bf16 v[84:99], v[144:147], v[116:119], v[84:99]
    v_exp_f32 v31, v31
    v_cvt_pk_bf16_f32 v120, v28, v29
    v_exp_f32 v32, v32
    v_cvt_pk_bf16_f32 v121, v30, v31
    v_exp_f32 v33, v33
    v_exp_f32 v34, v34
    v_mfma_f32_32x32x16_bf16 v[52:67], v[136:139], v[124:127], v[52:67]
    v_exp_f32 v35, v35
    v_cvt_pk_bf16_f32 v122, v32, v33
    v_exp_f32 v36, v36
    v_cvt_pk_bf16_f32 v123, v34, v35
    v_exp_f32 v37, v37
    v_exp_f32 v38, v38
    v_mfma_f32_32x32x16_bf16 v[84:99], v[148:151], v[120:123], v[84:99]
    s_setprio 0
    v_exp_f32 v39, v39
    v_cvt_pk_bf16_f32 v116, v36, v37
    v_exp_f32 v40, v40
    v_cvt_pk_bf16_f32 v117, v38, v39
    v_exp_f32 v41, v41
    v_exp_f32 v42, v42
    v_mfma_f32_32x32x16_bf16 v[68:83], v[136:139], v[128:131], v[68:83]
    s_waitcnt vmcnt(0)
    s_barrier
    s_setprio 3
    ds_read_b128 v[136:139], v7 offset:0
    ds_read_b64 v[140:141], v8 offset:0
    v_exp_f32 v43, v43
    s_add_u32 m0, s50, 12288
    v_cvt_pk_bf16_f32 v118, v40, v41
    v_exp_f32 v44, v44
    s_nop 0
    v_cvt_pk_bf16_f32 v119, v42, v43
    v_exp_f32 v45, v45
    buffer_load_dwordx4 v216, s[8:11], 0 offen sc1 lds
    v_exp_f32 v46, v46
    s_add_u32 m0, m0, s51
    v_mfma_f32_32x32x16_bf16 v[100:115], v[144:147], v[116:119], v[100:115]
    v_exp_f32 v47, v47
    v_add_u32 v216, v216, v219
    v_cvt_pk_bf16_f32 v120, v44, v45
    v_exp_f32 v48, v48
    buffer_load_dwordx4 v217, s[8:11], 0 offen sc1 lds
    v_cvt_pk_bf16_f32 v121, v46, v47
    v_exp_f32 v49, v49
    s_add_u32 m0, m0, s51
    v_exp_f32 v50, v50
    v_add_u32 v217, v217, v220
    v_exp_f32 v51, v51
    buffer_load_dwordx4 v218, s[8:11], 0 offen sc1 lds
    v_cvt_pk_bf16_f32 v122, v48, v49
    ds_read_b128 v[144:147], v9 offset:28608
    v_cvt_pk_bf16_f32 v123, v50, v51
    ds_read_b128 v[152:155], v9 offset:29280
    s_nop 0
    v_mfma_f32_32x32x16_bf16 v[100:115], v[148:151], v[120:123], v[100:115]
    v_exp_f32 v52, v52
    v_add_u32 v218, v218, v221
    v_exp_f32 v53, v53
    v_exp_f32 v54, v54
    v_exp_f32 v55, v55
    s_waitcnt lgkmcnt(2)
    v_mfma_f32_32x32x4_2b_bf16 v[20:51], v[140:141], v[132:133], 0
    v_exp_f32 v56, v56
    v_cvt_pk_bf16_f32 v116, v52, v53
    v_exp_f32 v57, v57
    v_cvt_pk_bf16_f32 v117, v54, v55
    v_exp_f32 v58, v58
    v_exp_f32 v59, v59
    v_cvt_pk_bf16_f32 v118, v56, v57
    v_exp_f32 v60, v60
    v_cvt_pk_bf16_f32 v119, v58, v59
    v_exp_f32 v61, v61
    v_exp_f32 v62, v62
    s_waitcnt lgkmcnt(0)
    v_mfma_f32_32x32x16_bf16 v[84:99], v[144:147], v[116:119], v[84:99]
    v_exp_f32 v63, v63
    v_cvt_pk_bf16_f32 v120, v60, v61
    v_exp_f32 v64, v64
    v_cvt_pk_bf16_f32 v121, v62, v63
    v_exp_f32 v65, v65
    v_exp_f32 v66, v66
    v_mfma_f32_32x32x16_bf16 v[20:35], v[136:139], v[124:127], v[20:35]
    v_exp_f32 v67, v67
    v_cvt_pk_bf16_f32 v122, v64, v65
    v_exp_f32 v68, v68
    v_cvt_pk_bf16_f32 v123, v66, v67
    v_exp_f32 v69, v69
    v_exp_f32 v70, v70
    v_mfma_f32_32x32x16_bf16 v[84:99], v[152:155], v[120:123], v[84:99]
    v_exp_f32 v71, v71
    v_cvt_pk_bf16_f32 v116, v68, v69
    v_exp_f32 v72, v72
    v_cvt_pk_bf16_f32 v117, v70, v71
    v_exp_f32 v73, v73
    v_exp_f32 v74, v74
    v_mfma_f32_32x32x16_bf16 v[36:51], v[136:139], v[128:131], v[36:51]
    ds_read_b128 v[136:139], v7 offset:512
    ds_read_b64 v[140:141], v8 offset:512
    ds_read_b64_tr_b16 v[156:157], v3 offset:0
    ds_read_b64_tr_b16 v[158:159], v3 offset:1024
    ds_read_b64_tr_b16 v[160:161], v3 offset:32
    ds_read_b64_tr_b16 v[162:163], v3 offset:1056
    ds_read_b64_tr_b16 v[164:165], v3 offset:64
    ds_read_b64_tr_b16 v[166:167], v3 offset:1088
    ds_read_b64_tr_b16 v[168:169], v3 offset:96
    ds_read_b64_tr_b16 v[170:171], v3 offset:1120
    v_exp_f32 v75, v75
    v_cvt_pk_bf16_f32 v118, v72, v73
    v_exp_f32 v76, v76
    v_cvt_pk_bf16_f32 v119, v74, v75
    v_exp_f32 v77, v77
    v_exp_f32 v78, v78
    v_mfma_f32_32x32x16_bf16 v[100:115], v[144:147], v[116:119], v[100:115]
    v_exp_f32 v79, v79
    v_cvt_pk_bf16_f32 v120, v76, v77
    v_exp_f32 v80, v80
    v_cvt_pk_bf16_f32 v121, v78, v79
    v_exp_f32 v81, v81
    v_exp_f32 v82, v82
    v_exp_f32 v83, v83
    v_cvt_pk_bf16_f32 v122, v80, v81
    ds_read_b128 v[144:147], v9 offset:0
    v_cvt_pk_bf16_f32 v123, v82, v83
    ds_read_b128 v[148:151], v9 offset:672
    s_nop 0
    v_mfma_f32_32x32x16_bf16 v[100:115], v[152:155], v[120:123], v[100:115]
    v_exp_f32 v20, v20
    v_exp_f32 v21, v21
    v_exp_f32 v22, v22
    v_exp_f32 v23, v23
    s_waitcnt lgkmcnt(2)
    v_mfma_f32_32x32x4_2b_bf16 v[52:83], v[140:141], v[132:133], 0
    v_exp_f32 v24, v24
    v_cvt_pk_bf16_f32 v116, v20, v21
    v_exp_f32 v25, v25
    v_cvt_pk_bf16_f32 v117, v22, v23
    v_exp_f32 v26, v26
    v_exp_f32 v27, v27
    v_cvt_pk_bf16_f32 v118, v24, v25
    v_exp_f32 v28, v28
    v_cvt_pk_bf16_f32 v119, v26, v27
    v_exp_f32 v29, v29
    v_exp_f32 v30, v30
    s_waitcnt lgkmcnt(0)
    v_mfma_f32_32x32x16_bf16 v[84:99], v[144:147], v[116:119], v[84:99]
    v_exp_f32 v31, v31
    v_cvt_pk_bf16_f32 v120, v28, v29
    v_exp_f32 v32, v32
    v_cvt_pk_bf16_f32 v121, v30, v31
    v_exp_f32 v33, v33
    v_exp_f32 v34, v34
    v_mfma_f32_32x32x16_bf16 v[52:67], v[136:139], v[124:127], v[52:67]
    v_exp_f32 v35, v35
    v_cvt_pk_bf16_f32 v122, v32, v33
    v_exp_f32 v36, v36
    v_cvt_pk_bf16_f32 v123, v34, v35
    v_exp_f32 v37, v37
    v_exp_f32 v38, v38
    v_mfma_f32_32x32x16_bf16 v[84:99], v[148:151], v[120:123], v[84:99]
    v_exp_f32 v39, v39
    v_cvt_pk_bf16_f32 v116, v36, v37
    v_exp_f32 v40, v40
    v_cvt_pk_bf16_f32 v117, v38, v39
    v_exp_f32 v41, v41
    v_exp_f32 v42, v42
    v_mfma_f32_32x32x16_bf16 v[68:83], v[136:139], v[128:131], v[68:83]
    ds_read_b128 v[136:139], v7 offset:1024
    ds_read_b64 v[140:141], v8 offset:1024
    v_mfma_f32_32x32x16_bf16 v[172:187], v[188:191], v[156:159], 0
    v_exp_f32 v43, v43
    v_cvt_pk_bf16_f32 v118, v40, v41
    v_exp_f32 v44, v44
    v_cvt_pk_bf16_f32 v119, v42, v43
    v_exp_f32 v45, v45
    v_mfma_f32_32x32x16_bf16 v[172:187], v[192:195], v[160:163], v[172:187]
    v_exp_f32 v46, v46
    buffer_store_dwordx4 v[156:159], v2, s[8:11], s20 offen offset:0 sc1
    v_mfma_f32_32x32x16_bf16 v[100:115], v[144:147], v[116:119], v[100:115]
    v_exp_f32 v47, v47
    buffer_store_dwordx4 v[160:163], v2, s[8:11], s20 offen offset:1024 sc1
    v_cvt_pk_bf16_f32 v120, v44, v45
    v_exp_f32 v48, v48
    v_cvt_pk_bf16_f32 v121, v46, v47
    v_exp_f32 v49, v49
    v_exp_f32 v50, v50
    v_exp_f32 v51, v51
    v_cvt_pk_bf16_f32 v122, v48, v49
    ds_read_b128 v[144:147], v9 offset:1344
    v_cvt_pk_bf16_f32 v123, v50, v51
    ds_read_b128 v[152:155], v9 offset:2016
    s_nop 0
    v_mfma_f32_32x32x16_bf16 v[100:115], v[148:151], v[120:123], v[100:115]
    v_exp_f32 v52, v52
    v_exp_f32 v53, v53
    v_exp_f32 v54, v54
    v_exp_f32 v55, v55
    s_waitcnt lgkmcnt(2)
    v_mfma_f32_32x32x4_2b_bf16 v[20:51], v[140:141], v[132:133], 0
    v_exp_f32 v56, v56
    v_cvt_pk_bf16_f32 v116, v52, v53
    v_exp_f32 v57, v57
    v_cvt_pk_bf16_f32 v117, v54, v55
    v_exp_f32 v58, v58
    v_exp_f32 v59, v59
    v_cvt_pk_bf16_f32 v118, v56, v57
    v_exp_f32 v60, v60
    v_cvt_pk_bf16_f32 v119, v58, v59
    v_exp_f32 v61, v61
    v_exp_f32 v62, v62
    s_waitcnt lgkmcnt(0)
    v_mfma_f32_32x32x16_bf16 v[84:99], v[144:147], v[116:119], v[84:99]
    s_setprio 2
    v_exp_f32 v63, v63
    v_cvt_pk_bf16_f32 v120, v60, v61
    v_exp_f32 v64, v64
    v_cvt_pk_bf16_f32 v121, v62, v63
    v_exp_f32 v65, v65
    v_exp_f32 v66, v66
    v_mfma_f32_32x32x16_bf16 v[20:35], v[136:139], v[124:127], v[20:35]
    v_exp_f32 v67, v67
    v_cvt_pk_bf16_f32 v122, v64, v65
    v_exp_f32 v68, v68
    v_cvt_pk_bf16_f32 v123, v66, v67
    v_exp_f32 v69, v69
    v_exp_f32 v70, v70
    v_mfma_f32_32x32x16_bf16 v[84:99], v[152:155], v[120:123], v[84:99]
    v_exp_f32 v71, v71
    v_cvt_pk_bf16_f32 v116, v68, v69
    v_exp_f32 v72, v72
    v_cvt_pk_bf16_f32 v117, v70, v71
    v_exp_f32 v73, v73
    v_exp_f32 v74, v74
    v_mfma_f32_32x32x16_bf16 v[36:51], v[136:139], v[128:131], v[36:51]
    ds_read_b128 v[136:139], v7 offset:1536
    ds_read_b64 v[140:141], v8 offset:1536
    v_mfma_f32_32x32x16_bf16 v[172:187], v[196:199], v[164:167], v[172:187]
    v_exp_f32 v75, v75
    v_cvt_pk_bf16_f32 v118, v72, v73
    v_exp_f32 v76, v76
    v_cvt_pk_bf16_f32 v119, v74, v75
    v_exp_f32 v77, v77
    v_mfma_f32_32x32x16_bf16 v[172:187], v[200:203], v[168:171], v[172:187]
    v_exp_f32 v78, v78
    buffer_store_dwordx4 v[164:167], v2, s[8:11], s20 offen offset:2048 sc1
    v_mfma_f32_32x32x16_bf16 v[100:115], v[144:147], v[116:119], v[100:115]
    v_exp_f32 v79, v79
    buffer_store_dwordx4 v[168:171], v2, s[8:11], s20 offen offset:3072 sc1
    v_cvt_pk_bf16_f32 v120, v76, v77
    v_exp_f32 v80, v80
    v_cvt_pk_bf16_f32 v121, v78, v79
    v_exp_f32 v81, v81
    v_exp_f32 v82, v82
    v_exp_f32 v83, v83
    v_cvt_pk_bf16_f32 v122, v80, v81
    ds_read_b128 v[144:147], v9 offset:2688
    v_cvt_pk_bf16_f32 v123, v82, v83
    ds_read_b128 v[148:151], v9 offset:3360
    s_nop 0
    v_mfma_f32_32x32x16_bf16 v[100:115], v[152:155], v[120:123], v[100:115]
    v_exp_f32 v20, v20
    v_exp_f32 v21, v21
    v_exp_f32 v22, v22
    v_exp_f32 v23, v23
    s_waitcnt lgkmcnt(2)
    v_mfma_f32_32x32x4_2b_bf16 v[52:83], v[140:141], v[132:133], 0
    s_setprio 1
    v_exp_f32 v24, v24
    v_cvt_pk_bf16_f32 v116, v20, v21
    v_exp_f32 v25, v25
    v_cvt_pk_bf16_f32 v117, v22, v23
    v_exp_f32 v26, v26
    v_exp_f32 v27, v27
    v_cvt_pk_bf16_f32 v118, v24, v25
    v_exp_f32 v28, v28
    v_cvt_pk_bf16_f32 v119, v26, v27
    v_exp_f32 v29, v29
    v_exp_f32 v30, v30
    s_waitcnt lgkmcnt(0)
    v_mfma_f32_32x32x16_bf16 v[84:99], v[144:147], v[116:119], v[84:99]
    v_exp_f32 v31, v31
    v_cvt_pk_bf16_f32 v120, v28, v29
    v_exp_f32 v32, v32
    v_cvt_pk_bf16_f32 v121, v30, v31
    v_exp_f32 v33, v33
    v_exp_f32 v34, v34
    v_mfma_f32_32x32x16_bf16 v[52:67], v[136:139], v[124:127], v[52:67]
    v_exp_f32 v35, v35
    v_cvt_pk_bf16_f32 v122, v32, v33
    v_exp_f32 v36, v36
    v_cvt_pk_bf16_f32 v123, v34, v35
    v_exp_f32 v37, v37
    v_exp_f32 v38, v38
    v_mfma_f32_32x32x16_bf16 v[84:99], v[148:151], v[120:123], v[84:99]
    s_setprio 0
    v_exp_f32 v39, v39
    v_cvt_pk_bf16_f32 v116, v36, v37
    v_exp_f32 v40, v40
    v_cvt_pk_bf16_f32 v117, v38, v39
    v_exp_f32 v41, v41
    v_exp_f32 v42, v42
    v_mfma_f32_32x32x16_bf16 v[68:83], v[136:139], v[128:131], v[68:83]
    s_waitcnt vmcnt(4)
    s_barrier
    s_setprio 3
    ds_read_b128 v[136:139], v7 offset:12288
    ds_read_b64 v[140:141], v8 offset:12288
    v_exp_f32 v43, v43
    s_add_u32 m0, s50, 24576
    v_cvt_pk_bf16_f32 v118, v40, v41
    v_exp_f32 v44, v44
    s_nop 0
    v_cvt_pk_bf16_f32 v119, v42, v43
    v_exp_f32 v45, v45
    buffer_load_dwordx4 v216, s[8:11], 0 offen sc1 lds
    v_exp_f32 v46, v46
    s_add_u32 m0, m0, s51
    v_mfma_f32_32x32x16_bf16 v[100:115], v[144:147], v[116:119], v[100:115]
    v_exp_f32 v47, v47
    v_add_u32 v216, v216, v219
    v_cvt_pk_bf16_f32 v120, v44, v45
    v_exp_f32 v48, v48
    buffer_load_dwordx4 v217, s[8:11], 0 offen sc1 lds
    v_cvt_pk_bf16_f32 v121, v46, v47
    v_exp_f32 v49, v49
    s_add_u32 m0, m0, s51
    v_exp_f32 v50, v50
    v_add_u32 v217, v217, v220
    v_exp_f32 v51, v51
    buffer_load_dwordx4 v218, s[8:11], 0 offen sc1 lds
    v_cvt_pk_bf16_f32 v122, v48, v49
    ds_read_b128 v[144:147], v9 offset:4032
    v_cvt_pk_bf16_f32 v123, v50, v51
    ds_read_b128 v[152:155], v9 offset:4704
    s_nop 0
    v_mfma_f32_32x32x16_bf16 v[100:115], v[148:151], v[120:123], v[100:115]
    v_exp_f32 v52, v52
    v_add_u32 v218, v218, v221
    v_exp_f32 v53, v53
    v_exp_f32 v54, v54
    buffer_atomic_add_f32 v172, v204, s[8:11], s21 offen
    v_exp_f32 v55, v55
    buffer_atomic_add_f32 v173, v204, s[8:11], s21 offen offset:256
    s_waitcnt lgkmcnt(2)
    v_mfma_f32_32x32x4_2b_bf16 v[20:51], v[140:141], v[132:133], 0
    v_exp_f32 v56, v56
    v_cvt_pk_bf16_f32 v116, v52, v53
    v_exp_f32 v57, v57
    v_cvt_pk_bf16_f32 v117, v54, v55
    v_exp_f32 v58, v58
    v_exp_f32 v59, v59
    v_cvt_pk_bf16_f32 v118, v56, v57
    v_exp_f32 v60, v60
    v_cvt_pk_bf16_f32 v119, v58, v59
    v_exp_f32 v61, v61
    v_exp_f32 v62, v62
    s_waitcnt lgkmcnt(0)
    v_mfma_f32_32x32x16_bf16 v[84:99], v[144:147], v[116:119], v[84:99]
    v_exp_f32 v63, v63
    v_cvt_pk_bf16_f32 v120, v60, v61
    v_exp_f32 v64, v64
    v_cvt_pk_bf16_f32 v121, v62, v63
    v_exp_f32 v65, v65
    v_exp_f32 v66, v66
    v_mfma_f32_32x32x16_bf16 v[20:35], v[136:139], v[124:127], v[20:35]
    v_exp_f32 v67, v67
    v_cvt_pk_bf16_f32 v122, v64, v65
    v_exp_f32 v68, v68
    v_cvt_pk_bf16_f32 v123, v66, v67
    v_exp_f32 v69, v69
    v_exp_f32 v70, v70
    v_mfma_f32_32x32x16_bf16 v[84:99], v[152:155], v[120:123], v[84:99]
    v_exp_f32 v71, v71
    v_cvt_pk_bf16_f32 v116, v68, v69
    v_exp_f32 v72, v72
    v_cvt_pk_bf16_f32 v117, v70, v71
    v_exp_f32 v73, v73
    v_exp_f32 v74, v74
    v_mfma_f32_32x32x16_bf16 v[36:51], v[136:139], v[128:131], v[36:51]
    ds_read_b128 v[136:139], v7 offset:12800
    ds_read_b64 v[140:141], v8 offset:12800
    v_exp_f32 v75, v75
    v_cvt_pk_bf16_f32 v118, v72, v73
    v_exp_f32 v76, v76
    v_cvt_pk_bf16_f32 v119, v74, v75
    v_exp_f32 v77, v77
    v_exp_f32 v78, v78
    v_mfma_f32_32x32x16_bf16 v[100:115], v[144:147], v[116:119], v[100:115]
    v_exp_f32 v79, v79
    v_cvt_pk_bf16_f32 v120, v76, v77
    v_exp_f32 v80, v80
    v_cvt_pk_bf16_f32 v121, v78, v79
    v_exp_f32 v81, v81
    v_exp_f32 v82, v82
    v_exp_f32 v83, v83
    v_cvt_pk_bf16_f32 v122, v80, v81
    ds_read_b128 v[144:147], v9 offset:12288
    v_cvt_pk_bf16_f32 v123, v82, v83
    ds_read_b128 v[148:151], v9 offset:12960
    s_nop 0
    v_mfma_f32_32x32x16_bf16 v[100:115], v[152:155], v[120:123], v[100:115]
    v_exp_f32 v20, v20
    v_exp_f32 v21, v21
    v_exp_f32 v22, v22
    v_exp_f32 v23, v23
    s_waitcnt lgkmcnt(2)
    v_mfma_f32_32x32x4_2b_bf16 v[52:83], v[140:141], v[132:133], 0
    v_exp_f32 v24, v24
    v_cvt_pk_bf16_f32 v116, v20, v21
    v_exp_f32 v25, v25
    v_cvt_pk_bf16_f32 v117, v22, v23
    v_exp_f32 v26, v26
    v_exp_f32 v27, v27
    v_cvt_pk_bf16_f32 v118, v24, v25
    v_exp_f32 v28, v28
    v_cvt_pk_bf16_f32 v119, v26, v27
    v_exp_f32 v29, v29
    v_exp_f32 v30, v30
    s_waitcnt lgkmcnt(0)
    v_mfma_f32_32x32x16_bf16 v[84:99], v[144:147], v[116:119], v[84:99]
    v_exp_f32 v31, v31
    v_cvt_pk_bf16_f32 v120, v28, v29
    v_exp_f32 v32, v32
    v_cvt_pk_bf16_f32 v121, v30, v31
    v_exp_f32 v33, v33
    v_exp_f32 v34, v34
    v_mfma_f32_32x32x16_bf16 v[52:67], v[136:139], v[124:127], v[52:67]
    v_exp_f32 v35, v35
    v_cvt_pk_bf16_f32 v122, v32, v33
    v_exp_f32 v36, v36
    v_cvt_pk_bf16_f32 v123, v34, v35
    v_exp_f32 v37, v37
    v_exp_f32 v38, v38
    v_mfma_f32_32x32x16_bf16 v[84:99], v[148:151], v[120:123], v[84:99]
    v_exp_f32 v39, v39
    v_cvt_pk_bf16_f32 v116, v36, v37
    v_exp_f32 v40, v40
    v_cvt_pk_bf16_f32 v117, v38, v39
    v_exp_f32 v41, v41
    v_exp_f32 v42, v42
    v_mfma_f32_32x32x16_bf16 v[68:83], v[136:139], v[128:131], v[68:83]
    ds_read_b128 v[136:139], v7 offset:13312
    ds_read_b64 v[140:141], v8 offset:13312
    v_exp_f32 v43, v43
    v_cvt_pk_bf16_f32 v118, v40, v41
    v_exp_f32 v44, v44
    v_cvt_pk_bf16_f32 v119, v42, v43
    v_exp_f32 v45, v45
    v_exp_f32 v46, v46
    v_mfma_f32_32x32x16_bf16 v[100:115], v[144:147], v[116:119], v[100:115]
    v_exp_f32 v47, v47
    v_cvt_pk_bf16_f32 v120, v44, v45
    v_exp_f32 v48, v48
    v_cvt_pk_bf16_f32 v121, v46, v47
    v_exp_f32 v49, v49
    v_exp_f32 v50, v50
    v_exp_f32 v51, v51
    v_cvt_pk_bf16_f32 v122, v48, v49
    ds_read_b128 v[144:147], v9 offset:13632
    v_cvt_pk_bf16_f32 v123, v50, v51
    ds_read_b128 v[152:155], v9 offset:14304
    s_nop 0
    v_mfma_f32_32x32x16_bf16 v[100:115], v[148:151], v[120:123], v[100:115]
    v_exp_f32 v52, v52
    v_exp_f32 v53, v53
    v_exp_f32 v54, v54
    v_exp_f32 v55, v55
    s_waitcnt lgkmcnt(2)
    v_mfma_f32_32x32x4_2b_bf16 v[20:51], v[140:141], v[132:133], 0
    v_exp_f32 v56, v56
    v_cvt_pk_bf16_f32 v116, v52, v53
    v_exp_f32 v57, v57
    v_cvt_pk_bf16_f32 v117, v54, v55
    v_exp_f32 v58, v58
    v_exp_f32 v59, v59
    v_cvt_pk_bf16_f32 v118, v56, v57
    v_exp_f32 v60, v60
    v_cvt_pk_bf16_f32 v119, v58, v59
    v_exp_f32 v61, v61
    v_exp_f32 v62, v62
    s_waitcnt lgkmcnt(0)
    v_mfma_f32_32x32x16_bf16 v[84:99], v[144:147], v[116:119], v[84:99]
    s_setprio 2
    v_exp_f32 v63, v63
    v_cvt_pk_bf16_f32 v120, v60, v61
    v_exp_f32 v64, v64
    v_cvt_pk_bf16_f32 v121, v62, v63
    v_exp_f32 v65, v65
    v_exp_f32 v66, v66
    v_mfma_f32_32x32x16_bf16 v[20:35], v[136:139], v[124:127], v[20:35]
    v_exp_f32 v67, v67
    v_cvt_pk_bf16_f32 v122, v64, v65
    v_exp_f32 v68, v68
    v_cvt_pk_bf16_f32 v123, v66, v67
    v_exp_f32 v69, v69
    v_exp_f32 v70, v70
    v_mfma_f32_32x32x16_bf16 v[84:99], v[152:155], v[120:123], v[84:99]
    v_exp_f32 v71, v71
    v_cvt_pk_bf16_f32 v116, v68, v69
    v_exp_f32 v72, v72
    v_cvt_pk_bf16_f32 v117, v70, v71
    v_exp_f32 v73, v73
    v_exp_f32 v74, v74
    v_mfma_f32_32x32x16_bf16 v[36:51], v[136:139], v[128:131], v[36:51]
    ds_read_b128 v[136:139], v7 offset:13824
    ds_read_b64 v[140:141], v8 offset:13824
    v_exp_f32 v75, v75
    v_cvt_pk_bf16_f32 v118, v72, v73
    v_exp_f32 v76, v76
    v_cvt_pk_bf16_f32 v119, v74, v75
    v_exp_f32 v77, v77
    v_exp_f32 v78, v78
    v_mfma_f32_32x32x16_bf16 v[100:115], v[144:147], v[116:119], v[100:115]
    v_exp_f32 v79, v79
    v_cvt_pk_bf16_f32 v120, v76, v77
    v_exp_f32 v80, v80
    v_cvt_pk_bf16_f32 v121, v78, v79
    v_exp_f32 v81, v81
    v_exp_f32 v82, v82
    v_exp_f32 v83, v83
    v_cvt_pk_bf16_f32 v122, v80, v81
    ds_read_b128 v[144:147], v9 offset:14976
    v_cvt_pk_bf16_f32 v123, v82, v83
    ds_read_b128 v[148:151], v9 offset:15648
    s_nop 0
    v_mfma_f32_32x32x16_bf16 v[100:115], v[152:155], v[120:123], v[100:115]
    v_exp_f32 v20, v20
    v_exp_f32 v21, v21
    v_exp_f32 v22, v22
    v_exp_f32 v23, v23
    s_waitcnt lgkmcnt(2)
    v_mfma_f32_32x32x4_2b_bf16 v[52:83], v[140:141], v[132:133], 0
    s_setprio 1
    v_exp_f32 v24, v24
    v_cvt_pk_bf16_f32 v116, v20, v21
    v_exp_f32 v25, v25
    v_cvt_pk_bf16_f32 v117, v22, v23
    v_exp_f32 v26, v26
    v_exp_f32 v27, v27
    v_cvt_pk_bf16_f32 v118, v24, v25
    v_exp_f32 v28, v28
    v_cvt_pk_bf16_f32 v119, v26, v27
    v_exp_f32 v29, v29
    v_exp_f32 v30, v30
    s_waitcnt lgkmcnt(0)
    v_mfma_f32_32x32x16_bf16 v[84:99], v[144:147], v[116:119], v[84:99]
    v_exp_f32 v31, v31
    v_cvt_pk_bf16_f32 v120, v28, v29
    v_exp_f32 v32, v32
    v_cvt_pk_bf16_f32 v121, v30, v31
    v_exp_f32 v33, v33
    v_exp_f32 v34, v34
    v_mfma_f32_32x32x16_bf16 v[52:67], v[136:139], v[124:127], v[52:67]
    v_exp_f32 v35, v35
    v_cvt_pk_bf16_f32 v122, v32, v33
    v_exp_f32 v36, v36
    v_cvt_pk_bf16_f32 v123, v34, v35
    v_exp_f32 v37, v37
    v_exp_f32 v38, v38
    v_mfma_f32_32x32x16_bf16 v[84:99], v[148:151], v[120:123], v[84:99]
    s_setprio 0
    v_exp_f32 v39, v39
    v_cvt_pk_bf16_f32 v116, v36, v37
    v_exp_f32 v40, v40
    v_cvt_pk_bf16_f32 v117, v38, v39
    v_exp_f32 v41, v41
    v_exp_f32 v42, v42
    v_mfma_f32_32x32x16_bf16 v[68:83], v[136:139], v[128:131], v[68:83]
    s_waitcnt vmcnt(0)
    s_barrier
    s_cmp_lg_u32 s12, 0
    s_cbranch_scc1 L_sequential_preLN__softmax_full_mha__swiglu_ffn__prompt_kernel_nf_29
    s_lshl_b32 s42, s2, 2
    s_add_u32 s42, s42, 13631488
    v_mov_b32 v14, 1
    v_mov_b32 v15, 0
    s_mov_b64 exec, 1
    buffer_store_dword v14, v15, s[8:11], s42 offen sc1
    s_mov_b64 exec, -1
L_sequential_preLN__softmax_full_mha__swiglu_ffn__prompt_kernel_nf_29:
    s_setprio 3
    ds_read_b128 v[136:139], v7 offset:24576
    ds_read_b64 v[140:141], v8 offset:24576
    v_exp_f32 v43, v43
    s_add_u32 m0, s50, 0
    v_cvt_pk_bf16_f32 v118, v40, v41
    v_exp_f32 v44, v44
    s_nop 0
    v_cvt_pk_bf16_f32 v119, v42, v43
    v_exp_f32 v45, v45
    buffer_load_dwordx4 v216, s[8:11], 0 offen sc1 lds
    v_exp_f32 v46, v46
    s_add_u32 m0, m0, s51
    v_mfma_f32_32x32x16_bf16 v[100:115], v[144:147], v[116:119], v[100:115]
    v_exp_f32 v47, v47
    v_add_u32 v216, v216, v219
    v_cvt_pk_bf16_f32 v120, v44, v45
    v_exp_f32 v48, v48
    buffer_load_dwordx4 v217, s[8:11], 0 offen sc1 lds
    v_cvt_pk_bf16_f32 v121, v46, v47
    v_exp_f32 v49, v49
    s_add_u32 m0, m0, s51
    v_exp_f32 v50, v50
    v_add_u32 v217, v217, v220
    v_exp_f32 v51, v51
    buffer_load_dwordx4 v218, s[8:11], 0 offen sc1 lds
    v_cvt_pk_bf16_f32 v122, v48, v49
    ds_read_b128 v[144:147], v9 offset:16320
    v_cvt_pk_bf16_f32 v123, v50, v51
    ds_read_b128 v[152:155], v9 offset:16992
    s_nop 0
    v_mfma_f32_32x32x16_bf16 v[100:115], v[148:151], v[120:123], v[100:115]
    v_exp_f32 v52, v52
    v_add_u32 v218, v218, v221
    v_exp_f32 v53, v53
    v_exp_f32 v54, v54
    v_exp_f32 v55, v55
    s_waitcnt lgkmcnt(2)
    v_mfma_f32_32x32x4_2b_bf16 v[20:51], v[140:141], v[132:133], 0
    v_exp_f32 v56, v56
    v_cvt_pk_bf16_f32 v116, v52, v53
    v_exp_f32 v57, v57
    v_cvt_pk_bf16_f32 v117, v54, v55
    v_exp_f32 v58, v58
    v_exp_f32 v59, v59
    v_cvt_pk_bf16_f32 v118, v56, v57
    v_exp_f32 v60, v60
    v_cvt_pk_bf16_f32 v119, v58, v59
    v_exp_f32 v61, v61
    v_exp_f32 v62, v62
    s_waitcnt lgkmcnt(0)
    v_mfma_f32_32x32x16_bf16 v[84:99], v[144:147], v[116:119], v[84:99]
    v_exp_f32 v63, v63
    v_cvt_pk_bf16_f32 v120, v60, v61
    v_exp_f32 v64, v64
    v_cvt_pk_bf16_f32 v121, v62, v63
    v_exp_f32 v65, v65
    v_exp_f32 v66, v66
    v_mfma_f32_32x32x16_bf16 v[20:35], v[136:139], v[124:127], v[20:35]
    v_exp_f32 v67, v67
    v_cvt_pk_bf16_f32 v122, v64, v65
    v_exp_f32 v68, v68
    v_cvt_pk_bf16_f32 v123, v66, v67
    v_exp_f32 v69, v69
    v_exp_f32 v70, v70
    v_mfma_f32_32x32x16_bf16 v[84:99], v[152:155], v[120:123], v[84:99]
    v_exp_f32 v71, v71
    v_cvt_pk_bf16_f32 v116, v68, v69
    v_exp_f32 v72, v72
    v_cvt_pk_bf16_f32 v117, v70, v71
    v_exp_f32 v73, v73
    v_exp_f32 v74, v74
    v_mfma_f32_32x32x16_bf16 v[36:51], v[136:139], v[128:131], v[36:51]
    ds_read_b128 v[136:139], v7 offset:25088
    ds_read_b64 v[140:141], v8 offset:25088
    v_exp_f32 v75, v75
    v_cvt_pk_bf16_f32 v118, v72, v73
    v_exp_f32 v76, v76
    v_cvt_pk_bf16_f32 v119, v74, v75
    v_exp_f32 v77, v77
    v_exp_f32 v78, v78
    v_mfma_f32_32x32x16_bf16 v[100:115], v[144:147], v[116:119], v[100:115]
    v_exp_f32 v79, v79
    v_cvt_pk_bf16_f32 v120, v76, v77
    v_exp_f32 v80, v80
    v_cvt_pk_bf16_f32 v121, v78, v79
    v_exp_f32 v81, v81
    v_exp_f32 v82, v82
    v_exp_f32 v83, v83
    v_cvt_pk_bf16_f32 v122, v80, v81
    ds_read_b128 v[144:147], v9 offset:24576
    v_cvt_pk_bf16_f32 v123, v82, v83
    ds_read_b128 v[148:151], v9 offset:25248
    s_nop 0
    v_mfma_f32_32x32x16_bf16 v[100:115], v[152:155], v[120:123], v[100:115]
    v_exp_f32 v20, v20
    v_exp_f32 v21, v21
    v_exp_f32 v22, v22
    v_exp_f32 v23, v23
    s_waitcnt lgkmcnt(2)
    v_mfma_f32_32x32x4_2b_bf16 v[52:83], v[140:141], v[132:133], 0
    v_exp_f32 v24, v24
    v_cvt_pk_bf16_f32 v116, v20, v21
    v_exp_f32 v25, v25
    v_cvt_pk_bf16_f32 v117, v22, v23
    v_exp_f32 v26, v26
    v_exp_f32 v27, v27
    v_cvt_pk_bf16_f32 v118, v24, v25
    v_exp_f32 v28, v28
    v_cvt_pk_bf16_f32 v119, v26, v27
    v_exp_f32 v29, v29
    v_exp_f32 v30, v30
    s_waitcnt lgkmcnt(0)
    v_mfma_f32_32x32x16_bf16 v[84:99], v[144:147], v[116:119], v[84:99]
    v_exp_f32 v31, v31
    v_cvt_pk_bf16_f32 v120, v28, v29
    v_exp_f32 v32, v32
    v_cvt_pk_bf16_f32 v121, v30, v31
    v_exp_f32 v33, v33
    v_exp_f32 v34, v34
    v_mfma_f32_32x32x16_bf16 v[52:67], v[136:139], v[124:127], v[52:67]
    v_exp_f32 v35, v35
    v_cvt_pk_bf16_f32 v122, v32, v33
    v_exp_f32 v36, v36
    v_cvt_pk_bf16_f32 v123, v34, v35
    v_exp_f32 v37, v37
    v_exp_f32 v38, v38
    v_mfma_f32_32x32x16_bf16 v[84:99], v[148:151], v[120:123], v[84:99]
    v_exp_f32 v39, v39
    v_cvt_pk_bf16_f32 v116, v36, v37
    v_exp_f32 v40, v40
    v_cvt_pk_bf16_f32 v117, v38, v39
    v_exp_f32 v41, v41
    v_exp_f32 v42, v42
    v_mfma_f32_32x32x16_bf16 v[68:83], v[136:139], v[128:131], v[68:83]
    ds_read_b128 v[136:139], v7 offset:25600
    ds_read_b64 v[140:141], v8 offset:25600
    v_exp_f32 v43, v43
    v_cvt_pk_bf16_f32 v118, v40, v41
    v_exp_f32 v44, v44
    v_cvt_pk_bf16_f32 v119, v42, v43
    v_exp_f32 v45, v45
    v_exp_f32 v46, v46
    v_mfma_f32_32x32x16_bf16 v[100:115], v[144:147], v[116:119], v[100:115]
    v_exp_f32 v47, v47
    v_cvt_pk_bf16_f32 v120, v44, v45
    v_exp_f32 v48, v48
    v_cvt_pk_bf16_f32 v121, v46, v47
    v_exp_f32 v49, v49
    v_exp_f32 v50, v50
    v_exp_f32 v51, v51
    v_cvt_pk_bf16_f32 v122, v48, v49
    ds_read_b128 v[144:147], v9 offset:25920
    v_cvt_pk_bf16_f32 v123, v50, v51
    ds_read_b128 v[152:155], v9 offset:26592
    s_nop 0
    v_mfma_f32_32x32x16_bf16 v[100:115], v[148:151], v[120:123], v[100:115]
    v_exp_f32 v52, v52
    v_exp_f32 v53, v53
    v_exp_f32 v54, v54
    v_exp_f32 v55, v55
    s_waitcnt lgkmcnt(2)
    v_mfma_f32_32x32x4_2b_bf16 v[20:51], v[140:141], v[132:133], 0
    v_exp_f32 v56, v56
    v_cvt_pk_bf16_f32 v116, v52, v53
    v_exp_f32 v57, v57
    v_cvt_pk_bf16_f32 v117, v54, v55
    v_exp_f32 v58, v58
    v_exp_f32 v59, v59
    v_cvt_pk_bf16_f32 v118, v56, v57
    v_exp_f32 v60, v60
    v_cvt_pk_bf16_f32 v119, v58, v59
    v_exp_f32 v61, v61
    v_exp_f32 v62, v62
    s_waitcnt lgkmcnt(0)
    v_mfma_f32_32x32x16_bf16 v[84:99], v[144:147], v[116:119], v[84:99]
    s_setprio 2
    v_exp_f32 v63, v63
    v_cvt_pk_bf16_f32 v120, v60, v61
    v_exp_f32 v64, v64
    v_cvt_pk_bf16_f32 v121, v62, v63
    v_exp_f32 v65, v65
    v_exp_f32 v66, v66
    v_mfma_f32_32x32x16_bf16 v[20:35], v[136:139], v[124:127], v[20:35]
    v_exp_f32 v67, v67
    v_cvt_pk_bf16_f32 v122, v64, v65
    v_exp_f32 v68, v68
    v_cvt_pk_bf16_f32 v123, v66, v67
    v_exp_f32 v69, v69
    v_exp_f32 v70, v70
    v_mfma_f32_32x32x16_bf16 v[84:99], v[152:155], v[120:123], v[84:99]
    v_exp_f32 v71, v71
    v_cvt_pk_bf16_f32 v116, v68, v69
    v_exp_f32 v72, v72
    v_cvt_pk_bf16_f32 v117, v70, v71
    v_exp_f32 v73, v73
    v_exp_f32 v74, v74
    v_mfma_f32_32x32x16_bf16 v[36:51], v[136:139], v[128:131], v[36:51]
    ds_read_b128 v[136:139], v7 offset:26112
    ds_read_b64 v[140:141], v8 offset:26112
    v_exp_f32 v75, v75
    v_cvt_pk_bf16_f32 v118, v72, v73
    v_exp_f32 v76, v76
    v_cvt_pk_bf16_f32 v119, v74, v75
    v_exp_f32 v77, v77
    v_exp_f32 v78, v78
    v_mfma_f32_32x32x16_bf16 v[100:115], v[144:147], v[116:119], v[100:115]
    v_exp_f32 v79, v79
    v_cvt_pk_bf16_f32 v120, v76, v77
    v_exp_f32 v80, v80
    v_cvt_pk_bf16_f32 v121, v78, v79
    v_exp_f32 v81, v81
    v_exp_f32 v82, v82
    v_exp_f32 v83, v83
    v_cvt_pk_bf16_f32 v122, v80, v81
    ds_read_b128 v[144:147], v9 offset:27264
    v_cvt_pk_bf16_f32 v123, v82, v83
    ds_read_b128 v[148:151], v9 offset:27936
    s_nop 0
    v_mfma_f32_32x32x16_bf16 v[100:115], v[152:155], v[120:123], v[100:115]
    v_exp_f32 v20, v20
    v_exp_f32 v21, v21
    v_exp_f32 v22, v22
    v_exp_f32 v23, v23
    s_waitcnt lgkmcnt(2)
    v_mfma_f32_32x32x4_2b_bf16 v[52:83], v[140:141], v[132:133], 0
    s_setprio 1
    v_exp_f32 v24, v24
    v_cvt_pk_bf16_f32 v116, v20, v21
    v_exp_f32 v25, v25
    v_cvt_pk_bf16_f32 v117, v22, v23
    v_exp_f32 v26, v26
    v_exp_f32 v27, v27
    v_cvt_pk_bf16_f32 v118, v24, v25
    v_exp_f32 v28, v28
    v_cvt_pk_bf16_f32 v119, v26, v27
    v_exp_f32 v29, v29
    v_exp_f32 v30, v30
    s_waitcnt lgkmcnt(0)
    v_mfma_f32_32x32x16_bf16 v[84:99], v[144:147], v[116:119], v[84:99]
    v_exp_f32 v31, v31
    v_cvt_pk_bf16_f32 v120, v28, v29
    v_exp_f32 v32, v32
    v_cvt_pk_bf16_f32 v121, v30, v31
    v_exp_f32 v33, v33
    v_exp_f32 v34, v34
    v_mfma_f32_32x32x16_bf16 v[52:67], v[136:139], v[124:127], v[52:67]
    v_exp_f32 v35, v35
    v_cvt_pk_bf16_f32 v122, v32, v33
    v_exp_f32 v36, v36
    v_cvt_pk_bf16_f32 v123, v34, v35
    v_exp_f32 v37, v37
    v_exp_f32 v38, v38
    v_mfma_f32_32x32x16_bf16 v[84:99], v[148:151], v[120:123], v[84:99]
    s_setprio 0
    v_exp_f32 v39, v39
    v_cvt_pk_bf16_f32 v116, v36, v37
    v_exp_f32 v40, v40
    v_cvt_pk_bf16_f32 v117, v38, v39
    v_exp_f32 v41, v41
    v_exp_f32 v42, v42
    v_mfma_f32_32x32x16_bf16 v[68:83], v[136:139], v[128:131], v[68:83]
    s_waitcnt vmcnt(0)
    s_barrier
    s_setprio 3
    ds_read_b128 v[136:139], v7 offset:0
    ds_read_b64 v[140:141], v8 offset:0
    v_exp_f32 v43, v43
    s_add_u32 m0, s50, 12288
    v_cvt_pk_bf16_f32 v118, v40, v41
    v_exp_f32 v44, v44
    s_nop 0
    v_cvt_pk_bf16_f32 v119, v42, v43
    v_exp_f32 v45, v45
    buffer_load_dwordx4 v216, s[8:11], 0 offen sc1 lds
    v_exp_f32 v46, v46
    s_add_u32 m0, m0, s51
    v_mfma_f32_32x32x16_bf16 v[100:115], v[144:147], v[116:119], v[100:115]
    v_exp_f32 v47, v47
    v_add_u32 v216, v216, v219
    v_cvt_pk_bf16_f32 v120, v44, v45
    v_exp_f32 v48, v48
    buffer_load_dwordx4 v217, s[8:11], 0 offen sc1 lds
    v_cvt_pk_bf16_f32 v121, v46, v47
    v_exp_f32 v49, v49
    s_add_u32 m0, m0, s51
    v_exp_f32 v50, v50
    v_add_u32 v217, v217, v220
    v_exp_f32 v51, v51
    buffer_load_dwordx4 v218, s[8:11], 0 offen sc1 lds
    v_cvt_pk_bf16_f32 v122, v48, v49
    ds_read_b128 v[144:147], v9 offset:28608
    v_cvt_pk_bf16_f32 v123, v50, v51
    ds_read_b128 v[152:155], v9 offset:29280
    s_nop 0
    v_mfma_f32_32x32x16_bf16 v[100:115], v[148:151], v[120:123], v[100:115]
    v_exp_f32 v52, v52
    v_add_u32 v218, v218, v221
    v_exp_f32 v53, v53
    v_exp_f32 v54, v54
    v_exp_f32 v55, v55
    s_waitcnt lgkmcnt(2)
    v_mfma_f32_32x32x4_2b_bf16 v[20:51], v[140:141], v[132:133], 0
    v_exp_f32 v56, v56
    v_cvt_pk_bf16_f32 v116, v52, v53
    v_exp_f32 v57, v57
    v_cvt_pk_bf16_f32 v117, v54, v55
    v_exp_f32 v58, v58
    v_exp_f32 v59, v59
    v_cvt_pk_bf16_f32 v118, v56, v57
    v_exp_f32 v60, v60
    v_cvt_pk_bf16_f32 v119, v58, v59
    v_exp_f32 v61, v61
    v_exp_f32 v62, v62
    s_waitcnt lgkmcnt(0)
    v_mfma_f32_32x32x16_bf16 v[84:99], v[144:147], v[116:119], v[84:99]
    v_exp_f32 v63, v63
    v_cvt_pk_bf16_f32 v120, v60, v61
    v_exp_f32 v64, v64
    v_cvt_pk_bf16_f32 v121, v62, v63
    v_exp_f32 v65, v65
    v_exp_f32 v66, v66
    v_mfma_f32_32x32x16_bf16 v[20:35], v[136:139], v[124:127], v[20:35]
    v_exp_f32 v67, v67
    v_cvt_pk_bf16_f32 v122, v64, v65
    v_exp_f32 v68, v68
    v_cvt_pk_bf16_f32 v123, v66, v67
    v_exp_f32 v69, v69
    v_exp_f32 v70, v70
    v_mfma_f32_32x32x16_bf16 v[84:99], v[152:155], v[120:123], v[84:99]
    v_exp_f32 v71, v71
    v_cvt_pk_bf16_f32 v116, v68, v69
    v_exp_f32 v72, v72
    v_cvt_pk_bf16_f32 v117, v70, v71
    v_exp_f32 v73, v73
    v_exp_f32 v74, v74
    v_mfma_f32_32x32x16_bf16 v[36:51], v[136:139], v[128:131], v[36:51]
    ds_read_b128 v[136:139], v7 offset:512
    ds_read_b64 v[140:141], v8 offset:512
    v_exp_f32 v75, v75
    v_cvt_pk_bf16_f32 v118, v72, v73
    v_exp_f32 v76, v76
    v_cvt_pk_bf16_f32 v119, v74, v75
    v_exp_f32 v77, v77
    v_exp_f32 v78, v78
    v_mfma_f32_32x32x16_bf16 v[100:115], v[144:147], v[116:119], v[100:115]
    v_exp_f32 v79, v79
    v_cvt_pk_bf16_f32 v120, v76, v77
    v_exp_f32 v80, v80
    v_cvt_pk_bf16_f32 v121, v78, v79
    v_exp_f32 v81, v81
    v_exp_f32 v82, v82
    v_exp_f32 v83, v83
    v_cvt_pk_bf16_f32 v122, v80, v81
    ds_read_b128 v[144:147], v9 offset:0
    v_cvt_pk_bf16_f32 v123, v82, v83
    ds_read_b128 v[148:151], v9 offset:672
    s_nop 0
    v_mfma_f32_32x32x16_bf16 v[100:115], v[152:155], v[120:123], v[100:115]
    v_exp_f32 v20, v20
    v_exp_f32 v21, v21
    v_exp_f32 v22, v22
    v_exp_f32 v23, v23
    s_waitcnt lgkmcnt(2)
    v_mfma_f32_32x32x4_2b_bf16 v[52:83], v[140:141], v[132:133], 0
    v_exp_f32 v24, v24
    v_cvt_pk_bf16_f32 v116, v20, v21
    v_exp_f32 v25, v25
    v_cvt_pk_bf16_f32 v117, v22, v23
    v_exp_f32 v26, v26
    v_exp_f32 v27, v27
    v_cvt_pk_bf16_f32 v118, v24, v25
    v_exp_f32 v28, v28
    v_cvt_pk_bf16_f32 v119, v26, v27
    v_exp_f32 v29, v29
    v_exp_f32 v30, v30
    s_waitcnt lgkmcnt(0)
    v_mfma_f32_32x32x16_bf16 v[84:99], v[144:147], v[116:119], v[84:99]
    v_exp_f32 v31, v31
    v_cvt_pk_bf16_f32 v120, v28, v29
    v_exp_f32 v32, v32
    v_cvt_pk_bf16_f32 v121, v30, v31
    v_exp_f32 v33, v33
    v_exp_f32 v34, v34
    v_mfma_f32_32x32x16_bf16 v[52:67], v[136:139], v[124:127], v[52:67]
    v_exp_f32 v35, v35
    v_cvt_pk_bf16_f32 v122, v32, v33
    v_exp_f32 v36, v36
    v_cvt_pk_bf16_f32 v123, v34, v35
    v_exp_f32 v37, v37
    v_exp_f32 v38, v38
    v_mfma_f32_32x32x16_bf16 v[84:99], v[148:151], v[120:123], v[84:99]
    v_exp_f32 v39, v39
    v_cvt_pk_bf16_f32 v116, v36, v37
    v_exp_f32 v40, v40
    v_cvt_pk_bf16_f32 v117, v38, v39
    v_exp_f32 v41, v41
    v_exp_f32 v42, v42
    v_mfma_f32_32x32x16_bf16 v[68:83], v[136:139], v[128:131], v[68:83]
    ds_read_b128 v[136:139], v7 offset:1024
    ds_read_b64 v[140:141], v8 offset:1024
    s_cmp_lg_u32 s12, 0
    s_cbranch_scc1 L_sequential_preLN__softmax_full_mha__swiglu_ffn__prompt_kernel_nl_30
    s_mov_b32 s42, 13631488
    buffer_load_dwordx4 v[208:211], v2, s[8:11], s42 offen sc1
L_sequential_preLN__softmax_full_mha__swiglu_ffn__prompt_kernel_nl_30:
    v_exp_f32 v43, v43
    v_cvt_pk_bf16_f32 v118, v40, v41
    v_exp_f32 v44, v44
    v_cvt_pk_bf16_f32 v119, v42, v43
    v_exp_f32 v45, v45
    v_exp_f32 v46, v46
    v_mfma_f32_32x32x16_bf16 v[100:115], v[144:147], v[116:119], v[100:115]
    v_exp_f32 v47, v47
    v_cvt_pk_bf16_f32 v120, v44, v45
    v_exp_f32 v48, v48
    v_cvt_pk_bf16_f32 v121, v46, v47
    v_exp_f32 v49, v49
    v_exp_f32 v50, v50
    v_exp_f32 v51, v51
    v_cvt_pk_bf16_f32 v122, v48, v49
    ds_read_b128 v[144:147], v9 offset:1344
    v_cvt_pk_bf16_f32 v123, v50, v51
    ds_read_b128 v[152:155], v9 offset:2016
    s_nop 0
    v_mfma_f32_32x32x16_bf16 v[100:115], v[148:151], v[120:123], v[100:115]
    v_exp_f32 v52, v52
    v_exp_f32 v53, v53
    v_exp_f32 v54, v54
    v_exp_f32 v55, v55
    s_waitcnt lgkmcnt(2)
    v_mfma_f32_32x32x4_2b_bf16 v[20:51], v[140:141], v[132:133], 0
    v_exp_f32 v56, v56
    v_cvt_pk_bf16_f32 v116, v52, v53
    v_exp_f32 v57, v57
    v_cvt_pk_bf16_f32 v117, v54, v55
    v_exp_f32 v58, v58
    v_exp_f32 v59, v59
    v_cvt_pk_bf16_f32 v118, v56, v57
    v_exp_f32 v60, v60
    v_cvt_pk_bf16_f32 v119, v58, v59
    v_exp_f32 v61, v61
    v_exp_f32 v62, v62
    s_waitcnt lgkmcnt(0)
    v_mfma_f32_32x32x16_bf16 v[84:99], v[144:147], v[116:119], v[84:99]
    s_setprio 2
    v_exp_f32 v63, v63
    v_cvt_pk_bf16_f32 v120, v60, v61
    v_exp_f32 v64, v64
    v_cvt_pk_bf16_f32 v121, v62, v63
    v_exp_f32 v65, v65
    v_exp_f32 v66, v66
    v_mfma_f32_32x32x16_bf16 v[20:35], v[136:139], v[124:127], v[20:35]
    v_exp_f32 v67, v67
    v_cvt_pk_bf16_f32 v122, v64, v65
    v_exp_f32 v68, v68
    v_cvt_pk_bf16_f32 v123, v66, v67
    v_exp_f32 v69, v69
    v_exp_f32 v70, v70
    v_mfma_f32_32x32x16_bf16 v[84:99], v[152:155], v[120:123], v[84:99]
    v_exp_f32 v71, v71
    v_cvt_pk_bf16_f32 v116, v68, v69
    v_exp_f32 v72, v72
    v_cvt_pk_bf16_f32 v117, v70, v71
    v_exp_f32 v73, v73
    v_exp_f32 v74, v74
    v_mfma_f32_32x32x16_bf16 v[36:51], v[136:139], v[128:131], v[36:51]
    ds_read_b128 v[136:139], v7 offset:1536
    ds_read_b64 v[140:141], v8 offset:1536
    v_exp_f32 v75, v75
    v_cvt_pk_bf16_f32 v118, v72, v73
    v_exp_f32 v76, v76
    v_cvt_pk_bf16_f32 v119, v74, v75
    v_exp_f32 v77, v77
    v_exp_f32 v78, v78
    v_mfma_f32_32x32x16_bf16 v[100:115], v[144:147], v[116:119], v[100:115]
    v_exp_f32 v79, v79
    v_cvt_pk_bf16_f32 v120, v76, v77
    v_exp_f32 v80, v80
    v_cvt_pk_bf16_f32 v121, v78, v79
    v_exp_f32 v81, v81
    v_exp_f32 v82, v82
    v_exp_f32 v83, v83
    v_cvt_pk_bf16_f32 v122, v80, v81
    ds_read_b128 v[144:147], v9 offset:2688
    v_cvt_pk_bf16_f32 v123, v82, v83
    ds_read_b128 v[148:151], v9 offset:3360
    s_nop 0
    v_mfma_f32_32x32x16_bf16 v[100:115], v[152:155], v[120:123], v[100:115]
    v_exp_f32 v20, v20
    v_exp_f32 v21, v21
    v_exp_f32 v22, v22
    v_exp_f32 v23, v23
    s_waitcnt lgkmcnt(2)
    v_mfma_f32_32x32x4_2b_bf16 v[52:83], v[140:141], v[132:133], 0
    s_setprio 1
    v_exp_f32 v24, v24
    v_cvt_pk_bf16_f32 v116, v20, v21
    v_exp_f32 v25, v25
    v_cvt_pk_bf16_f32 v117, v22, v23
    v_exp_f32 v26, v26
    v_exp_f32 v27, v27
    v_cvt_pk_bf16_f32 v118, v24, v25
    v_exp_f32 v28, v28
    v_cvt_pk_bf16_f32 v119, v26, v27
    v_exp_f32 v29, v29
    v_exp_f32 v30, v30
    s_waitcnt lgkmcnt(0)
    v_mfma_f32_32x32x16_bf16 v[84:99], v[144:147], v[116:119], v[84:99]
    v_exp_f32 v31, v31
    v_cvt_pk_bf16_f32 v120, v28, v29
    v_exp_f32 v32, v32
    v_cvt_pk_bf16_f32 v121, v30, v31
    v_exp_f32 v33, v33
    v_exp_f32 v34, v34
    v_mfma_f32_32x32x16_bf16 v[52:67], v[136:139], v[124:127], v[52:67]
    v_exp_f32 v35, v35
    v_cvt_pk_bf16_f32 v122, v32, v33
    v_exp_f32 v36, v36
    v_cvt_pk_bf16_f32 v123, v34, v35
    v_exp_f32 v37, v37
    v_exp_f32 v38, v38
    v_mfma_f32_32x32x16_bf16 v[84:99], v[148:151], v[120:123], v[84:99]
    s_setprio 0
    v_exp_f32 v39, v39
    v_cvt_pk_bf16_f32 v116, v36, v37
    v_exp_f32 v40, v40
    v_cvt_pk_bf16_f32 v117, v38, v39
    v_exp_f32 v41, v41
    v_exp_f32 v42, v42
    v_mfma_f32_32x32x16_bf16 v[68:83], v[136:139], v[128:131], v[68:83]
    s_waitcnt vmcnt(0)
    s_cmp_lg_u32 s12, 0
    s_cbranch_scc1 L_sequential_preLN__softmax_full_mha__swiglu_ffn__prompt_kernel_ne_31
    s_mov_b32 s44, 0
L_sequential_preLN__softmax_full_mha__swiglu_ffn__prompt_kernel_e_32:
    v_min_u32 v208, v208, v209
    v_min3_u32 v208, v208, v210, v211
    s_add_u32 s44, s44, 1
    v_cmp_ne_u32 vcc, 0, v208
    s_nop 0
    s_cmp_eq_u64 vcc, -1
    s_cbranch_scc1 L_sequential_preLN__softmax_full_mha__swiglu_ffn__prompt_kernel_ne_31
    s_cmp_gt_u32 s44, 0x40000
    s_cbranch_scc1 L_sequential_preLN__softmax_full_mha__swiglu_ffn__prompt_kernel_ne_31
    buffer_load_dwordx4 v[208:211], v2, s[8:11], s42 offen sc1
    s_waitcnt vmcnt(0)
    s_branch L_sequential_preLN__softmax_full_mha__swiglu_ffn__prompt_kernel_e_32
L_sequential_preLN__softmax_full_mha__swiglu_ffn__prompt_kernel_ne_31:
    s_barrier
    s_setprio 3
    ds_read_b128 v[136:139], v7 offset:12288
    ds_read_b64 v[140:141], v8 offset:12288
    v_exp_f32 v43, v43
    s_lshr_b32 s42, s2, 5
    v_cvt_pk_bf16_f32 v118, v40, v41
    v_exp_f32 v44, v44
    s_lshl_b32 s43, s12, 3
    v_cvt_pk_bf16_f32 v119, v42, v43
    v_exp_f32 v45, v45
    s_add_u32 s42, s42, s43
    v_exp_f32 v46, v46
    s_mul_i32 s42, s42, 5120
    v_mfma_f32_32x32x16_bf16 v[100:115], v[144:147], v[116:119], v[100:115]
    v_exp_f32 v47, v47
    s_add_u32 s42, s42, 20971520
    v_cvt_pk_bf16_f32 v120, v44, v45
    v_exp_f32 v48, v48
    s_mul_i32 s43, s12, 5120
    v_cvt_pk_bf16_f32 v121, v46, v47
    v_exp_f32 v49, v49
    s_add_u32 m0, s43, 73728
    v_exp_f32 v50, v50
    s_add_u32 s44, s42, 4096
    v_exp_f32 v51, v51
    buffer_load_dwordx4 v2, s[8:11], s42 offen offset:0 lds
    v_cvt_pk_bf16_f32 v122, v48, v49
    ds_read_b128 v[144:147], v9 offset:4032
    v_cvt_pk_bf16_f32 v123, v50, v51
    ds_read_b128 v[152:155], v9 offset:4704
    s_nop 0
    v_mfma_f32_32x32x16_bf16 v[100:115], v[148:151], v[120:123], v[100:115]
    v_exp_f32 v52, v52
    v_exp_f32 v53, v53
    v_exp_f32 v54, v54
    v_exp_f32 v55, v55
    s_waitcnt lgkmcnt(2)
    v_mfma_f32_32x32x4_2b_bf16 v[20:51], v[140:141], v[132:133], 0
    v_exp_f32 v56, v56
    v_cvt_pk_bf16_f32 v116, v52, v53
    v_exp_f32 v57, v57
    v_cvt_pk_bf16_f32 v117, v54, v55
    v_exp_f32 v58, v58
    v_exp_f32 v59, v59
    v_cvt_pk_bf16_f32 v118, v56, v57
    v_exp_f32 v60, v60
    buffer_load_dwordx4 v2, s[8:11], s42 offen offset:1024 lds
    v_cvt_pk_bf16_f32 v119, v58, v59
    v_exp_f32 v61, v61
    v_exp_f32 v62, v62
    s_waitcnt lgkmcnt(0)
    v_mfma_f32_32x32x16_bf16 v[84:99], v[144:147], v[116:119], v[84:99]
    v_exp_f32 v63, v63
    v_cvt_pk_bf16_f32 v120, v60, v61
    v_exp_f32 v64, v64
    v_cvt_pk_bf16_f32 v121, v62, v63
    v_exp_f32 v65, v65
    v_exp_f32 v66, v66
    v_mfma_f32_32x32x16_bf16 v[20:35], v[136:139], v[124:127], v[20:35]
    v_exp_f32 v67, v67
    v_cvt_pk_bf16_f32 v122, v64, v65
    v_exp_f32 v68, v68
    v_cvt_pk_bf16_f32 v123, v66, v67
    v_exp_f32 v69, v69
    buffer_load_dwordx4 v2, s[8:11], s42 offen offset:2048 lds
    v_exp_f32 v70, v70
    v_mfma_f32_32x32x16_bf16 v[84:99], v[152:155], v[120:123], v[84:99]
    v_exp_f32 v71, v71
    v_cvt_pk_bf16_f32 v116, v68, v69
    v_exp_f32 v72, v72
    v_cvt_pk_bf16_f32 v117, v70, v71
    v_exp_f32 v73, v73
    v_exp_f32 v74, v74
    v_mfma_f32_32x32x16_bf16 v[36:51], v[136:139], v[128:131], v[36:51]
    ds_read_b128 v[136:139], v7 offset:12800
    ds_read_b64 v[140:141], v8 offset:12800
    v_exp_f32 v75, v75
    v_cvt_pk_bf16_f32 v118, v72, v73
    v_exp_f32 v76, v76
    v_cvt_pk_bf16_f32 v119, v74, v75
    v_exp_f32 v77, v77
    v_exp_f32 v78, v78
    buffer_load_dwordx4 v2, s[8:11], s42 offen offset:3072 lds
    v_mfma_f32_32x32x16_bf16 v[100:115], v[144:147], v[116:119], v[100:115]
    v_exp_f32 v79, v79
    v_cvt_pk_bf16_f32 v120, v76, v77
    v_exp_f32 v80, v80
    v_cvt_pk_bf16_f32 v121, v78, v79
    v_exp_f32 v81, v81
    v_exp_f32 v82, v82
    v_exp_f32 v83, v83
    v_cvt_pk_bf16_f32 v122, v80, v81
    ds_read_b128 v[144:147], v9 offset:12288
    v_cvt_pk_bf16_f32 v123, v82, v83
    ds_read_b128 v[148:151], v9 offset:12960
    s_nop 0
    v_mfma_f32_32x32x16_bf16 v[100:115], v[152:155], v[120:123], v[100:115]
    v_exp_f32 v20, v20
    v_exp_f32 v21, v21
    v_exp_f32 v22, v22
    v_exp_f32 v23, v23
    s_add_u32 m0, m0, 4096
    s_waitcnt lgkmcnt(2)
    v_mfma_f32_32x32x4_2b_bf16 v[52:83], v[140:141], v[132:133], 0
    v_exp_f32 v24, v24
    s_add_u32 s42, s42, 327680
    v_cvt_pk_bf16_f32 v116, v20, v21
    v_exp_f32 v25, v25
    buffer_load_dwordx4 v2, s[8:11], s44 offen lds
    v_cvt_pk_bf16_f32 v117, v22, v23
    v_exp_f32 v26, v26
    v_exp_f32 v27, v27
    v_cvt_pk_bf16_f32 v118, v24, v25
    v_exp_f32 v28, v28
    v_cvt_pk_bf16_f32 v119, v26, v27
    v_exp_f32 v29, v29
    v_exp_f32 v30, v30
    s_waitcnt lgkmcnt(0)
    v_mfma_f32_32x32x16_bf16 v[84:99], v[144:147], v[116:119], v[84:99]
    v_exp_f32 v31, v31
    v_cvt_pk_bf16_f32 v120, v28, v29
    v_exp_f32 v32, v32
    v_cvt_pk_bf16_f32 v121, v30, v31
    v_exp_f32 v33, v33
    v_exp_f32 v34, v34
    s_add_u32 m0, s43, 114688
    v_mfma_f32_32x32x16_bf16 v[52:67], v[136:139], v[124:127], v[52:67]
    v_exp_f32 v35, v35
    s_add_u32 s44, s42, 4096
    v_cvt_pk_bf16_f32 v122, v32, v33
    v_exp_f32 v36, v36
    buffer_load_dwordx4 v2, s[8:11], s42 offen offset:0 lds
    v_cvt_pk_bf16_f32 v123, v34, v35
    v_exp_f32 v37, v37
    v_exp_f32 v38, v38
    v_mfma_f32_32x32x16_bf16 v[84:99], v[148:151], v[120:123], v[84:99]
    v_exp_f32 v39, v39
    v_cvt_pk_bf16_f32 v116, v36, v37
    v_exp_f32 v40, v40
    v_cvt_pk_bf16_f32 v117, v38, v39
    v_exp_f32 v41, v41
    v_exp_f32 v42, v42
    v_mfma_f32_32x32x16_bf16 v[68:83], v[136:139], v[128:131], v[68:83]
    ds_read_b128 v[136:139], v7 offset:13312
    ds_read_b64 v[140:141], v8 offset:13312
    v_exp_f32 v43, v43
    v_cvt_pk_bf16_f32 v118, v40, v41
    v_exp_f32 v44, v44
    v_cvt_pk_bf16_f32 v119, v42, v43
    v_exp_f32 v45, v45
    buffer_load_dwordx4 v2, s[8:11], s42 offen offset:1024 lds
    v_exp_f32 v46, v46
    v_mfma_f32_32x32x16_bf16 v[100:115], v[144:147], v[116:119], v[100:115]
    v_exp_f32 v47, v47
    v_cvt_pk_bf16_f32 v120, v44, v45
    v_exp_f32 v48, v48
    v_cvt_pk_bf16_f32 v121, v46, v47
    v_exp_f32 v49, v49
    v_exp_f32 v50, v50
    v_exp_f32 v51, v51
    v_cvt_pk_bf16_f32 v122, v48, v49
    ds_read_b128 v[144:147], v9 offset:13632
    v_cvt_pk_bf16_f32 v123, v50, v51
    ds_read_b128 v[152:155], v9 offset:14304
    s_nop 0
    v_mfma_f32_32x32x16_bf16 v[100:115], v[148:151], v[120:123], v[100:115]
    v_exp_f32 v52, v52
    v_exp_f32 v53, v53
    v_exp_f32 v54, v54
    buffer_load_dwordx4 v2, s[8:11], s42 offen offset:2048 lds
    v_exp_f32 v55, v55
    s_waitcnt lgkmcnt(2)
    v_mfma_f32_32x32x4_2b_bf16 v[20:51], v[140:141], v[132:133], 0
    v_exp_f32 v56, v56
    v_cvt_pk_bf16_f32 v116, v52, v53
    v_exp_f32 v57, v57
    v_cvt_pk_bf16_f32 v117, v54, v55
    v_exp_f32 v58, v58
    v_exp_f32 v59, v59
    v_cvt_pk_bf16_f32 v118, v56, v57
    v_exp_f32 v60, v60
    v_cvt_pk_bf16_f32 v119, v58, v59
    v_exp_f32 v61, v61
    v_exp_f32 v62, v62
    s_waitcnt lgkmcnt(0)
    v_mfma_f32_32x32x16_bf16 v[84:99], v[144:147], v[116:119], v[84:99]
    v_exp_f32 v63, v63
    buffer_load_dwordx4 v2, s[8:11], s42 offen offset:3072 lds
    v_cvt_pk_bf16_f32 v120, v60, v61
    v_exp_f32 v64, v64
    v_cvt_pk_bf16_f32 v121, v62, v63
    v_exp_f32 v65, v65
    v_exp_f32 v66, v66
    v_mfma_f32_32x32x16_bf16 v[20:35], v[136:139], v[124:127], v[20:35]
    v_exp_f32 v67, v67
    v_cvt_pk_bf16_f32 v122, v64, v65
    v_exp_f32 v68, v68
    v_cvt_pk_bf16_f32 v123, v66, v67
    v_exp_f32 v69, v69
    v_exp_f32 v70, v70
    v_mfma_f32_32x32x16_bf16 v[84:99], v[152:155], v[120:123], v[84:99]
    v_exp_f32 v71, v71
    v_cvt_pk_bf16_f32 v116, v68, v69
    v_exp_f32 v72, v72
    s_add_u32 m0, m0, 4096
    v_cvt_pk_bf16_f32 v117, v70, v71
    v_exp_f32 v73, v73
    s_add_u32 s42, s42, 327680
    v_exp_f32 v74, v74
    buffer_load_dwordx4 v2, s[8:11], s44 offen lds
    v_mfma_f32_32x32x16_bf16 v[36:51], v[136:139], v[128:131], v[36:51]
    ds_read_b128 v[136:139], v7 offset:13824
    ds_read_b64 v[140:141], v8 offset:13824
    v_exp_f32 v75, v75
    v_cvt_pk_bf16_f32 v118, v72, v73
    v_exp_f32 v76, v76
    v_cvt_pk_bf16_f32 v119, v74, v75
    v_exp_f32 v77, v77
    v_exp_f32 v78, v78
    v_mfma_f32_32x32x16_bf16 v[100:115], v[144:147], v[116:119], v[100:115]
    v_exp_f32 v79, v79
    v_cvt_pk_bf16_f32 v120, v76, v77
    v_exp_f32 v80, v80
    v_cvt_pk_bf16_f32 v121, v78, v79
    v_exp_f32 v81, v81
    v_exp_f32 v82, v82
    v_exp_f32 v83, v83
    v_cvt_pk_bf16_f32 v122, v80, v81
    ds_read_b128 v[144:147], v9 offset:14976
    v_cvt_pk_bf16_f32 v123, v82, v83
    ds_read_b128 v[148:151], v9 offset:15648
    s_nop 0
    v_mfma_f32_32x32x16_bf16 v[100:115], v[152:155], v[120:123], v[100:115]
    v_exp_f32 v20, v20
    v_exp_f32 v21, v21
    v_exp_f32 v22, v22
    v_exp_f32 v23, v23
    s_waitcnt lgkmcnt(2)
    v_mfma_f32_32x32x4_2b_bf16 v[52:83], v[140:141], v[132:133], 0
    s_setprio 2
    v_exp_f32 v24, v24
    v_cvt_pk_bf16_f32 v116, v20, v21
    v_exp_f32 v25, v25
    v_cvt_pk_bf16_f32 v117, v22, v23
    v_exp_f32 v26, v26
    v_exp_f32 v27, v27
    v_cvt_pk_bf16_f32 v118, v24, v25
    v_exp_f32 v28, v28
    v_cvt_pk_bf16_f32 v119, v26, v27
    v_exp_f32 v29, v29
    v_exp_f32 v30, v30
    s_waitcnt lgkmcnt(0)
    v_mfma_f32_32x32x16_bf16 v[84:99], v[144:147], v[116:119], v[84:99]
    v_exp_f32 v31, v31
    v_cvt_pk_bf16_f32 v120, v28, v29
    v_exp_f32 v32, v32
    v_cvt_pk_bf16_f32 v121, v30, v31
    v_exp_f32 v33, v33
    v_exp_f32 v34, v34
    v_mfma_f32_32x32x16_bf16 v[52:67], v[136:139], v[124:127], v[52:67]
    v_exp_f32 v35, v35
    v_cvt_pk_bf16_f32 v122, v32, v33
    v_exp_f32 v36, v36
    v_cvt_pk_bf16_f32 v123, v34, v35
    v_exp_f32 v37, v37
    v_exp_f32 v38, v38
    v_mfma_f32_32x32x16_bf16 v[84:99], v[148:151], v[120:123], v[84:99]
    v_exp_f32 v39, v39
    v_cvt_pk_bf16_f32 v116, v36, v37
    v_exp_f32 v40, v40
    v_cvt_pk_bf16_f32 v117, v38, v39
    v_exp_f32 v41, v41
    v_exp_f32 v42, v42
    v_mfma_f32_32x32x16_bf16 v[68:83], v[136:139], v[128:131], v[68:83]
    v_exp_f32 v43, v43
    v_cvt_pk_bf16_f32 v118, v40, v41
    v_exp_f32 v44, v44
    v_cvt_pk_bf16_f32 v119, v42, v43
    v_exp_f32 v45, v45
    v_exp_f32 v46, v46
    v_mfma_f32_32x32x16_bf16 v[100:115], v[144:147], v[116:119], v[100:115]
    v_exp_f32 v47, v47
    v_cvt_pk_bf16_f32 v120, v44, v45
    v_exp_f32 v48, v48
    v_cvt_pk_bf16_f32 v121, v46, v47
    v_exp_f32 v49, v49
    v_exp_f32 v50, v50
    v_exp_f32 v51, v51
    v_cvt_pk_bf16_f32 v122, v48, v49
    ds_read_b128 v[144:147], v9 offset:16320
    v_cvt_pk_bf16_f32 v123, v50, v51
    ds_read_b128 v[152:155], v9 offset:16992
    s_nop 0
    v_mfma_f32_32x32x16_bf16 v[100:115], v[148:151], v[120:123], v[100:115]
    v_exp_f32 v68, v68
    v_exp_f32 v69, v69
    v_exp_f32 v70, v70
    v_exp_f32 v71, v71
    v_exp_f32 v72, v72
    v_cvt_pk_bf16_f32 v116, v68, v69
    v_exp_f32 v73, v73
    v_cvt_pk_bf16_f32 v117, v70, v71
    v_exp_f32 v74, v74
    v_exp_f32 v75, v75
    v_cvt_pk_bf16_f32 v118, v72, v73
    v_exp_f32 v76, v76
    v_cvt_pk_bf16_f32 v119, v74, v75
    v_exp_f32 v77, v77
    v_exp_f32 v78, v78
    s_waitcnt lgkmcnt(0)
    v_mfma_f32_32x32x16_bf16 v[100:115], v[144:147], v[116:119], v[100:115]
    s_setprio 1
    v_exp_f32 v79, v79
    v_cvt_pk_bf16_f32 v120, v76, v77
    v_exp_f32 v80, v80
    v_cvt_pk_bf16_f32 v121, v78, v79
    v_exp_f32 v81, v81
    v_exp_f32 v82, v82
    v_exp_f32 v83, v83
    v_cvt_pk_bf16_f32 v122, v80, v81
    v_exp_f32 v52, v52
    v_cvt_pk_bf16_f32 v123, v82, v83
    v_exp_f32 v53, v53
    v_exp_f32 v54, v54
    v_mfma_f32_32x32x16_bf16 v[100:115], v[152:155], v[120:123], v[100:115]
    v_exp_f32 v55, v55
    v_cvt_pk_bf16_f32 v116, v52, v53
    v_exp_f32 v56, v56
    v_cvt_pk_bf16_f32 v117, v54, v55
    v_exp_f32 v57, v57
    v_exp_f32 v58, v58
    s_setprio 0
    v_exp_f32 v59, v59
    v_cvt_pk_bf16_f32 v118, v56, v57
    v_exp_f32 v60, v60
    v_cvt_pk_bf16_f32 v119, v58, v59
    v_exp_f32 v61, v61
    v_exp_f32 v62, v62
    v_mfma_f32_32x32x16_bf16 v[84:99], v[144:147], v[116:119], v[84:99]
    ds_write_b128 v214, v[100:103] offset:0
    ds_write_b128 v214, v[104:107] offset:1024
    ds_write_b128 v214, v[108:111] offset:2048
    v_exp_f32 v63, v63
    v_cvt_pk_bf16_f32 v120, v60, v61
    v_exp_f32 v64, v64
    v_cvt_pk_bf16_f32 v121, v62, v63
    v_exp_f32 v65, v65
    v_exp_f32 v66, v66
    v_exp_f32 v67, v67
    v_cvt_pk_bf16_f32 v122, v64, v65
    v_cvt_pk_bf16_f32 v123, v66, v67
    s_nop 1
    v_mfma_f32_32x32x16_bf16 v[84:99], v[152:155], v[120:123], v[84:99]
    s_setprio 0
    s_mov_b32 s52, 0x5f800000
    s_mov_b32 s53, 0x7f800000
    s_waitcnt lgkmcnt(0)
    s_barrier
    ds_read_b128 v[108:111], v215 offset:2048
    ds_read_b128 v[100:103], v215 offset:0
    ds_read_b128 v[104:107], v215 offset:1024
    s_waitcnt lgkmcnt(2)
    s_nop 2
    v_pk_add_f32 v[92:93], v[92:93], v[108:109]
    v_pk_add_f32 v[94:95], v[94:95], v[110:111]
    v_mov_b32 v12, v92
    v_mov_b32 v13, v92
    s_waitcnt lgkmcnt(0)
    v_pk_add_f32 v[84:85], v[84:85], v[100:101]
    v_pk_add_f32 v[86:87], v[86:87], v[102:103]
    v_pk_add_f32 v[88:89], v[88:89], v[104:105]
    v_pk_add_f32 v[90:91], v[90:91], v[106:107]
    v_permlane32_swap_b32 v12, v13
    v_add_f32 v14, |v92|, |v93|
    v_add_f32 v15, |v94|, |v95|
    v_add_f32 v14, |v84|, v14
    v_add_f32 v15, |v85|, v15
    v_add_f32 v14, |v86|, v14
    v_add_f32 v15, |v87|, v15
    v_add_f32 v14, |v88|, v14
    v_add_f32 v15, |v89|, v15
    v_add_f32 v14, |v90|, v14
    v_add_f32 v15, |v91|, v15
    v_cmp_lt_f32 vcc, 0x1f800000, v13
    v_add_f32 v14, v14, v15
    v_cmp_gt_f32 s[56:57], s52, v13
    v_cmp_gt_f32 s[54:55], s53, v14
    s_and_b64 vcc, vcc, s[56:57]
    s_and_b64 vcc, vcc, s[54:55]
    s_cmp_eq_u64 vcc, -1
    s_cbranch_scc0 L_sequential_preLN__softmax_full_mha__swiglu_ffn__prompt_kernel_slow_17
L_sequential_preLN__softmax_full_mha__swiglu_ffn__prompt_kernel_store_18:
    v_rcp_f32 v12, v13
    v_rcp_f32 v13, v13
    s_nop 2
    v_pk_mul_f32 v[84:85], v[84:85], v[12:13]
    v_pk_mul_f32 v[86:87], v[86:87], v[12:13]
    v_pk_mul_f32 v[88:89], v[88:89], v[12:13]
    v_pk_mul_f32 v[90:91], v[90:91], v[12:13]
    v_cvt_pk_bf16_f32 v84, v84, v85
    v_cvt_pk_bf16_f32 v85, v86, v87
    v_cvt_pk_bf16_f32 v86, v88, v89
    v_cvt_pk_bf16_f32 v87, v90, v91
    buffer_store_dwordx4 v[84:87], v212, s[8:11], s58 offen sc1
    v_pk_mul_f32 v[92:93], v[92:93], v[12:13]
    v_pk_mul_f32 v[94:95], v[94:95], v[12:13]
    v_cvt_pk_bf16_f32 v88, v92, v93
    v_cvt_pk_bf16_f32 v89, v94, v95
    s_mov_b32 exec_hi, 0
    buffer_store_dwordx2 v[88:89], v213, s[8:11], s59 offen sc1
    s_mov_b32 exec_hi, -1
    s_lshr_b32 s14, s2, 5
    s_lshl_b32 s14, s14, 5
    s_add_u32 s14, s14, s37
    s_lshl_b32 s14, s14, 6
    s_add_u32 s14, s14, 13516800
    s_load_dwordx2 s[38:39], s[0:1], 0
    s_and_b32 s50, s2, 7
    s_lshl_b32 s50, s50, 2
    s_bfe_u32 s51, s2, 0x20003
    s_add_u32 s48, s50, s51
    s_lshl_b32 s48, s48, 2
    s_add_u32 s48, s48, s13
    s_lshr_b32 s49, s2, 5
    s_cmp_ge_u32 s12, 4
    s_cbranch_scc1 L_sequential_preLN__softmax_full_mha__swiglu_ffn__prompt_kernel_ld_35
    v_add_u32 v5, 0, v1
    v_mul_u32_u24 v6, 6554, v5
    v_lshrrev_b32 v6, 16, v6
    v_mul_u32_u24 v6, 1120, v6
    v_lshl_add_u32 v16, v5, 4, v6
    v_add_u32 v5, 64, v1
    v_mul_u32_u24 v6, 6554, v5
    v_lshrrev_b32 v6, 16, v6
    v_mul_u32_u24 v6, 1120, v6
    v_lshl_add_u32 v17, v5, 4, v6
    v_add_u32 v5, 128, v1
    v_mul_u32_u24 v6, 6554, v5
    v_lshrrev_b32 v6, 16, v6
    v_mul_u32_u24 v6, 1120, v6
    v_lshl_add_u32 v18, v5, 4, v6
    s_mul_i32 s51, s48, 20480
    s_mul_i32 s52, s49, 160
    s_add_u32 s51, s51, s52
    s_waitcnt lgkmcnt(0)
    s_add_u32 s44, s38, s51
    s_addc_u32 s45, s39, 0
    s_sub_u32 s46, 2621440, s51
    s_mov_b32 s47, 0x20000
    s_mul_i32 s56, s13, 3072
    s_add_u32 s56, s56, 40960
    s_mov_b32 m0, s56
    s_nop 0
    buffer_load_dwordx4 v16, s[44:47], 0 offen lds
    s_add_u32 m0, m0, 1024
    s_nop 0
    buffer_load_dwordx4 v17, s[44:47], 0 offen lds
    s_add_u32 m0, m0, 1024
    s_nop 0
    buffer_load_dwordx4 v18, s[44:47], 0 offen lds
    v_lshrrev_b32 v5, 4, v1
    v_and_b32 v6, 15, v1
    v_lshlrev_b32 v7, 4, v6
    v_lshl_add_u32 v11, v5, 9, v7
    v_lshlrev_b32 v19, 3, v6
    v_lshl_add_u32 v19, v5, 8, v19
    s_lshr_b32 s51, s48, 1
    s_mul_i32 s51, s51, 40
    s_mul_i32 s52, s49, 5
    s_add_u32 s51, s51, s52
    s_lshl_b32 s51, s51, 10
    s_and_b32 s52, s12, 1
    s_lshl_b32 s52, s52, 8
    s_add_u32 s51, s51, s52
    s_add_u32 s57, s51, 10747904
    v_mul_u32_u24 v6, 160, v6
    v_lshl_add_u32 v6, v5, 3, v6
    v_add_u32 v12, s56, v6
    v_add_u32 v13, 73728, v2
    v_add_u32 v14, 135168, v2
    v_add_u32 v15, 0, v2
    s_mul_i32 s53, s48, 20480
    s_add_u32 s53, s53, 8126464
    s_lshr_b32 s15, s48, 4
    s_lshl_b32 s15, s15, 11
    s_add_u32 s15, s15, 13516800
    s_waitcnt vmcnt(0)
    s_barrier
    s_cmp_lg_u32 s12, 0
    s_cbranch_scc1 L_sequential_preLN__softmax_full_mha__swiglu_ffn__prompt_kernel_ns0_37
    v_mov_b32 v5, 1
    v_mov_b32 v6, 0
    s_mov_b64 exec, 1
    buffer_store_dword v5, v6, s[8:11], s14 offen sc1
    s_mov_b64 exec, -1
L_sequential_preLN__softmax_full_mha__swiglu_ffn__prompt_kernel_ns0_37:
    s_mul_i32 s51, s13, 2560
    s_add_u32 s51, s51, 152576
    v_add_u32 v20, s51, v2
    ds_read_b64 v[44:45], v12 offset:0
    ds_read_b64 v[46:47], v12 offset:32
    ds_read_b64 v[48:49], v12 offset:64
    ds_read_b64 v[50:51], v12 offset:96
    ds_read_b64 v[52:53], v12 offset:128
    s_waitcnt lgkmcnt(0)
    v_lshlrev_b32 v24, 16, v44
    v_and_b32 v25, 0xffff0000, v44
    v_lshlrev_b32 v26, 16, v45
    v_and_b32 v27, 0xffff0000, v45
    v_lshlrev_b32 v28, 16, v46
    v_and_b32 v29, 0xffff0000, v46
    v_lshlrev_b32 v30, 16, v47
    v_and_b32 v31, 0xffff0000, v47
    v_lshlrev_b32 v32, 16, v48
    v_and_b32 v33, 0xffff0000, v48
    v_lshlrev_b32 v34, 16, v49
    v_and_b32 v35, 0xffff0000, v49
    v_lshlrev_b32 v36, 16, v50
    v_and_b32 v37, 0xffff0000, v50
    v_lshlrev_b32 v38, 16, v51
    v_and_b32 v39, 0xffff0000, v51
    v_lshlrev_b32 v40, 16, v52
    v_and_b32 v41, 0xffff0000, v52
    v_lshlrev_b32 v42, 16, v53
    v_and_b32 v43, 0xffff0000, v53
    s_cmp_lg_u32 s12, 0
    s_cbranch_scc1 L_sequential_preLN__softmax_full_mha__swiglu_ffn__prompt_kernel_nw0_36
    v_and_b32 v5, 31, v1
    v_lshlrev_b32 v5, 6, v5
    s_mov_b32 s50, 0
L_sequential_preLN__softmax_full_mha__swiglu_ffn__prompt_kernel_poll_38:
    buffer_load_dword v6, v5, s[8:11], s15 offen sc1
    s_waitcnt vmcnt(0)
    v_cmp_ne_u32 vcc, 0, v6
    s_nop 0
    s_cmp_eq_u64 vcc, -1
    s_cbranch_scc1 L_sequential_preLN__softmax_full_mha__swiglu_ffn__prompt_kernel_pollx_39
    s_add_u32 s50, s50, 1
    s_cmp_lt_u32 s50, 0x40000
    s_cbranch_scc1 L_sequential_preLN__softmax_full_mha__swiglu_ffn__prompt_kernel_poll_38
L_sequential_preLN__softmax_full_mha__swiglu_ffn__prompt_kernel_pollx_39:
L_sequential_preLN__softmax_full_mha__swiglu_ffn__prompt_kernel_nw0_36:
    s_barrier
    buffer_load_dwordx4 v[116:119], v2, s[8:11], s53 offen offset:0
    buffer_load_dwordx4 v[120:123], v2, s[8:11], s53 offen offset:1024
    buffer_load_dwordx4 v[124:127], v2, s[8:11], s53 offen offset:2048
    buffer_load_dwordx4 v[128:131], v2, s[8:11], s53 offen offset:3072
    s_add_u32 s53, s53, 4096
    buffer_load_dwordx4 v[132:135], v2, s[8:11], s53 offen offset:0
    buffer_load_dwordx4 v[136:139], v2, s[8:11], s53 offen offset:1024
    ds_read_b128 v[44:47], v13 offset:0
    ds_read_b128 v[48:51], v13 offset:1024
    ds_read_b128 v[52:55], v13 offset:2048
    ds_read_b128 v[56:59], v13 offset:3072
    ds_read_b128 v[60:63], v13 offset:4096
    ds_read_b128 v[64:67], v13 offset:5120
    ds_read_b128 v[68:71], v13 offset:6144
    ds_read_b128 v[72:75], v13 offset:7168
    ds_read_b128 v[76:79], v13 offset:8192
    ds_read_b128 v[80:83], v13 offset:9216
    s_waitcnt vmcnt(5) lgkmcnt(5)
    v_mfma_f32_16x16x32_bf16 v[24:27], v[44:47], v[116:119], v[24:27]
    ds_read_b128 v[84:87], v13 offset:10240
    v_mfma_f32_16x16x32_bf16 v[28:31], v[48:51], v[116:119], v[28:31]
    ds_read_b128 v[88:91], v13 offset:11264
    v_mfma_f32_16x16x32_bf16 v[32:35], v[52:55], v[116:119], v[32:35]
    ds_read_b128 v[92:95], v13 offset:12288
    buffer_load_dwordx4 v[140:143], v2, s[8:11], s53 offen offset:2048
    v_mfma_f32_16x16x32_bf16 v[36:39], v[56:59], v[116:119], v[36:39]
    ds_read_b128 v[96:99], v13 offset:13312
    v_mfma_f32_16x16x32_bf16 v[40:43], v[60:63], v[116:119], v[40:43]
    ds_read_b128 v[100:103], v13 offset:14336
    buffer_load_dwordx4 v[144:147], v2, s[8:11], s53 offen offset:3072
    s_add_u32 s53, s53, 4096
    s_waitcnt vmcnt(6) lgkmcnt(5)
    v_mfma_f32_16x16x32_bf16 v[24:27], v[64:67], v[120:123], v[24:27]
    ds_read_b128 v[44:47], v13 offset:15360
    v_mfma_f32_16x16x32_bf16 v[28:31], v[68:71], v[120:123], v[28:31]
    ds_read_b128 v[48:51], v13 offset:16384
    v_mfma_f32_16x16x32_bf16 v[32:35], v[72:75], v[120:123], v[32:35]
    ds_read_b128 v[52:55], v13 offset:17408
    buffer_load_dwordx4 v[148:151], v2, s[8:11], s53 offen offset:0
    v_mfma_f32_16x16x32_bf16 v[36:39], v[76:79], v[120:123], v[36:39]
    ds_read_b128 v[56:59], v13 offset:18432
    v_mfma_f32_16x16x32_bf16 v[40:43], v[80:83], v[120:123], v[40:43]
    ds_read_b128 v[60:63], v13 offset:19456
    buffer_load_dwordx4 v[152:155], v2, s[8:11], s53 offen offset:1024
    s_waitcnt vmcnt(7) lgkmcnt(5)
    v_mfma_f32_16x16x32_bf16 v[24:27], v[84:87], v[124:127], v[24:27]
    ds_read_b128 v[64:67], v13 offset:20480
    v_mfma_f32_16x16x32_bf16 v[28:31], v[88:91], v[124:127], v[28:31]
    ds_read_b128 v[68:71], v13 offset:21504
    v_mfma_f32_16x16x32_bf16 v[32:35], v[92:95], v[124:127], v[32:35]
    ds_read_b128 v[72:75], v13 offset:22528
    buffer_load_dwordx4 v[156:159], v2, s[8:11], s53 offen offset:2048
    v_mfma_f32_16x16x32_bf16 v[36:39], v[96:99], v[124:127], v[36:39]
    ds_read_b128 v[76:79], v13 offset:23552
    v_mfma_f32_16x16x32_bf16 v[40:43], v[100:103], v[124:127], v[40:43]
    ds_read_b128 v[80:83], v13 offset:24576
    buffer_load_dwordx4 v[160:163], v2, s[8:11], s53 offen offset:3072
    s_add_u32 s53, s53, 4096
    s_waitcnt vmcnt(8) lgkmcnt(5)
    v_mfma_f32_16x16x32_bf16 v[24:27], v[44:47], v[128:131], v[24:27]
    ds_read_b128 v[84:87], v13 offset:25600
    v_mfma_f32_16x16x32_bf16 v[28:31], v[48:51], v[128:131], v[28:31]
    ds_read_b128 v[88:91], v13 offset:26624
    v_mfma_f32_16x16x32_bf16 v[32:35], v[52:55], v[128:131], v[32:35]
    ds_read_b128 v[92:95], v13 offset:27648
    buffer_load_dwordx4 v[164:167], v2, s[8:11], s53 offen offset:0
    v_mfma_f32_16x16x32_bf16 v[36:39], v[56:59], v[128:131], v[36:39]
    ds_read_b128 v[96:99], v13 offset:28672
    v_mfma_f32_16x16x32_bf16 v[40:43], v[60:63], v[128:131], v[40:43]
    ds_read_b128 v[100:103], v13 offset:29696
    buffer_load_dwordx4 v[168:171], v2, s[8:11], s53 offen offset:1024
    s_waitcnt vmcnt(9) lgkmcnt(5)
    v_mfma_f32_16x16x32_bf16 v[24:27], v[64:67], v[132:135], v[24:27]
    ds_read_b128 v[44:47], v13 offset:30720
    v_mfma_f32_16x16x32_bf16 v[28:31], v[68:71], v[132:135], v[28:31]
    ds_read_b128 v[48:51], v13 offset:31744
    v_mfma_f32_16x16x32_bf16 v[32:35], v[72:75], v[132:135], v[32:35]
    ds_read_b128 v[52:55], v13 offset:32768
    buffer_load_dwordx4 v[172:175], v2, s[8:11], s53 offen offset:2048
    v_mfma_f32_16x16x32_bf16 v[36:39], v[76:79], v[132:135], v[36:39]
    ds_read_b128 v[56:59], v13 offset:33792
    v_mfma_f32_16x16x32_bf16 v[40:43], v[80:83], v[132:135], v[40:43]
    ds_read_b128 v[60:63], v13 offset:34816
    buffer_load_dwordx4 v[176:179], v2, s[8:11], s53 offen offset:3072
    s_add_u32 s53, s53, 4096
    s_waitcnt vmcnt(10) lgkmcnt(5)
    v_mfma_f32_16x16x32_bf16 v[24:27], v[84:87], v[136:139], v[24:27]
    ds_read_b128 v[64:67], v13 offset:35840
    v_mfma_f32_16x16x32_bf16 v[28:31], v[88:91], v[136:139], v[28:31]
    ds_read_b128 v[68:71], v13 offset:36864
    v_mfma_f32_16x16x32_bf16 v[32:35], v[92:95], v[136:139], v[32:35]
    ds_read_b128 v[72:75], v13 offset:37888
    buffer_load_dwordx2 v[180:181], v19, s[8:11], s53 offen offset:0
    buffer_load_dwordx2 v[182:183], v19, s[8:11], s53 offen offset:128
    v_mfma_f32_16x16x32_bf16 v[36:39], v[96:99], v[136:139], v[36:39]
    ds_read_b128 v[76:79], v13 offset:38912
    v_mfma_f32_16x16x32_bf16 v[40:43], v[100:103], v[136:139], v[40:43]
    ds_read_b128 v[80:83], v13 offset:39936
    buffer_load_dwordx2 v[184:185], v19, s[8:11], s53 offen offset:1024
    buffer_load_dwordx2 v[186:187], v19, s[8:11], s53 offen offset:1152
    s_waitcnt vmcnt(13) lgkmcnt(5)
    v_mfma_f32_16x16x32_bf16 v[24:27], v[44:47], v[140:143], v[24:27]
    ds_read_b128 v[84:87], v13 offset:40960
    v_mfma_f32_16x16x32_bf16 v[28:31], v[48:51], v[140:143], v[28:31]
    ds_read_b128 v[88:91], v13 offset:41984
    v_mfma_f32_16x16x32_bf16 v[32:35], v[52:55], v[140:143], v[32:35]
    ds_read_b128 v[92:95], v13 offset:43008
    buffer_load_dwordx2 v[188:189], v19, s[8:11], s53 offen offset:2048
    buffer_load_dwordx2 v[190:191], v19, s[8:11], s53 offen offset:2176
    v_mfma_f32_16x16x32_bf16 v[36:39], v[56:59], v[140:143], v[36:39]
    ds_read_b128 v[96:99], v13 offset:44032
    v_mfma_f32_16x16x32_bf16 v[40:43], v[60:63], v[140:143], v[40:43]
    ds_read_b128 v[100:103], v13 offset:45056
    buffer_load_dwordx2 v[192:193], v19, s[8:11], s53 offen offset:3072
    buffer_load_dwordx2 v[194:195], v19, s[8:11], s53 offen offset:3200
    s_waitcnt vmcnt(16) lgkmcnt(5)
    v_mfma_f32_16x16x32_bf16 v[24:27], v[64:67], v[144:147], v[24:27]
    ds_read_b128 v[44:47], v13 offset:46080
    v_mfma_f32_16x16x32_bf16 v[28:31], v[68:71], v[144:147], v[28:31]
    ds_read_b128 v[48:51], v13 offset:47104
    v_mfma_f32_16x16x32_bf16 v[32:35], v[72:75], v[144:147], v[32:35]
    ds_read_b128 v[52:55], v13 offset:48128
    v_mfma_f32_16x16x32_bf16 v[36:39], v[76:79], v[144:147], v[36:39]
    ds_read_b128 v[56:59], v13 offset:49152
    v_mfma_f32_16x16x32_bf16 v[40:43], v[80:83], v[144:147], v[40:43]
    ds_read_b128 v[60:63], v13 offset:50176
    s_waitcnt vmcnt(15) lgkmcnt(5)
    v_mfma_f32_16x16x32_bf16 v[24:27], v[84:87], v[148:151], v[24:27]
    ds_read_b128 v[64:67], v13 offset:51200
    v_mfma_f32_16x16x32_bf16 v[28:31], v[88:91], v[148:151], v[28:31]
    ds_read_b128 v[68:71], v13 offset:52224
    v_mfma_f32_16x16x32_bf16 v[32:35], v[92:95], v[148:151], v[32:35]
    ds_read_b128 v[72:75], v13 offset:53248
    v_mfma_f32_16x16x32_bf16 v[36:39], v[96:99], v[148:151], v[36:39]
    ds_read_b128 v[76:79], v13 offset:54272
    v_mfma_f32_16x16x32_bf16 v[40:43], v[100:103], v[148:151], v[40:43]
    ds_read_b128 v[80:83], v13 offset:55296
    s_waitcnt vmcnt(14) lgkmcnt(5)
    v_mfma_f32_16x16x32_bf16 v[24:27], v[44:47], v[152:155], v[24:27]
    ds_read_b128 v[84:87], v13 offset:56320
    v_mfma_f32_16x16x32_bf16 v[28:31], v[48:51], v[152:155], v[28:31]
    ds_read_b128 v[88:91], v13 offset:57344
    v_mfma_f32_16x16x32_bf16 v[32:35], v[52:55], v[152:155], v[32:35]
    ds_read_b128 v[92:95], v13 offset:58368
    v_mfma_f32_16x16x32_bf16 v[36:39], v[56:59], v[152:155], v[36:39]
    ds_read_b128 v[96:99], v13 offset:59392
    v_mfma_f32_16x16x32_bf16 v[40:43], v[60:63], v[152:155], v[40:43]
    ds_read_b128 v[100:103], v13 offset:60416
    s_waitcnt vmcnt(13) lgkmcnt(5)
    v_mfma_f32_16x16x32_bf16 v[24:27], v[64:67], v[156:159], v[24:27]
    ds_read_b128 v[44:47], v14 offset:0
    v_mfma_f32_16x16x32_bf16 v[28:31], v[68:71], v[156:159], v[28:31]
    ds_read_b128 v[48:51], v14 offset:1024
    v_mfma_f32_16x16x32_bf16 v[32:35], v[72:75], v[156:159], v[32:35]
    ds_read_b128 v[52:55], v14 offset:2048
    v_mfma_f32_16x16x32_bf16 v[36:39], v[76:79], v[156:159], v[36:39]
    ds_read_b128 v[56:59], v14 offset:3072
    v_mfma_f32_16x16x32_bf16 v[40:43], v[80:83], v[156:159], v[40:43]
    ds_read_b128 v[60:63], v14 offset:4096
    s_waitcnt vmcnt(12) lgkmcnt(5)
    v_mfma_f32_16x16x32_bf16 v[24:27], v[84:87], v[160:163], v[24:27]
    ds_read_b128 v[64:67], v14 offset:5120
    v_mfma_f32_16x16x32_bf16 v[28:31], v[88:91], v[160:163], v[28:31]
    ds_read_b128 v[68:71], v14 offset:6144
    v_mfma_f32_16x16x32_bf16 v[32:35], v[92:95], v[160:163], v[32:35]
    ds_read_b128 v[72:75], v14 offset:7168
    v_mfma_f32_16x16x32_bf16 v[36:39], v[96:99], v[160:163], v[36:39]
    ds_read_b128 v[76:79], v14 offset:8192
    v_mfma_f32_16x16x32_bf16 v[40:43], v[100:103], v[160:163], v[40:43]
    ds_read_b128 v[80:83], v14 offset:9216
    s_waitcnt vmcnt(11) lgkmcnt(5)
    v_mfma_f32_16x16x32_bf16 v[24:27], v[44:47], v[164:167], v[24:27]
    ds_read_b128 v[84:87], v14 offset:10240
    v_mfma_f32_16x16x32_bf16 v[28:31], v[48:51], v[164:167], v[28:31]
    ds_read_b128 v[88:91], v14 offset:11264
    v_mfma_f32_16x16x32_bf16 v[32:35], v[52:55], v[164:167], v[32:35]
    ds_read_b128 v[92:95], v14 offset:12288
    v_mfma_f32_16x16x32_bf16 v[36:39], v[56:59], v[164:167], v[36:39]
    ds_read_b128 v[96:99], v14 offset:13312
    v_mfma_f32_16x16x32_bf16 v[40:43], v[60:63], v[164:167], v[40:43]
    ds_read_b128 v[100:103], v14 offset:14336
    s_waitcnt vmcnt(10) lgkmcnt(5)
    v_mfma_f32_16x16x32_bf16 v[24:27], v[64:67], v[168:171], v[24:27]
    ds_read_b128 v[44:47], v14 offset:15360
    v_mfma_f32_16x16x32_bf16 v[28:31], v[68:71], v[168:171], v[28:31]
    ds_read_b128 v[48:51], v14 offset:16384
    v_mfma_f32_16x16x32_bf16 v[32:35], v[72:75], v[168:171], v[32:35]
    ds_read_b128 v[52:55], v14 offset:17408
    v_mfma_f32_16x16x32_bf16 v[36:39], v[76:79], v[168:171], v[36:39]
    ds_read_b128 v[56:59], v14 offset:18432
    v_mfma_f32_16x16x32_bf16 v[40:43], v[80:83], v[168:171], v[40:43]
    ds_read_b128 v[60:63], v14 offset:19456
    s_waitcnt vmcnt(9) lgkmcnt(5)
    v_mfma_f32_16x16x32_bf16 v[24:27], v[84:87], v[172:175], v[24:27]
    ds_read_b128 v[64:67], v15 offset:0
    v_mfma_f32_16x16x32_bf16 v[28:31], v[88:91], v[172:175], v[28:31]
    ds_read_b128 v[68:71], v15 offset:1024
    v_mfma_f32_16x16x32_bf16 v[32:35], v[92:95], v[172:175], v[32:35]
    ds_read_b128 v[72:75], v15 offset:2048
    v_mfma_f32_16x16x32_bf16 v[36:39], v[96:99], v[172:175], v[36:39]
    ds_read_b128 v[76:79], v15 offset:3072
    v_mfma_f32_16x16x32_bf16 v[40:43], v[100:103], v[172:175], v[40:43]
    ds_read_b128 v[80:83], v15 offset:4096
    s_waitcnt vmcnt(8) lgkmcnt(5)
    v_mfma_f32_16x16x32_bf16 v[24:27], v[44:47], v[176:179], v[24:27]
    ds_read_b128 v[84:87], v15 offset:5120
    v_mfma_f32_16x16x32_bf16 v[28:31], v[48:51], v[176:179], v[28:31]
    ds_read_b128 v[88:91], v15 offset:6144
    v_mfma_f32_16x16x32_bf16 v[32:35], v[52:55], v[176:179], v[32:35]
    ds_read_b128 v[92:95], v15 offset:7168
    v_mfma_f32_16x16x32_bf16 v[36:39], v[56:59], v[176:179], v[36:39]
    ds_read_b128 v[96:99], v15 offset:8192
    v_mfma_f32_16x16x32_bf16 v[40:43], v[60:63], v[176:179], v[40:43]
    ds_read_b128 v[100:103], v15 offset:9216
    s_waitcnt vmcnt(6) lgkmcnt(5)
    v_mfma_f32_16x16x32_bf16 v[24:27], v[64:67], v[180:183], v[24:27]
    ds_read_b128 v[44:47], v15 offset:10240
    v_mfma_f32_16x16x32_bf16 v[28:31], v[68:71], v[180:183], v[28:31]
    ds_read_b128 v[48:51], v15 offset:11264
    v_mfma_f32_16x16x32_bf16 v[32:35], v[72:75], v[180:183], v[32:35]
    ds_read_b128 v[52:55], v15 offset:12288
    v_mfma_f32_16x16x32_bf16 v[36:39], v[76:79], v[180:183], v[36:39]
    ds_read_b128 v[56:59], v15 offset:13312
    v_mfma_f32_16x16x32_bf16 v[40:43], v[80:83], v[180:183], v[40:43]
    ds_read_b128 v[60:63], v15 offset:14336
    s_waitcnt vmcnt(4) lgkmcnt(5)
    v_mfma_f32_16x16x32_bf16 v[24:27], v[84:87], v[184:187], v[24:27]
    ds_read_b128 v[64:67], v15 offset:15360
    v_mfma_f32_16x16x32_bf16 v[28:31], v[88:91], v[184:187], v[28:31]
    ds_read_b128 v[68:71], v15 offset:16384
    v_mfma_f32_16x16x32_bf16 v[32:35], v[92:95], v[184:187], v[32:35]
    ds_read_b128 v[72:75], v15 offset:17408
    v_mfma_f32_16x16x32_bf16 v[36:39], v[96:99], v[184:187], v[36:39]
    ds_read_b128 v[76:79], v15 offset:18432
    v_mfma_f32_16x16x32_bf16 v[40:43], v[100:103], v[184:187], v[40:43]
    ds_read_b128 v[80:83], v15 offset:19456
    s_waitcnt vmcnt(2) lgkmcnt(5)
    v_mfma_f32_16x16x32_bf16 v[24:27], v[44:47], v[188:191], v[24:27]
    v_mfma_f32_16x16x32_bf16 v[28:31], v[48:51], v[188:191], v[28:31]
    v_mfma_f32_16x16x32_bf16 v[32:35], v[52:55], v[188:191], v[32:35]
    v_mfma_f32_16x16x32_bf16 v[36:39], v[56:59], v[188:191], v[36:39]
    v_mfma_f32_16x16x32_bf16 v[40:43], v[60:63], v[188:191], v[40:43]
    s_waitcnt vmcnt(0) lgkmcnt(0)
    v_mfma_f32_16x16x32_bf16 v[24:27], v[64:67], v[192:195], v[24:27]
    v_mfma_f32_16x16x32_bf16 v[28:31], v[68:71], v[192:195], v[28:31]
    v_mfma_f32_16x16x32_bf16 v[32:35], v[72:75], v[192:195], v[32:35]
    v_mfma_f32_16x16x32_bf16 v[36:39], v[76:79], v[192:195], v[36:39]
    v_mfma_f32_16x16x32_bf16 v[40:43], v[80:83], v[192:195], v[40:43]
    s_mov_b32 s58, 0x3f803f80
    v_mov_b32 v5, 0
    v_mov_b32 v6, 0
    v_mov_b32 v74, 0
    v_mov_b32 v75, 0
    v_cvt_pk_bf16_f32 v64, v24, v25
    v_cvt_pk_bf16_f32 v65, v26, v27
    v_cvt_pk_bf16_f32 v66, v28, v29
    v_cvt_pk_bf16_f32 v67, v30, v31
    v_cvt_pk_bf16_f32 v68, v32, v33
    v_cvt_pk_bf16_f32 v69, v34, v35
    v_cvt_pk_bf16_f32 v70, v36, v37
    v_cvt_pk_bf16_f32 v71, v38, v39
    v_cvt_pk_bf16_f32 v72, v40, v41
    v_cvt_pk_bf16_f32 v73, v42, v43
    v_permlane32_swap_b32 v64, v66
    v_permlane32_swap_b32 v65, v67
    v_permlane32_swap_b32 v68, v70
    v_permlane32_swap_b32 v69, v71
    v_permlane32_swap_b32 v72, v74
    v_permlane32_swap_b32 v73, v75
    s_add_u32 s51, s57, 4096
    buffer_store_dwordx4 v[64:67], v11, s[8:11], s57 offen sc1
    buffer_store_dwordx4 v[68:71], v11, s[8:11], s57 offen offset:2048 sc1
    s_mov_b32 exec_hi, 0
    buffer_store_dwordx4 v[72:75], v11, s[8:11], s51 offen sc1
    s_mov_b32 exec_hi, -1
    s_barrier
    ds_write_b128 v20, v[64:67]
    ds_write_b128 v20, v[68:71] offset:1024
    s_mov_b32 exec_hi, 0
    ds_write_b128 v20, v[72:75] offset:2048
    s_mov_b32 exec_hi, -1
    v_dot2c_f32_bf16 v5, s58, v64
    v_dot2c_f32_bf16 v6, v64, v64
    v_dot2c_f32_bf16 v5, s58, v65
    v_dot2c_f32_bf16 v6, v65, v65
    v_dot2c_f32_bf16 v5, s58, v66
    v_dot2c_f32_bf16 v6, v66, v66
    v_dot2c_f32_bf16 v5, s58, v67
    v_dot2c_f32_bf16 v6, v67, v67
    v_dot2c_f32_bf16 v5, s58, v68
    v_dot2c_f32_bf16 v6, v68, v68
    v_dot2c_f32_bf16 v5, s58, v69
    v_dot2c_f32_bf16 v6, v69, v69
    v_dot2c_f32_bf16 v5, s58, v70
    v_dot2c_f32_bf16 v6, v70, v70
    v_dot2c_f32_bf16 v5, s58, v71
    v_dot2c_f32_bf16 v6, v71, v71
    v_dot2c_f32_bf16 v5, s58, v72
    v_dot2c_f32_bf16 v6, v72, v72
    v_dot2c_f32_bf16 v5, s58, v73
    v_dot2c_f32_bf16 v6, v73, v73
    v_dot2c_f32_bf16 v5, s58, v74
    v_dot2c_f32_bf16 v6, v74, v74
    v_dot2c_f32_bf16 v5, s58, v75
    v_dot2c_f32_bf16 v6, v75, v75
    s_nop 1
    v_mov_b32 v7, v5
    v_mov_b32 v8, v6
    s_nop 0
    v_permlane32_swap_b32 v7, v5
    v_permlane32_swap_b32 v8, v6
    v_add_f32 v5, v5, v7
    v_add_f32 v6, v6, v8
    v_mov_b32 v7, v5
    v_mov_b32 v8, v6
    s_nop 0
    v_permlane16_swap_b32 v7, v5
    v_permlane16_swap_b32 v8, v6
    v_add_f32 v24, v5, v7
    v_add_f32 v25, v6, v8
    v_lshlrev_b32 v9, 3, v1
    s_lshl_b32 s52, s49, 14
    s_lshl_b32 s50, s48, 7
    s_add_u32 s52, s52, s50
    s_add_u32 s52, s52, 13369344
    s_mov_b64 exec, 0xffff
    buffer_store_dwordx2 v[24:25], v9, s[8:11], s52 offen sc1
    s_mov_b64 exec, -1
    s_lshr_b32 s14, s48, 3
    s_lshl_b32 s14, s14, 5
    s_bfe_u32 s50, s48, 0x10002
    s_lshl_b32 s50, s50, 3
    s_add_u32 s14, s14, s50
    s_add_u32 s14, s14, s49
    s_lshl_b32 s14, s14, 6
    s_add_u32 s14, s14, 13533184
    s_and_b32 s39, s2, 1
    s_lshl_b32 s39, s39, 3
    s_bfe_u32 s40, s2, 0x30003
    s_add_u32 s37, s39, s40
    s_lshl_b32 s37, s37, 2
    s_add_u32 s37, s37, s13
    s_bfe_u32 s39, s2, 0x20001
    s_lshl_b32 s39, s39, 2
    s_lshr_b32 s40, s2, 6
    s_add_u32 s38, s39, s40
    v_mov_b32 v9, v2
    v_add_u32 v10, 57344, v2
    v_add_u32 v11, 114688, v2
    s_mul_i32 s42, s37, 40960
    s_add_u32 s42, s42, 10747904
    v_and_b32 v5, 31, v1
    v_lshrrev_b32 v6, 5, v1
    v_lshlrev_b32 v7, 3, v5
    v_lshl_add_u32 v7, v6, 12, v7
    s_lshl_b32 s39, s13, 8
    s_add_u32 s39, s39, 144384
    v_add_u32 v7, s39, v7
    s_lshr_b32 s15, s37, 2
    s_lshl_b32 s15, s15, 11
    s_add_u32 s15, s15, 13533184
    s_waitcnt vmcnt(0)
    s_barrier
    s_cmp_lg_u32 s12, 0
    s_cbranch_scc1 L_sequential_preLN__softmax_full_mha__swiglu_ffn__prompt_kernel_ns0_41
    v_mov_b32 v12, 1
    v_mov_b32 v13, 0
    s_mov_b64 exec, 1
    buffer_store_dword v12, v13, s[8:11], s14 offen sc1
    s_mov_b64 exec, -1
L_sequential_preLN__softmax_full_mha__swiglu_ffn__prompt_kernel_ns0_41:
    s_cmp_lg_u32 s12, 0
    s_cbranch_scc1 L_sequential_preLN__softmax_full_mha__swiglu_ffn__prompt_kernel_nw0_40
    v_and_b32 v12, 15, v1
    v_lshlrev_b32 v12, 6, v12
    s_mov_b32 s40, 0
L_sequential_preLN__softmax_full_mha__swiglu_ffn__prompt_kernel_poll_42:
    buffer_load_dword v13, v12, s[8:11], s15 offen sc1
    s_waitcnt vmcnt(0)
    v_cmp_ne_u32 vcc, 0, v13
    s_nop 0
    s_cmp_eq_u64 vcc, -1
    s_cbranch_scc1 L_sequential_preLN__softmax_full_mha__swiglu_ffn__prompt_kernel_pollx_43
    s_add_u32 s40, s40, 1
    s_cmp_lt_u32 s40, 0x40000
    s_cbranch_scc1 L_sequential_preLN__softmax_full_mha__swiglu_ffn__prompt_kernel_poll_42
L_sequential_preLN__softmax_full_mha__swiglu_ffn__prompt_kernel_pollx_43:
L_sequential_preLN__softmax_full_mha__swiglu_ffn__prompt_kernel_nw0_40:
    s_barrier
    buffer_load_dwordx4 v[196:199], v2, s[8:11], s42 offen offset:0
    buffer_load_dwordx4 v[200:203], v2, s[8:11], s42 offen offset:1024
    buffer_load_dwordx4 v[204:207], v2, s[8:11], s42 offen offset:2048
    buffer_load_dwordx4 v[208:211], v2, s[8:11], s42 offen offset:3072
    s_add_u32 s42, s42, 4096
    ds_read_b128 v[140:143], v9 offset:0
    ds_read_b128 v[144:147], v9 offset:1024
    ds_read_b128 v[148:151], v9 offset:2048
    ds_read_b128 v[152:155], v9 offset:3072
    ds_read_b128 v[156:159], v9 offset:4096
    ds_read_b128 v[160:163], v9 offset:5120
    ds_read_b128 v[164:167], v9 offset:6144
    s_waitcnt vmcnt(3) lgkmcnt(0)
    v_mfma_f32_32x32x16_bf16 v[28:43], v[140:143], v[196:199], 0
    ds_read_b128 v[168:171], v9 offset:7168
    ds_read_b128 v[172:175], v9 offset:8192
    v_mfma_f32_32x32x16_bf16 v[44:59], v[144:147], v[196:199], 0
    ds_read_b128 v[176:179], v9 offset:9216
    ds_read_b128 v[180:183], v9 offset:10240
    v_mfma_f32_32x32x16_bf16 v[60:75], v[148:151], v[196:199], 0
    ds_read_b128 v[184:187], v9 offset:11264
    ds_read_b128 v[188:191], v9 offset:12288
    v_mfma_f32_32x32x16_bf16 v[76:91], v[152:155], v[196:199], 0
    ds_read_b128 v[192:195], v9 offset:13312
    v_mfma_f32_32x32x16_bf16 v[92:107], v[156:159], v[196:199], 0
    v_mfma_f32_32x32x16_bf16 v[108:123], v[160:163], v[196:199], 0
    buffer_load_dwordx4 v[212:215], v2, s[8:11], s42 offen offset:0
    v_mfma_f32_32x32x16_bf16 v[124:139], v[164:167], v[196:199], 0
    buffer_load_dwordx4 v[216:219], v2, s[8:11], s42 offen offset:1024
    s_waitcnt vmcnt(4) lgkmcnt(0)
    v_mfma_f32_32x32x16_bf16 v[28:43], v[168:171], v[200:203], v[28:43]
    ds_read_b128 v[140:143], v9 offset:14336
    ds_read_b128 v[144:147], v9 offset:15360
    v_mfma_f32_32x32x16_bf16 v[44:59], v[172:175], v[200:203], v[44:59]
    ds_read_b128 v[148:151], v9 offset:16384
    ds_read_b128 v[152:155], v9 offset:17408
    v_mfma_f32_32x32x16_bf16 v[60:75], v[176:179], v[200:203], v[60:75]
    ds_read_b128 v[156:159], v9 offset:18432
    ds_read_b128 v[160:163], v9 offset:19456
    v_mfma_f32_32x32x16_bf16 v[76:91], v[180:183], v[200:203], v[76:91]
    ds_read_b128 v[164:167], v9 offset:20480
    v_mfma_f32_32x32x16_bf16 v[92:107], v[184:187], v[200:203], v[92:107]
    v_mfma_f32_32x32x16_bf16 v[108:123], v[188:191], v[200:203], v[108:123]
    buffer_load_dwordx4 v[220:223], v2, s[8:11], s42 offen offset:2048
    v_mfma_f32_32x32x16_bf16 v[124:139], v[192:195], v[200:203], v[124:139]
    buffer_load_dwordx4 v[224:227], v2, s[8:11], s42 offen offset:3072
    s_add_u32 s42, s42, 4096
    s_waitcnt vmcnt(5) lgkmcnt(0)
    v_mfma_f32_32x32x16_bf16 v[28:43], v[140:143], v[204:207], v[28:43]
    ds_read_b128 v[168:171], v9 offset:21504
    ds_read_b128 v[172:175], v9 offset:22528
    v_mfma_f32_32x32x16_bf16 v[44:59], v[144:147], v[204:207], v[44:59]
    ds_read_b128 v[176:179], v9 offset:23552
    ds_read_b128 v[180:183], v9 offset:24576
    v_mfma_f32_32x32x16_bf16 v[60:75], v[148:151], v[204:207], v[60:75]
    ds_read_b128 v[184:187], v9 offset:25600
    ds_read_b128 v[188:191], v9 offset:26624
    v_mfma_f32_32x32x16_bf16 v[76:91], v[152:155], v[204:207], v[76:91]
    ds_read_b128 v[192:195], v9 offset:27648
    v_mfma_f32_32x32x16_bf16 v[92:107], v[156:159], v[204:207], v[92:107]
    v_mfma_f32_32x32x16_bf16 v[108:123], v[160:163], v[204:207], v[108:123]
    buffer_load_dwordx4 v[228:231], v2, s[8:11], s42 offen offset:0
    v_mfma_f32_32x32x16_bf16 v[124:139], v[164:167], v[204:207], v[124:139]
    buffer_load_dwordx4 v[232:235], v2, s[8:11], s42 offen offset:1024
    s_waitcnt vmcnt(6) lgkmcnt(0)
    v_mfma_f32_32x32x16_bf16 v[28:43], v[168:171], v[208:211], v[28:43]
    v_mfma_f32_32x32x16_bf16 v[44:59], v[172:175], v[208:211], v[44:59]
    s_barrier
    ds_read_b128 v[140:143], v9 offset:28672
    ds_read_b128 v[144:147], v9 offset:29696
    v_mfma_f32_32x32x16_bf16 v[60:75], v[176:179], v[208:211], v[60:75]
    ds_read_b128 v[148:151], v9 offset:30720
    ds_read_b128 v[152:155], v9 offset:31744
    v_mfma_f32_32x32x16_bf16 v[76:91], v[180:183], v[208:211], v[76:91]
    ds_read_b128 v[156:159], v9 offset:32768
    ds_read_b128 v[160:163], v9 offset:33792
    v_mfma_f32_32x32x16_bf16 v[92:107], v[184:187], v[208:211], v[92:107]
    ds_read_b128 v[164:167], v9 offset:34816
    v_mfma_f32_32x32x16_bf16 v[108:123], v[188:191], v[208:211], v[108:123]
    buffer_load_dwordx4 v[236:239], v2, s[8:11], s42 offen offset:2048
    v_mfma_f32_32x32x16_bf16 v[124:139], v[192:195], v[208:211], v[124:139]
    buffer_load_dwordx4 v[240:243], v2, s[8:11], s42 offen offset:3072
    s_add_u32 s42, s42, 4096
    s_waitcnt vmcnt(7) lgkmcnt(0)
    v_mfma_f32_32x32x16_bf16 v[28:43], v[140:143], v[212:215], v[28:43]
    ds_read_b128 v[168:171], v9 offset:35840
    ds_read_b128 v[172:175], v9 offset:36864
    v_mfma_f32_32x32x16_bf16 v[44:59], v[144:147], v[212:215], v[44:59]
    ds_read_b128 v[176:179], v9 offset:37888
    ds_read_b128 v[180:183], v9 offset:38912
    v_mfma_f32_32x32x16_bf16 v[60:75], v[148:151], v[212:215], v[60:75]
    ds_read_b128 v[184:187], v9 offset:39936
    ds_read_b128 v[188:191], v9 offset:40960
    v_mfma_f32_32x32x16_bf16 v[76:91], v[152:155], v[212:215], v[76:91]
    ds_read_b128 v[192:195], v9 offset:41984
    v_mfma_f32_32x32x16_bf16 v[92:107], v[156:159], v[212:215], v[92:107]
    v_mfma_f32_32x32x16_bf16 v[108:123], v[160:163], v[212:215], v[108:123]
    v_mfma_f32_32x32x16_bf16 v[124:139], v[164:167], v[212:215], v[124:139]
    s_waitcnt vmcnt(6) lgkmcnt(0)
    v_mfma_f32_32x32x16_bf16 v[28:43], v[168:171], v[216:219], v[28:43]
    ds_read_b128 v[140:143], v9 offset:43008
    ds_read_b128 v[144:147], v9 offset:44032
    v_mfma_f32_32x32x16_bf16 v[44:59], v[172:175], v[216:219], v[44:59]
    ds_read_b128 v[148:151], v9 offset:45056
    ds_read_b128 v[152:155], v9 offset:46080
    v_mfma_f32_32x32x16_bf16 v[60:75], v[176:179], v[216:219], v[60:75]
    ds_read_b128 v[156:159], v9 offset:47104
    ds_read_b128 v[160:163], v9 offset:48128
    v_mfma_f32_32x32x16_bf16 v[76:91], v[180:183], v[216:219], v[76:91]
    ds_read_b128 v[164:167], v9 offset:49152
    buffer_load_dwordx4 v[196:199], v2, s[8:11], s42 offen offset:0
    v_mfma_f32_32x32x16_bf16 v[92:107], v[184:187], v[216:219], v[92:107]
    v_mfma_f32_32x32x16_bf16 v[108:123], v[188:191], v[216:219], v[108:123]
    buffer_load_dwordx4 v[200:203], v2, s[8:11], s42 offen offset:1024
    v_mfma_f32_32x32x16_bf16 v[124:139], v[192:195], v[216:219], v[124:139]
    s_waitcnt vmcnt(7) lgkmcnt(0)
    v_mfma_f32_32x32x16_bf16 v[28:43], v[140:143], v[220:223], v[28:43]
    ds_read_b128 v[168:171], v9 offset:50176
    ds_read_b128 v[172:175], v9 offset:51200
    v_mfma_f32_32x32x16_bf16 v[44:59], v[144:147], v[220:223], v[44:59]
    ds_read_b128 v[176:179], v9 offset:52224
    ds_read_b128 v[180:183], v9 offset:53248
    v_mfma_f32_32x32x16_bf16 v[60:75], v[148:151], v[220:223], v[60:75]
    ds_read_b128 v[184:187], v9 offset:54272
    ds_read_b128 v[188:191], v9 offset:55296
    v_mfma_f32_32x32x16_bf16 v[76:91], v[152:155], v[220:223], v[76:91]
    ds_read_b128 v[192:195], v9 offset:56320
    buffer_load_dwordx4 v[204:207], v2, s[8:11], s42 offen offset:2048
    v_mfma_f32_32x32x16_bf16 v[92:107], v[156:159], v[220:223], v[92:107]
    v_mfma_f32_32x32x16_bf16 v[108:123], v[160:163], v[220:223], v[108:123]
    buffer_load_dwordx4 v[208:211], v2, s[8:11], s42 offen offset:3072
    s_add_u32 s42, s42, 4096
    v_mfma_f32_32x32x16_bf16 v[124:139], v[164:167], v[220:223], v[124:139]
    s_waitcnt vmcnt(8) lgkmcnt(0)
    v_mfma_f32_32x32x16_bf16 v[28:43], v[168:171], v[224:227], v[28:43]
    v_mfma_f32_32x32x16_bf16 v[44:59], v[172:175], v[224:227], v[44:59]
    s_barrier
    ds_read_b128 v[140:143], v10 offset:0
    ds_read_b128 v[144:147], v10 offset:1024
    v_mfma_f32_32x32x16_bf16 v[60:75], v[176:179], v[224:227], v[60:75]
    ds_read_b128 v[148:151], v10 offset:2048
    ds_read_b128 v[152:155], v10 offset:3072
    v_mfma_f32_32x32x16_bf16 v[76:91], v[180:183], v[224:227], v[76:91]
    ds_read_b128 v[156:159], v10 offset:4096
    ds_read_b128 v[160:163], v10 offset:5120
    v_mfma_f32_32x32x16_bf16 v[92:107], v[184:187], v[224:227], v[92:107]
    ds_read_b128 v[164:167], v10 offset:6144
    v_mfma_f32_32x32x16_bf16 v[108:123], v[188:191], v[224:227], v[108:123]
    v_mfma_f32_32x32x16_bf16 v[124:139], v[192:195], v[224:227], v[124:139]
    s_waitcnt vmcnt(7) lgkmcnt(0)
    v_mfma_f32_32x32x16_bf16 v[28:43], v[140:143], v[228:231], v[28:43]
    ds_read_b128 v[168:171], v10 offset:7168
    ds_read_b128 v[172:175], v10 offset:8192
    v_mfma_f32_32x32x16_bf16 v[44:59], v[144:147], v[228:231], v[44:59]
    ds_read_b128 v[176:179], v10 offset:9216
    ds_read_b128 v[180:183], v10 offset:10240
    v_mfma_f32_32x32x16_bf16 v[60:75], v[148:151], v[228:231], v[60:75]
    ds_read_b128 v[184:187], v10 offset:11264
    ds_read_b128 v[188:191], v10 offset:12288
    v_mfma_f32_32x32x16_bf16 v[76:91], v[152:155], v[228:231], v[76:91]
    ds_read_b128 v[192:195], v10 offset:13312
    v_mfma_f32_32x32x16_bf16 v[92:107], v[156:159], v[228:231], v[92:107]
    v_mfma_f32_32x32x16_bf16 v[108:123], v[160:163], v[228:231], v[108:123]
    v_mfma_f32_32x32x16_bf16 v[124:139], v[164:167], v[228:231], v[124:139]
    s_waitcnt vmcnt(6) lgkmcnt(0)
    v_mfma_f32_32x32x16_bf16 v[28:43], v[168:171], v[232:235], v[28:43]
    ds_read_b128 v[140:143], v10 offset:14336
    ds_read_b128 v[144:147], v10 offset:15360
    v_mfma_f32_32x32x16_bf16 v[44:59], v[172:175], v[232:235], v[44:59]
    ds_read_b128 v[148:151], v10 offset:16384
    ds_read_b128 v[152:155], v10 offset:17408
    v_mfma_f32_32x32x16_bf16 v[60:75], v[176:179], v[232:235], v[60:75]
    ds_read_b128 v[156:159], v10 offset:18432
    ds_read_b128 v[160:163], v10 offset:19456
    v_mfma_f32_32x32x16_bf16 v[76:91], v[180:183], v[232:235], v[76:91]
    ds_read_b128 v[164:167], v10 offset:20480
    buffer_load_dwordx4 v[212:215], v2, s[8:11], s42 offen offset:0
    v_mfma_f32_32x32x16_bf16 v[92:107], v[184:187], v[232:235], v[92:107]
    v_mfma_f32_32x32x16_bf16 v[108:123], v[188:191], v[232:235], v[108:123]
    buffer_load_dwordx4 v[216:219], v2, s[8:11], s42 offen offset:1024
    v_mfma_f32_32x32x16_bf16 v[124:139], v[192:195], v[232:235], v[124:139]
    s_waitcnt vmcnt(7) lgkmcnt(0)
    v_mfma_f32_32x32x16_bf16 v[28:43], v[140:143], v[236:239], v[28:43]
    ds_read_b128 v[168:171], v10 offset:21504
    ds_read_b128 v[172:175], v10 offset:22528
    v_mfma_f32_32x32x16_bf16 v[44:59], v[144:147], v[236:239], v[44:59]
    ds_read_b128 v[176:179], v10 offset:23552
    ds_read_b128 v[180:183], v10 offset:24576
    v_mfma_f32_32x32x16_bf16 v[60:75], v[148:151], v[236:239], v[60:75]
    ds_read_b128 v[184:187], v10 offset:25600
    ds_read_b128 v[188:191], v10 offset:26624
    v_mfma_f32_32x32x16_bf16 v[76:91], v[152:155], v[236:239], v[76:91]
    ds_read_b128 v[192:195], v10 offset:27648
    buffer_load_dwordx4 v[220:223], v2, s[8:11], s42 offen offset:2048
    v_mfma_f32_32x32x16_bf16 v[92:107], v[156:159], v[236:239], v[92:107]
    v_mfma_f32_32x32x16_bf16 v[108:123], v[160:163], v[236:239], v[108:123]
    buffer_load_dwordx4 v[224:227], v2, s[8:11], s42 offen offset:3072
    s_add_u32 s42, s42, 4096
    v_mfma_f32_32x32x16_bf16 v[124:139], v[164:167], v[236:239], v[124:139]
    s_waitcnt vmcnt(8) lgkmcnt(0)
    v_mfma_f32_32x32x16_bf16 v[28:43], v[168:171], v[240:243], v[28:43]
    v_mfma_f32_32x32x16_bf16 v[44:59], v[172:175], v[240:243], v[44:59]
    s_barrier
    ds_read_b128 v[140:143], v10 offset:28672
    ds_read_b128 v[144:147], v10 offset:29696
    v_mfma_f32_32x32x16_bf16 v[60:75], v[176:179], v[240:243], v[60:75]
    ds_read_b128 v[148:151], v10 offset:30720
    ds_read_b128 v[152:155], v10 offset:31744
    v_mfma_f32_32x32x16_bf16 v[76:91], v[180:183], v[240:243], v[76:91]
    ds_read_b128 v[156:159], v10 offset:32768
    ds_read_b128 v[160:163], v10 offset:33792
    v_mfma_f32_32x32x16_bf16 v[92:107], v[184:187], v[240:243], v[92:107]
    ds_read_b128 v[164:167], v10 offset:34816
    v_mfma_f32_32x32x16_bf16 v[108:123], v[188:191], v[240:243], v[108:123]
    v_mfma_f32_32x32x16_bf16 v[124:139], v[192:195], v[240:243], v[124:139]
    s_waitcnt vmcnt(7) lgkmcnt(0)
    v_mfma_f32_32x32x16_bf16 v[28:43], v[140:143], v[196:199], v[28:43]
    ds_read_b128 v[168:171], v10 offset:35840
    ds_read_b128 v[172:175], v10 offset:36864
    v_mfma_f32_32x32x16_bf16 v[44:59], v[144:147], v[196:199], v[44:59]
    ds_read_b128 v[176:179], v10 offset:37888
    ds_read_b128 v[180:183], v10 offset:38912
    v_mfma_f32_32x32x16_bf16 v[60:75], v[148:151], v[196:199], v[60:75]
    ds_read_b128 v[184:187], v10 offset:39936
    ds_read_b128 v[188:191], v10 offset:40960
    v_mfma_f32_32x32x16_bf16 v[76:91], v[152:155], v[196:199], v[76:91]
    ds_read_b128 v[192:195], v10 offset:41984
    v_mfma_f32_32x32x16_bf16 v[92:107], v[156:159], v[196:199], v[92:107]
    v_mfma_f32_32x32x16_bf16 v[108:123], v[160:163], v[196:199], v[108:123]
    v_mfma_f32_32x32x16_bf16 v[124:139], v[164:167], v[196:199], v[124:139]
    s_waitcnt vmcnt(6) lgkmcnt(0)
    v_mfma_f32_32x32x16_bf16 v[28:43], v[168:171], v[200:203], v[28:43]
    ds_read_b128 v[140:143], v10 offset:43008
    ds_read_b128 v[144:147], v10 offset:44032
    v_mfma_f32_32x32x16_bf16 v[44:59], v[172:175], v[200:203], v[44:59]
    ds_read_b128 v[148:151], v10 offset:45056
    ds_read_b128 v[152:155], v10 offset:46080
    v_mfma_f32_32x32x16_bf16 v[60:75], v[176:179], v[200:203], v[60:75]
    ds_read_b128 v[156:159], v10 offset:47104
    ds_read_b128 v[160:163], v10 offset:48128
    v_mfma_f32_32x32x16_bf16 v[76:91], v[180:183], v[200:203], v[76:91]
    ds_read_b128 v[164:167], v10 offset:49152
    buffer_load_dwordx4 v[228:231], v2, s[8:11], s42 offen offset:0
    v_mfma_f32_32x32x16_bf16 v[92:107], v[184:187], v[200:203], v[92:107]
    v_mfma_f32_32x32x16_bf16 v[108:123], v[188:191], v[200:203], v[108:123]
    buffer_load_dwordx4 v[232:235], v2, s[8:11], s42 offen offset:1024
    v_mfma_f32_32x32x16_bf16 v[124:139], v[192:195], v[200:203], v[124:139]
    s_waitcnt vmcnt(7) lgkmcnt(0)
    v_mfma_f32_32x32x16_bf16 v[28:43], v[140:143], v[204:207], v[28:43]
    ds_read_b128 v[168:171], v10 offset:50176
    ds_read_b128 v[172:175], v10 offset:51200
    v_mfma_f32_32x32x16_bf16 v[44:59], v[144:147], v[204:207], v[44:59]
    ds_read_b128 v[176:179], v10 offset:52224
    ds_read_b128 v[180:183], v10 offset:53248
    v_mfma_f32_32x32x16_bf16 v[60:75], v[148:151], v[204:207], v[60:75]
    ds_read_b128 v[184:187], v10 offset:54272
    ds_read_b128 v[188:191], v10 offset:55296
    v_mfma_f32_32x32x16_bf16 v[76:91], v[152:155], v[204:207], v[76:91]
    ds_read_b128 v[192:195], v10 offset:56320
    buffer_load_dwordx4 v[236:239], v2, s[8:11], s42 offen offset:2048
    v_mfma_f32_32x32x16_bf16 v[92:107], v[156:159], v[204:207], v[92:107]
    v_mfma_f32_32x32x16_bf16 v[108:123], v[160:163], v[204:207], v[108:123]
    buffer_load_dwordx4 v[240:243], v2, s[8:11], s42 offen offset:3072
    s_add_u32 s42, s42, 4096
    v_mfma_f32_32x32x16_bf16 v[124:139], v[164:167], v[204:207], v[124:139]
    s_waitcnt vmcnt(8) lgkmcnt(0)
    v_mfma_f32_32x32x16_bf16 v[28:43], v[168:171], v[208:211], v[28:43]
    v_mfma_f32_32x32x16_bf16 v[44:59], v[172:175], v[208:211], v[44:59]
    s_barrier
    ds_read_b128 v[140:143], v11 offset:0
    ds_read_b128 v[144:147], v11 offset:1024
    v_mfma_f32_32x32x16_bf16 v[60:75], v[176:179], v[208:211], v[60:75]
    ds_read_b128 v[148:151], v11 offset:2048
    ds_read_b128 v[152:155], v11 offset:3072
    v_mfma_f32_32x32x16_bf16 v[76:91], v[180:183], v[208:211], v[76:91]
    ds_read_b128 v[156:159], v11 offset:4096
    ds_read_b128 v[160:163], v11 offset:5120
    v_mfma_f32_32x32x16_bf16 v[92:107], v[184:187], v[208:211], v[92:107]
    ds_read_b128 v[164:167], v11 offset:6144
    v_mfma_f32_32x32x16_bf16 v[108:123], v[188:191], v[208:211], v[108:123]
    v_mfma_f32_32x32x16_bf16 v[124:139], v[192:195], v[208:211], v[124:139]
    s_waitcnt vmcnt(7) lgkmcnt(0)
    v_mfma_f32_32x32x16_bf16 v[28:43], v[140:143], v[212:215], v[28:43]
    ds_read_b128 v[168:171], v11 offset:7168
    ds_read_b128 v[172:175], v11 offset:8192
    v_mfma_f32_32x32x16_bf16 v[44:59], v[144:147], v[212:215], v[44:59]
    ds_read_b128 v[176:179], v11 offset:9216
    ds_read_b128 v[180:183], v11 offset:10240
    v_mfma_f32_32x32x16_bf16 v[60:75], v[148:151], v[212:215], v[60:75]
    ds_read_b128 v[184:187], v11 offset:11264
    ds_read_b128 v[188:191], v11 offset:12288
    v_mfma_f32_32x32x16_bf16 v[76:91], v[152:155], v[212:215], v[76:91]
    ds_read_b128 v[192:195], v11 offset:13312
    v_mfma_f32_32x32x16_bf16 v[92:107], v[156:159], v[212:215], v[92:107]
    v_mfma_f32_32x32x16_bf16 v[108:123], v[160:163], v[212:215], v[108:123]
    v_mfma_f32_32x32x16_bf16 v[124:139], v[164:167], v[212:215], v[124:139]
    ds_read_b64 v[12:13], v7 offset:0
    ds_read_b64 v[14:15], v7 offset:1024
    ds_read_b64 v[16:17], v7 offset:2048
    ds_read_b64 v[18:19], v7 offset:3072
    s_waitcnt vmcnt(6) lgkmcnt(0)
    v_mfma_f32_32x32x16_bf16 v[28:43], v[168:171], v[216:219], v[28:43]
    ds_read_b128 v[140:143], v11 offset:14336
    ds_read_b128 v[144:147], v11 offset:15360
    v_mfma_f32_32x32x16_bf16 v[44:59], v[172:175], v[216:219], v[44:59]
    ds_read_b128 v[148:151], v11 offset:16384
    ds_read_b128 v[152:155], v11 offset:17408
    buffer_load_dwordx4 v[196:199], v2, s[8:11], s42 offen offset:0
    v_mfma_f32_32x32x16_bf16 v[60:75], v[176:179], v[216:219], v[60:75]
    ds_read_b128 v[156:159], v11 offset:18432
    ds_read_b128 v[160:163], v11 offset:19456
    v_mfma_f32_32x32x16_bf16 v[76:91], v[180:183], v[216:219], v[76:91]
    ds_read_b128 v[164:167], v11 offset:20480
    buffer_load_dwordx4 v[200:203], v2, s[8:11], s42 offen offset:1024
    v_mfma_f32_32x32x16_bf16 v[92:107], v[184:187], v[216:219], v[92:107]
    v_lshrrev_b32 v5, 5, v1
    v_and_b32 v6, 31, v1
    v_mfma_f32_32x32x16_bf16 v[108:123], v[188:191], v[216:219], v[108:123]
    v_lshlrev_b32 v6, 2, v6
    v_add_u32 v6, 143360, v6
    buffer_load_dwordx4 v[204:207], v2, s[8:11], s42 offen offset:2048
    v_mfma_f32_32x32x16_bf16 v[124:139], v[192:195], v[216:219], v[124:139]
    v_add_f32 v12, v12, v14
    v_add_f32 v13, v13, v15
    s_waitcnt vmcnt(8) lgkmcnt(0)
    v_mfma_f32_32x32x16_bf16 v[28:43], v[140:143], v[220:223], v[28:43]
    ds_read_b128 v[168:171], v11 offset:21504
    ds_read_b128 v[172:175], v11 offset:22528
    v_mfma_f32_32x32x16_bf16 v[44:59], v[144:147], v[220:223], v[44:59]
    ds_read_b128 v[176:179], v11 offset:23552
    ds_read_b128 v[180:183], v11 offset:24576
    buffer_load_dwordx4 v[208:211], v2, s[8:11], s42 offen offset:3072
    s_add_u32 s42, s42, 4096
    v_mfma_f32_32x32x16_bf16 v[60:75], v[148:151], v[220:223], v[60:75]
    ds_read_b128 v[184:187], v11 offset:25600
    ds_read_b128 v[188:191], v11 offset:26624
    v_mfma_f32_32x32x16_bf16 v[76:91], v[152:155], v[220:223], v[76:91]
    ds_read_b128 v[192:195], v11 offset:27648
    buffer_load_dwordx4 v[212:215], v2, s[8:11], s42 offen offset:0
    v_mfma_f32_32x32x16_bf16 v[92:107], v[156:159], v[220:223], v[92:107]
    v_add_f32 v16, v16, v18
    v_add_f32 v17, v17, v19
    v_mfma_f32_32x32x16_bf16 v[108:123], v[160:163], v[220:223], v[108:123]
    v_add_f32 v12, v12, v16
    v_add_f32 v13, v13, v17
    buffer_load_dwordx4 v[216:219], v2, s[8:11], s42 offen offset:1024
    v_mfma_f32_32x32x16_bf16 v[124:139], v[164:167], v[220:223], v[124:139]
    v_mov_b32 v14, v12
    v_mov_b32 v15, v13
    s_waitcnt vmcnt(10) lgkmcnt(0)
    v_mfma_f32_32x32x16_bf16 v[28:43], v[168:171], v[224:227], v[28:43]
    v_mfma_f32_32x32x16_bf16 v[44:59], v[172:175], v[224:227], v[44:59]
    s_barrier
    ds_read_b128 v[140:143], v9 offset:0
    ds_read_b128 v[144:147], v9 offset:1024
    v_mfma_f32_32x32x16_bf16 v[60:75], v[176:179], v[224:227], v[60:75]
    ds_read_b128 v[148:151], v9 offset:2048
    ds_read_b128 v[152:155], v9 offset:3072
    v_mfma_f32_32x32x16_bf16 v[76:91], v[180:183], v[224:227], v[76:91]
    ds_read_b128 v[156:159], v9 offset:4096
    ds_read_b128 v[160:163], v9 offset:5120
    v_mfma_f32_32x32x16_bf16 v[92:107], v[184:187], v[224:227], v[92:107]
    ds_read_b128 v[164:167], v9 offset:6144
    v_bfe_u32 v7, v1, 4, 1
    v_mul_u32_u24 v7, 55296, v7
    v_mfma_f32_32x32x16_bf16 v[108:123], v[188:191], v[224:227], v[108:123]
    v_permlane32_swap_b32 v14, v12
    v_permlane32_swap_b32 v15, v13
    v_mfma_f32_32x32x16_bf16 v[124:139], v[192:195], v[224:227], v[124:139]
    v_add_f32 v12, v12, v14
    v_add_f32 v13, v13, v15
    s_waitcnt vmcnt(9) lgkmcnt(0)
    v_mfma_f32_32x32x16_bf16 v[28:43], v[140:143], v[228:231], v[28:43]
    ds_read_b128 v[168:171], v9 offset:7168
    ds_read_b128 v[172:175], v9 offset:8192
    v_mfma_f32_32x32x16_bf16 v[44:59], v[144:147], v[228:231], v[44:59]
    ds_read_b128 v[176:179], v9 offset:9216
    ds_read_b128 v[180:183], v9 offset:10240
    v_mfma_f32_32x32x16_bf16 v[60:75], v[148:151], v[228:231], v[60:75]
    ds_read_b128 v[184:187], v9 offset:11264
    ds_read_b128 v[188:191], v9 offset:12288
    v_mfma_f32_32x32x16_bf16 v[76:91], v[152:155], v[228:231], v[76:91]
    ds_read_b128 v[192:195], v9 offset:13312
    v_mfma_f32_32x32x16_bf16 v[92:107], v[156:159], v[228:231], v[92:107]
    v_mul_f32 v20, 0xbacccccd, v12
    v_mul_f32 v13, 0x3acccccd, v13
    v_mfma_f32_32x32x16_bf16 v[108:123], v[160:163], v[228:231], v[108:123]
    v_fma_f32 v13, -v20, v20, v13
    v_max_f32 v13, 0, v13
    v_mfma_f32_32x32x16_bf16 v[124:139], v[164:167], v[228:231], v[124:139]
    v_add_f32 v24, 0x3727c5ac, v13
    v_rsq_f32 v22, v24
    s_waitcnt vmcnt(8) lgkmcnt(0)
    v_mfma_f32_32x32x16_bf16 v[28:43], v[168:171], v[232:235], v[28:43]
    ds_read_b128 v[140:143], v9 offset:14336
    ds_read_b128 v[144:147], v9 offset:15360
    v_mfma_f32_32x32x16_bf16 v[44:59], v[172:175], v[232:235], v[44:59]
    ds_read_b128 v[148:151], v9 offset:16384
    ds_read_b128 v[152:155], v9 offset:17408
    buffer_load_dwordx4 v[220:223], v2, s[8:11], s42 offen offset:2048
    v_mfma_f32_32x32x16_bf16 v[60:75], v[176:179], v[232:235], v[60:75]
    ds_read_b128 v[156:159], v9 offset:18432
    ds_read_b128 v[160:163], v9 offset:19456
    v_mfma_f32_32x32x16_bf16 v[76:91], v[180:183], v[232:235], v[76:91]
    ds_read_b128 v[164:167], v9 offset:20480
    buffer_load_dwordx4 v[224:227], v2, s[8:11], s42 offen offset:3072
    s_add_u32 s42, s42, 4096
    v_mfma_f32_32x32x16_bf16 v[92:107], v[184:187], v[232:235], v[92:107]
    v_cmp_gt_u32 vcc, 32, v1
    v_mov_b32 v25, v24
    v_mfma_f32_32x32x16_bf16 v[108:123], v[188:191], v[232:235], v[108:123]
    v_mul_f32 v22, 0xbfb8aa3b, v22
    v_lshl_add_u32 v7, v5, 8, v7
    buffer_load_dwordx4 v[228:231], v2, s[8:11], s42 offen offset:0
    v_mfma_f32_32x32x16_bf16 v[124:139], v[192:195], v[232:235], v[124:139]
    v_mov_b32 v23, v22
    v_and_b32 v8, 15, v1
    s_waitcnt vmcnt(10) lgkmcnt(0)
    v_mfma_f32_32x32x16_bf16 v[28:43], v[140:143], v[236:239], v[28:43]
    ds_read_b128 v[168:171], v9 offset:21504
    ds_read_b128 v[172:175], v9 offset:22528
    v_mfma_f32_32x32x16_bf16 v[44:59], v[144:147], v[236:239], v[44:59]
    ds_read_b128 v[176:179], v9 offset:23552
    ds_read_b128 v[180:183], v9 offset:24576
    buffer_load_dwordx4 v[232:235], v2, s[8:11], s42 offen offset:1024
    v_mfma_f32_32x32x16_bf16 v[60:75], v[148:151], v[236:239], v[60:75]
    ds_read_b128 v[184:187], v9 offset:25600
    ds_read_b128 v[188:191], v9 offset:26624
    v_mfma_f32_32x32x16_bf16 v[76:91], v[152:155], v[236:239], v[76:91]
    ds_read_b128 v[192:195], v9 offset:27648
    v_mfma_f32_32x32x16_bf16 v[92:107], v[156:159], v[236:239], v[92:107]
    v_lshl_add_u32 v7, v8, 4, v7
    s_mul_i32 s39, s37, 110592
    v_mfma_f32_32x32x16_bf16 v[108:123], v[160:163], v[236:239], v[108:123]
    s_mul_i32 s40, s38, 3584
    s_add_u32 s39, s39, s40
    v_mfma_f32_32x32x16_bf16 v[124:139], v[164:167], v[236:239], v[124:139]
    s_add_u32 s39, s39, 13893632
    v_cndmask_b32 v20, 0, v20, vcc
    s_waitcnt vmcnt(10) lgkmcnt(0)
    v_mfma_f32_32x32x16_bf16 v[28:43], v[168:171], v[240:243], v[28:43]
    v_mfma_f32_32x32x16_bf16 v[44:59], v[172:175], v[240:243], v[44:59]
    s_barrier
    ds_read_b128 v[140:143], v9 offset:28672
    ds_read_b128 v[144:147], v9 offset:29696
    v_mfma_f32_32x32x16_bf16 v[60:75], v[176:179], v[240:243], v[60:75]
    ds_read_b128 v[148:151], v9 offset:30720
    ds_read_b128 v[152:155], v9 offset:31744
    v_mfma_f32_32x32x16_bf16 v[76:91], v[180:183], v[240:243], v[76:91]
    ds_read_b128 v[156:159], v9 offset:32768
    ds_read_b128 v[160:163], v9 offset:33792
    v_mfma_f32_32x32x16_bf16 v[92:107], v[184:187], v[240:243], v[92:107]
    ds_read_b128 v[164:167], v9 offset:34816
    v_cvt_pk_bf16_f32 v16, v20, v20
    v_and_b32 v21, 0xffff0000, v16
    v_mfma_f32_32x32x16_bf16 v[108:123], v[188:191], v[240:243], v[108:123]
    v_sub_f32 v21, v20, v21
    v_cvt_pk_bf16_f32 v17, v21, 0
    v_mfma_f32_32x32x16_bf16 v[124:139], v[192:195], v[240:243], v[124:139]
    s_waitcnt vmcnt(9) lgkmcnt(0)
    v_mfma_f32_32x32x16_bf16 v[28:43], v[140:143], v[196:199], v[28:43]
    ds_read_b128 v[168:171], v9 offset:35840
    ds_read_b128 v[172:175], v9 offset:36864
    v_mfma_f32_32x32x16_bf16 v[44:59], v[144:147], v[196:199], v[44:59]
    ds_read_b128 v[176:179], v9 offset:37888
    ds_read_b128 v[180:183], v9 offset:38912
    v_mfma_f32_32x32x16_bf16 v[60:75], v[148:151], v[196:199], v[60:75]
    ds_read_b128 v[184:187], v9 offset:39936
    ds_read_b128 v[188:191], v9 offset:40960
    v_mfma_f32_32x32x16_bf16 v[76:91], v[152:155], v[196:199], v[76:91]
    ds_read_b128 v[192:195], v9 offset:41984
    v_mfma_f32_32x32x16_bf16 v[92:107], v[156:159], v[196:199], v[92:107]
    ds_read_b32 v244, v6 offset:0
    ds_read_b32 v246, v6 offset:128
    v_mfma_f32_32x32x16_bf16 v[108:123], v[160:163], v[196:199], v[108:123]
    ds_read_b32 v248, v6 offset:256
    ds_read_b32 v250, v6 offset:384
    v_mfma_f32_32x32x16_bf16 v[124:139], v[164:167], v[196:199], v[124:139]
    ds_read_b32 v252, v6 offset:512
    ds_read_b32 v254, v6 offset:640
    s_waitcnt vmcnt(8) lgkmcnt(0)
    v_mfma_f32_32x32x16_bf16 v[28:43], v[168:171], v[200:203], v[28:43]
    ds_read_b128 v[140:143], v9 offset:43008
    ds_read_b128 v[144:147], v9 offset:44032
    v_mfma_f32_32x32x16_bf16 v[44:59], v[172:175], v[200:203], v[44:59]
    ds_read_b128 v[148:151], v9 offset:45056
    ds_read_b128 v[152:155], v9 offset:46080
    buffer_load_dwordx4 v[236:239], v2, s[8:11], s42 offen offset:2048
    v_mfma_f32_32x32x16_bf16 v[60:75], v[176:179], v[200:203], v[60:75]
    ds_read_b128 v[156:159], v9 offset:47104
    ds_read_b128 v[160:163], v9 offset:48128
    v_mfma_f32_32x32x16_bf16 v[76:91], v[180:183], v[200:203], v[76:91]
    ds_read_b128 v[164:167], v9 offset:49152
    buffer_load_dwordx4 v[240:243], v2, s[8:11], s42 offen offset:3072
    s_add_u32 s42, s42, 4096
    v_mfma_f32_32x32x16_bf16 v[92:107], v[184:187], v[200:203], v[92:107]
    ds_read_b32 v14, v6 offset:768
    v_mfma_f32_32x32x16_bf16 v[108:123], v[188:191], v[200:203], v[108:123]
    buffer_load_dwordx4 v[196:199], v2, s[8:11], s42 offen offset:0
    v_mfma_f32_32x32x16_bf16 v[124:139], v[192:195], v[200:203], v[124:139]
    s_waitcnt vmcnt(10) lgkmcnt(0)
    v_mfma_f32_32x32x16_bf16 v[28:43], v[140:143], v[204:207], v[28:43]
    ds_read_b128 v[168:171], v9 offset:50176
    ds_read_b128 v[172:175], v9 offset:51200
    v_mfma_f32_32x32x16_bf16 v[44:59], v[144:147], v[204:207], v[44:59]
    ds_read_b128 v[176:179], v9 offset:52224
    ds_read_b128 v[180:183], v9 offset:53248
    buffer_load_dwordx4 v[200:203], v2, s[8:11], s42 offen offset:1024
    v_mfma_f32_32x32x16_bf16 v[60:75], v[148:151], v[204:207], v[60:75]
    ds_read_b128 v[184:187], v9 offset:54272
    ds_read_b128 v[188:191], v9 offset:55296
    v_mfma_f32_32x32x16_bf16 v[76:91], v[152:155], v[204:207], v[76:91]
    ds_read_b128 v[192:195], v9 offset:56320
    v_mfma_f32_32x32x16_bf16 v[92:107], v[156:159], v[204:207], v[92:107]
    v_cvt_pk_bf16_f32 v245, v244, 0
    v_lshlrev_b32 v18, 16, v245
    v_mfma_f32_32x32x16_bf16 v[108:123], v[160:163], v[204:207], v[108:123]
    v_sub_f32 v244, v244, v18
    v_cvt_pk_bf16_f32 v244, v18, v244
    v_mfma_f32_32x32x16_bf16 v[124:139], v[164:167], v[204:207], v[124:139]
    v_cvt_pk_bf16_f32 v247, v246, 0
    v_lshlrev_b32 v19, 16, v247
    s_waitcnt vmcnt(10) lgkmcnt(0)
    v_mfma_f32_32x32x16_bf16 v[28:43], v[168:171], v[208:211], v[28:43]
    v_mfma_f32_32x32x16_bf16 v[44:59], v[172:175], v[208:211], v[44:59]
    s_barrier
    ds_read_b128 v[140:143], v10 offset:0
    ds_read_b128 v[144:147], v10 offset:1024
    v_mfma_f32_32x32x16_bf16 v[60:75], v[176:179], v[208:211], v[60:75]
    ds_read_b128 v[148:151], v10 offset:2048
    ds_read_b128 v[152:155], v10 offset:3072
    v_mfma_f32_32x32x16_bf16 v[76:91], v[180:183], v[208:211], v[76:91]
    ds_read_b128 v[156:159], v10 offset:4096
    ds_read_b128 v[160:163], v10 offset:5120
    v_mfma_f32_32x32x16_bf16 v[92:107], v[184:187], v[208:211], v[92:107]
    ds_read_b128 v[164:167], v10 offset:6144
    v_sub_f32 v246, v246, v19
    v_cvt_pk_bf16_f32 v246, v19, v246
    v_mfma_f32_32x32x16_bf16 v[108:123], v[188:191], v[208:211], v[108:123]
    v_cvt_pk_bf16_f32 v249, v248, 0
    v_lshlrev_b32 v18, 16, v249
    v_mfma_f32_32x32x16_bf16 v[124:139], v[192:195], v[208:211], v[124:139]
    v_sub_f32 v248, v248, v18
    v_cvt_pk_bf16_f32 v248, v18, v248
    s_waitcnt vmcnt(9) lgkmcnt(0)
    v_mfma_f32_32x32x16_bf16 v[28:43], v[140:143], v[212:215], v[28:43]
    ds_read_b128 v[168:171], v10 offset:7168
    ds_read_b128 v[172:175], v10 offset:8192
    v_mfma_f32_32x32x16_bf16 v[44:59], v[144:147], v[212:215], v[44:59]
    ds_read_b128 v[176:179], v10 offset:9216
    ds_read_b128 v[180:183], v10 offset:10240
    v_mfma_f32_32x32x16_bf16 v[60:75], v[148:151], v[212:215], v[60:75]
    ds_read_b128 v[184:187], v10 offset:11264
    ds_read_b128 v[188:191], v10 offset:12288
    v_mfma_f32_32x32x16_bf16 v[76:91], v[152:155], v[212:215], v[76:91]
    ds_read_b128 v[192:195], v10 offset:13312
    v_mfma_f32_32x32x16_bf16 v[92:107], v[156:159], v[212:215], v[92:107]
    v_cvt_pk_bf16_f32 v251, v250, 0
    v_lshlrev_b32 v19, 16, v251
    v_mfma_f32_32x32x16_bf16 v[108:123], v[160:163], v[212:215], v[108:123]
    v_sub_f32 v250, v250, v19
    v_cvt_pk_bf16_f32 v250, v19, v250
    v_mfma_f32_32x32x16_bf16 v[124:139], v[164:167], v[212:215], v[124:139]
    v_cvt_pk_bf16_f32 v253, v252, 0
    v_lshlrev_b32 v18, 16, v253
    s_waitcnt vmcnt(8) lgkmcnt(0)
    v_mfma_f32_32x32x16_bf16 v[28:43], v[168:171], v[216:219], v[28:43]
    ds_read_b128 v[140:143], v10 offset:14336
    ds_read_b128 v[144:147], v10 offset:15360
    v_mfma_f32_32x32x16_bf16 v[44:59], v[172:175], v[216:219], v[44:59]
    ds_read_b128 v[148:151], v10 offset:16384
    ds_read_b128 v[152:155], v10 offset:17408
    buffer_load_dwordx4 v[204:207], v2, s[8:11], s42 offen offset:2048
    v_mfma_f32_32x32x16_bf16 v[60:75], v[176:179], v[216:219], v[60:75]
    ds_read_b128 v[156:159], v10 offset:18432
    ds_read_b128 v[160:163], v10 offset:19456
    v_mfma_f32_32x32x16_bf16 v[76:91], v[180:183], v[216:219], v[76:91]
    ds_read_b128 v[164:167], v10 offset:20480
    buffer_load_dwordx4 v[208:211], v2, s[8:11], s42 offen offset:3072
    s_add_u32 s42, s42, 4096
    v_mfma_f32_32x32x16_bf16 v[92:107], v[184:187], v[216:219], v[92:107]
    v_sub_f32 v252, v252, v18
    v_cvt_pk_bf16_f32 v252, v18, v252
    v_mfma_f32_32x32x16_bf16 v[108:123], v[188:191], v[216:219], v[108:123]
    v_cvt_pk_bf16_f32 v255, v254, 0
    v_lshlrev_b32 v19, 16, v255
    v_mfma_f32_32x32x16_bf16 v[124:139], v[192:195], v[216:219], v[124:139]
    v_sub_f32 v254, v254, v19
    v_cvt_pk_bf16_f32 v254, v19, v254
    s_waitcnt vmcnt(9) lgkmcnt(0)
    v_mfma_f32_32x32x16_bf16 v[28:43], v[140:143], v[220:223], v[28:43]
    ds_read_b128 v[168:171], v10 offset:21504
    ds_read_b128 v[172:175], v10 offset:22528
    v_mfma_f32_32x32x16_bf16 v[44:59], v[144:147], v[220:223], v[44:59]
    ds_read_b128 v[176:179], v10 offset:23552
    ds_read_b128 v[180:183], v10 offset:24576
    v_mfma_f32_32x32x16_bf16 v[60:75], v[148:151], v[220:223], v[60:75]
    ds_read_b128 v[184:187], v10 offset:25600
    ds_read_b128 v[188:191], v10 offset:26624
    v_mfma_f32_32x32x16_bf16 v[76:91], v[152:155], v[220:223], v[76:91]
    ds_read_b128 v[192:195], v10 offset:27648
    v_mfma_f32_32x32x16_bf16 v[92:107], v[156:159], v[220:223], v[92:107]
    v_cvt_pk_bf16_f32 v15, v14, 0
    v_lshlrev_b32 v18, 16, v15
    v_mfma_f32_32x32x16_bf16 v[108:123], v[160:163], v[220:223], v[108:123]
    v_sub_f32 v14, v14, v18
    v_cvt_pk_bf16_f32 v14, v18, v14
    v_mfma_f32_32x32x16_bf16 v[124:139], v[164:167], v[220:223], v[124:139]
    s_waitcnt vmcnt(8) lgkmcnt(0)
    v_mfma_f32_32x32x16_bf16 v[28:43], v[168:171], v[224:227], v[28:43]
    v_mfma_f32_32x32x16_bf16 v[44:59], v[172:175], v[224:227], v[44:59]
    s_barrier
    ds_read_b128 v[140:143], v10 offset:28672
    ds_read_b128 v[144:147], v10 offset:35840
    v_mfma_f32_32x32x16_bf16 v[60:75], v[176:179], v[224:227], v[60:75]
    ds_read_b128 v[148:151], v10 offset:43008
    ds_read_b128 v[152:155], v10 offset:50176
    v_mfma_f32_32x32x16_bf16 v[76:91], v[180:183], v[224:227], v[76:91]
    ds_read_b128 v[156:159], v11 offset:0
    ds_read_b128 v[160:163], v11 offset:7168
    v_mfma_f32_32x32x16_bf16 v[92:107], v[184:187], v[224:227], v[92:107]
    ds_read_b128 v[164:167], v11 offset:14336
    v_mfma_f32_32x32x16_bf16 v[108:123], v[188:191], v[224:227], v[108:123]
    v_mfma_f32_32x32x16_bf16 v[124:139], v[192:195], v[224:227], v[124:139]
    v_mfma_f32_32x32x8_bf16 v[28:43], v[244:245], v[16:17], v[28:43]
    s_waitcnt vmcnt(7) lgkmcnt(6)
    v_mfma_f32_32x32x16_bf16 v[28:43], v[140:143], v[228:231], v[28:43]
    ds_read_b128 v[168:171], v11 offset:21504
    s_waitcnt vmcnt(6) lgkmcnt(6)
    v_mfma_f32_32x32x16_bf16 v[28:43], v[144:147], v[232:235], v[28:43]
    ds_read_b128 v[172:175], v10 offset:29696
    s_waitcnt vmcnt(5) lgkmcnt(6)
    v_mfma_f32_32x32x16_bf16 v[28:43], v[148:151], v[236:239], v[28:43]
    ds_read_b128 v[176:179], v10 offset:36864
    s_waitcnt vmcnt(4) lgkmcnt(6)
    v_mfma_f32_32x32x16_bf16 v[28:43], v[152:155], v[240:243], v[28:43]
    ds_read_b128 v[180:183], v10 offset:44032
    s_waitcnt vmcnt(3) lgkmcnt(6)
    v_mfma_f32_32x32x16_bf16 v[28:43], v[156:159], v[196:199], v[28:43]
    ds_read_b128 v[184:187], v10 offset:51200
    s_waitcnt vmcnt(2) lgkmcnt(6)
    v_mfma_f32_32x32x16_bf16 v[28:43], v[160:163], v[200:203], v[28:43]
    ds_read_b128 v[140:143], v11 offset:1024
    s_waitcnt vmcnt(1) lgkmcnt(6)
    v_mfma_f32_32x32x16_bf16 v[28:43], v[164:167], v[204:207], v[28:43]
    ds_read_b128 v[144:147], v11 offset:8192
    s_waitcnt vmcnt(0) lgkmcnt(6)
    v_mfma_f32_32x32x16_bf16 v[28:43], v[168:171], v[208:211], v[28:43]
    ds_read_b128 v[148:151], v11 offset:15360
    v_mfma_f32_32x32x8_bf16 v[44:59], v[246:247], v[16:17], v[44:59]
    s_waitcnt lgkmcnt(5)
    v_mfma_f32_32x32x16_bf16 v[44:59], v[172:175], v[228:231], v[44:59]
    ds_read_b128 v[152:155], v11 offset:22528
    v_mfma_f32_32x32x16_bf16 v[44:59], v[176:179], v[232:235], v[44:59]
    ds_read_b128 v[156:159], v10 offset:30720
    s_waitcnt lgkmcnt(5)
    v_mfma_f32_32x32x16_bf16 v[44:59], v[180:183], v[236:239], v[44:59]
    ds_read_b128 v[160:163], v10 offset:37888
    s_nop 1
    v_mul_f32 v188, v28, v22
    v_mul_f32 v189, v29, v22
    v_mul_f32 v190, v30, v22
    v_mul_f32 v191, v31, v22
    v_mul_f32 v192, v32, v22
    v_mul_f32 v193, v33, v22
    v_mul_f32 v194, v34, v22
    v_mul_f32 v195, v35, v22
    v_exp_f32 v188, v188
    v_mfma_f32_32x32x16_bf16 v[44:59], v[184:187], v[240:243], v[44:59]
    ds_read_b128 v[164:167], v10 offset:45056
    v_exp_f32 v189, v189
    v_exp_f32 v190, v190
    v_exp_f32 v191, v191
    v_exp_f32 v192, v192
    v_exp_f32 v193, v193
    v_exp_f32 v194, v194
    v_exp_f32 v195, v195
    v_mul_f32 v28, v28, v36
    v_mul_f32 v29, v29, v37
    s_waitcnt lgkmcnt(5)
    v_mfma_f32_32x32x16_bf16 v[44:59], v[140:143], v[196:199], v[44:59]
    ds_read_b128 v[168:171], v10 offset:52224
    v_mul_f32 v30, v30, v38
    v_mul_f32 v31, v31, v39
    v_mul_f32 v32, v32, v40
    v_mul_f32 v33, v33, v41
    v_mul_f32 v34, v34, v42
    v_mul_f32 v35, v35, v43
    v_fma_f32 v188, v188, v24, v24
    v_fma_f32 v189, v189, v24, v24
    v_fma_f32 v190, v190, v24, v24
    v_mfma_f32_32x32x16_bf16 v[44:59], v[144:147], v[200:203], v[44:59]
    ds_read_b128 v[172:175], v11 offset:2048
    v_fma_f32 v191, v191, v24, v24
    v_fma_f32 v192, v192, v24, v24
    v_fma_f32 v193, v193, v24, v24
    v_fma_f32 v194, v194, v24, v24
    v_fma_f32 v195, v195, v24, v24
    v_rcp_f32 v188, v188
    v_rcp_f32 v189, v189
    v_rcp_f32 v190, v190
    v_rcp_f32 v191, v191
    s_waitcnt lgkmcnt(5)
    v_mfma_f32_32x32x16_bf16 v[44:59], v[148:151], v[204:207], v[44:59]
    ds_read_b128 v[176:179], v11 offset:9216
    v_rcp_f32 v192, v192
    v_rcp_f32 v193, v193
    v_rcp_f32 v194, v194
    v_rcp_f32 v195, v195
    v_mul_f32 v28, v28, v188
    v_mul_f32 v29, v29, v189
    v_mul_f32 v30, v30, v190
    v_mul_f32 v31, v31, v191
    v_mul_f32 v32, v32, v192
    v_mfma_f32_32x32x16_bf16 v[44:59], v[152:155], v[208:211], v[44:59]
    ds_read_b128 v[180:183], v11 offset:16384
    v_mul_f32 v33, v33, v193
    v_mul_f32 v34, v34, v194
    v_mul_f32 v35, v35, v195
    v_cvt_pk_bf16_f32 v36, v28, v29
    v_cvt_pk_bf16_f32 v37, v30, v31
    v_cvt_pk_bf16_f32 v38, v32, v33
    v_cvt_pk_bf16_f32 v39, v34, v35
    buffer_store_dwordx4 v[36:39], v7, s[8:11], s39 offen offset:0 sc1
    v_mfma_f32_32x32x8_bf16 v[60:75], v[248:249], v[16:17], v[60:75]
    s_waitcnt lgkmcnt(5)
    v_mfma_f32_32x32x16_bf16 v[60:75], v[156:159], v[228:231], v[60:75]
    ds_read_b128 v[184:187], v11 offset:23552
    v_mfma_f32_32x32x16_bf16 v[60:75], v[160:163], v[232:235], v[60:75]
    ds_read_b128 v[140:143], v10 offset:31744
    s_waitcnt lgkmcnt(5)
    v_mfma_f32_32x32x16_bf16 v[60:75], v[164:167], v[236:239], v[60:75]
    ds_read_b128 v[144:147], v10 offset:38912
    v_mul_f32 v188, v44, v22
    v_mul_f32 v189, v45, v22
    v_mul_f32 v190, v46, v22
    v_mul_f32 v191, v47, v22
    v_mul_f32 v192, v48, v22
    v_mul_f32 v193, v49, v22
    v_mul_f32 v194, v50, v22
    v_mul_f32 v195, v51, v22
    v_exp_f32 v188, v188
    v_mfma_f32_32x32x16_bf16 v[60:75], v[168:171], v[240:243], v[60:75]
    ds_read_b128 v[148:151], v10 offset:46080
    v_exp_f32 v189, v189
    v_exp_f32 v190, v190
    v_exp_f32 v191, v191
    v_exp_f32 v192, v192
    v_exp_f32 v193, v193
    v_exp_f32 v194, v194
    v_exp_f32 v195, v195
    v_mul_f32 v44, v44, v52
    v_mul_f32 v45, v45, v53
    s_waitcnt lgkmcnt(5)
    v_mfma_f32_32x32x16_bf16 v[60:75], v[172:175], v[196:199], v[60:75]
    ds_read_b128 v[152:155], v10 offset:53248
    v_mul_f32 v46, v46, v54
    v_mul_f32 v47, v47, v55
    v_mul_f32 v48, v48, v56
    v_mul_f32 v49, v49, v57
    v_mul_f32 v50, v50, v58
    v_mul_f32 v51, v51, v59
    v_fma_f32 v188, v188, v24, v24
    v_fma_f32 v189, v189, v24, v24
    v_fma_f32 v190, v190, v24, v24
    v_mfma_f32_32x32x16_bf16 v[60:75], v[176:179], v[200:203], v[60:75]
    ds_read_b128 v[156:159], v11 offset:3072
    v_fma_f32 v191, v191, v24, v24
    v_fma_f32 v192, v192, v24, v24
    v_fma_f32 v193, v193, v24, v24
    v_fma_f32 v194, v194, v24, v24
    v_fma_f32 v195, v195, v24, v24
    v_rcp_f32 v188, v188
    v_rcp_f32 v189, v189
    v_rcp_f32 v190, v190
    v_rcp_f32 v191, v191
    s_waitcnt lgkmcnt(5)
    v_mfma_f32_32x32x16_bf16 v[60:75], v[180:183], v[204:207], v[60:75]
    ds_read_b128 v[160:163], v11 offset:10240
    v_rcp_f32 v192, v192
    v_rcp_f32 v193, v193
    v_rcp_f32 v194, v194
    v_rcp_f32 v195, v195
    v_mul_f32 v44, v44, v188
    v_mul_f32 v45, v45, v189
    v_mul_f32 v46, v46, v190
    v_mul_f32 v47, v47, v191
    v_mul_f32 v48, v48, v192
    v_mfma_f32_32x32x16_bf16 v[60:75], v[184:187], v[208:211], v[60:75]
    ds_read_b128 v[164:167], v11 offset:17408
    v_mul_f32 v49, v49, v193
    v_mul_f32 v50, v50, v194
    v_mul_f32 v51, v51, v195
    v_cvt_pk_bf16_f32 v52, v44, v45
    v_cvt_pk_bf16_f32 v53, v46, v47
    v_cvt_pk_bf16_f32 v54, v48, v49
    v_cvt_pk_bf16_f32 v55, v50, v51
    buffer_store_dwordx4 v[52:55], v7, s[8:11], s39 offen offset:512 sc1
    v_mfma_f32_32x32x8_bf16 v[76:91], v[250:251], v[16:17], v[76:91]
    s_waitcnt lgkmcnt(5)
    v_mfma_f32_32x32x16_bf16 v[76:91], v[140:143], v[228:231], v[76:91]
    ds_read_b128 v[168:171], v11 offset:24576
    v_mfma_f32_32x32x16_bf16 v[76:91], v[144:147], v[232:235], v[76:91]
    ds_read_b128 v[172:175], v10 offset:32768
    s_waitcnt lgkmcnt(5)
    v_mfma_f32_32x32x16_bf16 v[76:91], v[148:151], v[236:239], v[76:91]
    ds_read_b128 v[176:179], v10 offset:39936
    v_mul_f32 v188, v60, v22
    v_mul_f32 v189, v61, v22
    v_mul_f32 v190, v62, v22
    v_mul_f32 v191, v63, v22
    v_mul_f32 v192, v64, v22
    v_mul_f32 v193, v65, v22
    v_mul_f32 v194, v66, v22
    v_mul_f32 v195, v67, v22
    v_exp_f32 v188, v188
    v_mfma_f32_32x32x16_bf16 v[76:91], v[152:155], v[240:243], v[76:91]
    ds_read_b128 v[180:183], v10 offset:47104
    v_exp_f32 v189, v189
    v_exp_f32 v190, v190
    v_exp_f32 v191, v191
    v_exp_f32 v192, v192
    v_exp_f32 v193, v193
    v_exp_f32 v194, v194
    v_exp_f32 v195, v195
    v_mul_f32 v60, v60, v68
    v_mul_f32 v61, v61, v69
    s_waitcnt lgkmcnt(5)
    v_mfma_f32_32x32x16_bf16 v[76:91], v[156:159], v[196:199], v[76:91]
    ds_read_b128 v[184:187], v10 offset:54272
    v_mul_f32 v62, v62, v70
    v_mul_f32 v63, v63, v71
    v_mul_f32 v64, v64, v72
    v_mul_f32 v65, v65, v73
    v_mul_f32 v66, v66, v74
    v_mul_f32 v67, v67, v75
    v_fma_f32 v188, v188, v24, v24
    v_fma_f32 v189, v189, v24, v24
    v_fma_f32 v190, v190, v24, v24
    v_mfma_f32_32x32x16_bf16 v[76:91], v[160:163], v[200:203], v[76:91]
    ds_read_b128 v[140:143], v11 offset:4096
    v_fma_f32 v191, v191, v24, v24
    v_fma_f32 v192, v192, v24, v24
    v_fma_f32 v193, v193, v24, v24
    v_fma_f32 v194, v194, v24, v24
    v_fma_f32 v195, v195, v24, v24
    v_rcp_f32 v188, v188
    v_rcp_f32 v189, v189
    v_rcp_f32 v190, v190
    v_rcp_f32 v191, v191
    s_waitcnt lgkmcnt(5)
    v_mfma_f32_32x32x16_bf16 v[76:91], v[164:167], v[204:207], v[76:91]
    ds_read_b128 v[144:147], v11 offset:11264
    v_rcp_f32 v192, v192
    v_rcp_f32 v193, v193
    v_rcp_f32 v194, v194
    v_rcp_f32 v195, v195
    v_mul_f32 v60, v60, v188
    v_mul_f32 v61, v61, v189
    v_mul_f32 v62, v62, v190
    v_mul_f32 v63, v63, v191
    v_mul_f32 v64, v64, v192
    v_mfma_f32_32x32x16_bf16 v[76:91], v[168:171], v[208:211], v[76:91]
    ds_read_b128 v[148:151], v11 offset:18432
    v_mul_f32 v65, v65, v193
    v_mul_f32 v66, v66, v194
    v_mul_f32 v67, v67, v195
    v_cvt_pk_bf16_f32 v68, v60, v61
    v_cvt_pk_bf16_f32 v69, v62, v63
    v_cvt_pk_bf16_f32 v70, v64, v65
    v_cvt_pk_bf16_f32 v71, v66, v67
    buffer_store_dwordx4 v[68:71], v7, s[8:11], s39 offen offset:1024 sc1
    v_mfma_f32_32x32x8_bf16 v[92:107], v[252:253], v[16:17], v[92:107]
    s_waitcnt lgkmcnt(5)
    v_mfma_f32_32x32x16_bf16 v[92:107], v[172:175], v[228:231], v[92:107]
    ds_read_b128 v[152:155], v11 offset:25600
    v_mfma_f32_32x32x16_bf16 v[92:107], v[176:179], v[232:235], v[92:107]
    ds_read_b128 v[156:159], v10 offset:33792
    s_waitcnt lgkmcnt(5)
    v_mfma_f32_32x32x16_bf16 v[92:107], v[180:183], v[236:239], v[92:107]
    ds_read_b128 v[160:163], v10 offset:40960
    v_mul_f32 v188, v76, v22
    v_mul_f32 v189, v77, v22
    v_mul_f32 v190, v78, v22
    v_mul_f32 v191, v79, v22
    v_mul_f32 v192, v80, v22
    v_mul_f32 v193, v81, v22
    v_mul_f32 v194, v82, v22
    v_mul_f32 v195, v83, v22
    v_exp_f32 v188, v188
    v_mfma_f32_32x32x16_bf16 v[92:107], v[184:187], v[240:243], v[92:107]
    ds_read_b128 v[164:167], v10 offset:48128
    v_exp_f32 v189, v189
    v_exp_f32 v190, v190
    v_exp_f32 v191, v191
    v_exp_f32 v192, v192
    v_exp_f32 v193, v193
    v_exp_f32 v194, v194
    v_exp_f32 v195, v195
    v_mul_f32 v76, v76, v84
    v_mul_f32 v77, v77, v85
    s_waitcnt lgkmcnt(5)
    v_mfma_f32_32x32x16_bf16 v[92:107], v[140:143], v[196:199], v[92:107]
    ds_read_b128 v[168:171], v10 offset:55296
    v_mul_f32 v78, v78, v86
    v_mul_f32 v79, v79, v87
    v_mul_f32 v80, v80, v88
    v_mul_f32 v81, v81, v89
    v_mul_f32 v82, v82, v90
    v_mul_f32 v83, v83, v91
    v_fma_f32 v188, v188, v24, v24
    v_fma_f32 v189, v189, v24, v24
    v_fma_f32 v190, v190, v24, v24
    v_mfma_f32_32x32x16_bf16 v[92:107], v[144:147], v[200:203], v[92:107]
    ds_read_b128 v[172:175], v11 offset:5120
    v_fma_f32 v191, v191, v24, v24
    v_fma_f32 v192, v192, v24, v24
    v_fma_f32 v193, v193, v24, v24
    v_fma_f32 v194, v194, v24, v24
    v_fma_f32 v195, v195, v24, v24
    v_rcp_f32 v188, v188
    v_rcp_f32 v189, v189
    v_rcp_f32 v190, v190
    v_rcp_f32 v191, v191
    s_waitcnt lgkmcnt(5)
    v_mfma_f32_32x32x16_bf16 v[92:107], v[148:151], v[204:207], v[92:107]
    ds_read_b128 v[176:179], v11 offset:12288
    v_rcp_f32 v192, v192
    v_rcp_f32 v193, v193
    v_rcp_f32 v194, v194
    v_rcp_f32 v195, v195
    v_mul_f32 v76, v76, v188
    v_mul_f32 v77, v77, v189
    v_mul_f32 v78, v78, v190
    v_mul_f32 v79, v79, v191
    v_mul_f32 v80, v80, v192
    v_mfma_f32_32x32x16_bf16 v[92:107], v[152:155], v[208:211], v[92:107]
    ds_read_b128 v[180:183], v11 offset:19456
    v_mul_f32 v81, v81, v193
    v_mul_f32 v82, v82, v194
    v_mul_f32 v83, v83, v195
    v_cvt_pk_bf16_f32 v84, v76, v77
    v_cvt_pk_bf16_f32 v85, v78, v79
    v_cvt_pk_bf16_f32 v86, v80, v81
    v_cvt_pk_bf16_f32 v87, v82, v83
    s_cmp_eq_u32 s38, 15
    s_cselect_b32 s39, 29884416, s39
    buffer_store_dwordx4 v[84:87], v7, s[8:11], s39 offen offset:1536 sc1
    v_mfma_f32_32x32x8_bf16 v[108:123], v[254:255], v[16:17], v[108:123]
    s_waitcnt lgkmcnt(5)
    v_mfma_f32_32x32x16_bf16 v[108:123], v[156:159], v[228:231], v[108:123]
    ds_read_b128 v[184:187], v11 offset:26624
    v_mfma_f32_32x32x16_bf16 v[108:123], v[160:163], v[232:235], v[108:123]
    ds_read_b128 v[140:143], v10 offset:34816
    s_waitcnt lgkmcnt(5)
    v_mfma_f32_32x32x16_bf16 v[108:123], v[164:167], v[236:239], v[108:123]
    ds_read_b128 v[144:147], v10 offset:41984
    v_mul_f32 v188, v92, v22
    v_mul_f32 v189, v93, v22
    v_mul_f32 v190, v94, v22
    v_mul_f32 v191, v95, v22
    v_mul_f32 v192, v96, v22
    v_mul_f32 v193, v97, v22
    v_mul_f32 v194, v98, v22
    v_mul_f32 v195, v99, v22
    v_exp_f32 v188, v188
    v_mfma_f32_32x32x16_bf16 v[108:123], v[168:171], v[240:243], v[108:123]
    ds_read_b128 v[148:151], v10 offset:49152
    v_exp_f32 v189, v189
    v_exp_f32 v190, v190
    v_exp_f32 v191, v191
    v_exp_f32 v192, v192
    v_exp_f32 v193, v193
    v_exp_f32 v194, v194
    v_exp_f32 v195, v195
    v_mul_f32 v92, v92, v100
    v_mul_f32 v93, v93, v101
    s_waitcnt lgkmcnt(5)
    v_mfma_f32_32x32x16_bf16 v[108:123], v[172:175], v[196:199], v[108:123]
    ds_read_b128 v[152:155], v10 offset:56320
    v_mul_f32 v94, v94, v102
    v_mul_f32 v95, v95, v103
    v_mul_f32 v96, v96, v104
    v_mul_f32 v97, v97, v105
    v_mul_f32 v98, v98, v106
    v_mul_f32 v99, v99, v107
    v_fma_f32 v188, v188, v24, v24
    v_fma_f32 v189, v189, v24, v24
    v_fma_f32 v190, v190, v24, v24
    v_mfma_f32_32x32x16_bf16 v[108:123], v[176:179], v[200:203], v[108:123]
    ds_read_b128 v[156:159], v11 offset:6144
    v_fma_f32 v191, v191, v24, v24
    v_fma_f32 v192, v192, v24, v24
    v_fma_f32 v193, v193, v24, v24
    v_fma_f32 v194, v194, v24, v24
    v_fma_f32 v195, v195, v24, v24
    v_rcp_f32 v188, v188
    v_rcp_f32 v189, v189
    v_rcp_f32 v190, v190
    v_rcp_f32 v191, v191
    s_waitcnt lgkmcnt(5)
    v_mfma_f32_32x32x16_bf16 v[108:123], v[180:183], v[204:207], v[108:123]
    ds_read_b128 v[160:163], v11 offset:13312
    v_rcp_f32 v192, v192
    v_rcp_f32 v193, v193
    v_rcp_f32 v194, v194
    v_rcp_f32 v195, v195
    v_mul_f32 v92, v92, v188
    v_mul_f32 v93, v93, v189
    v_mul_f32 v94, v94, v190
    v_mul_f32 v95, v95, v191
    v_mul_f32 v96, v96, v192
    v_mfma_f32_32x32x16_bf16 v[108:123], v[184:187], v[208:211], v[108:123]
    ds_read_b128 v[164:167], v11 offset:20480
    v_mul_f32 v97, v97, v193
    v_mul_f32 v98, v98, v194
    v_mul_f32 v99, v99, v195
    v_cvt_pk_bf16_f32 v100, v92, v93
    v_cvt_pk_bf16_f32 v101, v94, v95
    v_cvt_pk_bf16_f32 v102, v96, v97
    v_cvt_pk_bf16_f32 v103, v98, v99
    buffer_store_dwordx4 v[100:103], v7, s[8:11], s39 offen offset:2048 sc1
    v_mfma_f32_32x32x8_bf16 v[124:139], v[14:15], v[16:17], v[124:139]
    s_waitcnt lgkmcnt(5)
    v_mfma_f32_32x32x16_bf16 v[124:139], v[140:143], v[228:231], v[124:139]
    ds_read_b128 v[168:171], v11 offset:27648
    v_mfma_f32_32x32x16_bf16 v[124:139], v[144:147], v[232:235], v[124:139]
    s_waitcnt lgkmcnt(4)
    v_mfma_f32_32x32x16_bf16 v[124:139], v[148:151], v[236:239], v[124:139]
    v_mul_f32 v188, v108, v22
    v_mul_f32 v189, v109, v22
    v_mul_f32 v190, v110, v22
    v_mul_f32 v191, v111, v22
    v_mul_f32 v192, v112, v22
    v_mul_f32 v193, v113, v22
    v_mul_f32 v194, v114, v22
    v_mul_f32 v195, v115, v22
    v_exp_f32 v188, v188
    v_mfma_f32_32x32x16_bf16 v[124:139], v[152:155], v[240:243], v[124:139]
    v_exp_f32 v189, v189
    v_exp_f32 v190, v190
    v_exp_f32 v191, v191
    v_exp_f32 v192, v192
    v_exp_f32 v193, v193
    v_exp_f32 v194, v194
    v_exp_f32 v195, v195
    v_mul_f32 v108, v108, v116
    v_mul_f32 v109, v109, v117
    s_waitcnt lgkmcnt(2)
    v_mfma_f32_32x32x16_bf16 v[124:139], v[156:159], v[196:199], v[124:139]
    v_mul_f32 v110, v110, v118
    v_mul_f32 v111, v111, v119
    v_mul_f32 v112, v112, v120
    v_mul_f32 v113, v113, v121
    v_mul_f32 v114, v114, v122
    v_mul_f32 v115, v115, v123
    v_fma_f32 v188, v188, v24, v24
    v_fma_f32 v189, v189, v24, v24
    v_fma_f32 v190, v190, v24, v24
    v_mfma_f32_32x32x16_bf16 v[124:139], v[160:163], v[200:203], v[124:139]
    v_fma_f32 v191, v191, v24, v24
    v_fma_f32 v192, v192, v24, v24
    v_fma_f32 v193, v193, v24, v24
    v_fma_f32 v194, v194, v24, v24
    v_fma_f32 v195, v195, v24, v24
    v_rcp_f32 v188, v188
    v_rcp_f32 v189, v189
    v_rcp_f32 v190, v190
    v_rcp_f32 v191, v191
    s_waitcnt lgkmcnt(0)
    v_mfma_f32_32x32x16_bf16 v[124:139], v[164:167], v[204:207], v[124:139]
    v_rcp_f32 v192, v192
    v_rcp_f32 v193, v193
    v_rcp_f32 v194, v194
    v_rcp_f32 v195, v195
    v_mul_f32 v108, v108, v188
    v_mul_f32 v109, v109, v189
    v_mul_f32 v110, v110, v190
    v_mul_f32 v111, v111, v191
    v_mul_f32 v112, v112, v192
    v_mfma_f32_32x32x16_bf16 v[124:139], v[168:171], v[208:211], v[124:139]
    v_mul_f32 v113, v113, v193
    v_mul_f32 v114, v114, v194
    v_mul_f32 v115, v115, v195
    v_cvt_pk_bf16_f32 v116, v108, v109
    v_cvt_pk_bf16_f32 v117, v110, v111
    v_cvt_pk_bf16_f32 v118, v112, v113
    v_cvt_pk_bf16_f32 v119, v114, v115
    buffer_store_dwordx4 v[116:119], v7, s[8:11], s39 offen offset:2560 sc1
    s_nop 3
    v_pk_mul_f32 v[188:189], v[124:125], v[22:23]
    v_pk_mul_f32 v[190:191], v[126:127], v[22:23]
    v_pk_mul_f32 v[192:193], v[128:129], v[22:23]
    v_pk_mul_f32 v[194:195], v[130:131], v[22:23]
    v_exp_f32 v188, v188
    v_exp_f32 v189, v189
    v_exp_f32 v190, v190
    v_exp_f32 v191, v191
    v_exp_f32 v192, v192
    v_exp_f32 v193, v193
    v_exp_f32 v194, v194
    v_exp_f32 v195, v195
    v_pk_mul_f32 v[124:125], v[124:125], v[132:133]
    v_pk_mul_f32 v[126:127], v[126:127], v[134:135]
    v_pk_mul_f32 v[128:129], v[128:129], v[136:137]
    v_pk_mul_f32 v[130:131], v[130:131], v[138:139]
    v_pk_fma_f32 v[188:189], v[188:189], v[24:25], v[24:25]
    v_pk_fma_f32 v[190:191], v[190:191], v[24:25], v[24:25]
    v_pk_fma_f32 v[192:193], v[192:193], v[24:25], v[24:25]
    v_pk_fma_f32 v[194:195], v[194:195], v[24:25], v[24:25]
    v_rcp_f32 v188, v188
    v_rcp_f32 v189, v189
    v_rcp_f32 v190, v190
    v_rcp_f32 v191, v191
    v_rcp_f32 v192, v192
    v_rcp_f32 v193, v193
    v_rcp_f32 v194, v194
    v_rcp_f32 v195, v195
    v_pk_mul_f32 v[124:125], v[124:125], v[188:189]
    v_pk_mul_f32 v[126:127], v[126:127], v[190:191]
    v_pk_mul_f32 v[128:129], v[128:129], v[192:193]
    v_pk_mul_f32 v[130:131], v[130:131], v[194:195]
    v_cvt_pk_bf16_f32 v132, v124, v125
    v_cvt_pk_bf16_f32 v133, v126, v127
    v_cvt_pk_bf16_f32 v134, v128, v129
    v_cvt_pk_bf16_f32 v135, v130, v131
    buffer_store_dwordx4 v[132:135], v7, s[8:11], s39 offen offset:3072 sc1
    s_lshr_b32 s14, s37, 2
    s_lshl_b32 s14, s14, 5
    s_add_u32 s14, s14, s38
    s_lshl_b32 s14, s14, 6
    s_add_u32 s14, s14, 13565952
    s_nop 1
    s_load_dwordx2 s[38:39], s[0:1], 56
    s_and_b32 s50, s2, 7
    s_lshl_b32 s50, s50, 2
    s_bfe_u32 s51, s2, 0x20003
    s_add_u32 s48, s50, s51
    s_lshl_b32 s48, s48, 2
    s_add_u32 s48, s48, s13
    s_lshr_b32 s49, s2, 5
    v_add_u32 v5, 0, v1
    v_mul_u32_u24 v6, 6554, v5
    v_lshrrev_b32 v6, 16, v6
    v_mul_u32_u24 v6, 1120, v6
    v_lshl_add_u32 v16, v5, 4, v6
    v_add_u32 v5, 64, v1
    v_mul_u32_u24 v6, 6554, v5
    v_lshrrev_b32 v6, 16, v6
    v_mul_u32_u24 v6, 1120, v6
    v_lshl_add_u32 v17, v5, 4, v6
    v_add_u32 v5, 128, v1
    v_mul_u32_u24 v6, 6554, v5
    v_lshrrev_b32 v6, 16, v6
    v_mul_u32_u24 v6, 1120, v6
    v_lshl_add_u32 v18, v5, 4, v6
    s_mul_i32 s51, s48, 20480
    s_mul_i32 s52, s49, 160
    s_add_u32 s51, s51, s52
    s_waitcnt lgkmcnt(0)
    s_add_u32 s44, s38, s51
    s_addc_u32 s45, s39, 0
    s_sub_u32 s46, 2621440, s51
    s_mov_b32 s47, 0x20000
    s_mul_i32 s56, s13, 3072
    s_add_u32 s56, s56, 143360
    v_lshrrev_b32 v5, 4, v1
    v_and_b32 v6, 15, v1
    v_lshlrev_b32 v7, 4, v6
    v_lshl_add_u32 v11, v5, 9, v7
    v_lshlrev_b32 v19, 3, v6
    v_lshl_add_u32 v19, v5, 8, v19
    s_lshr_b32 s51, s48, 1
    s_mul_i32 s51, s51, 40
    s_mul_i32 s52, s49, 5
    s_add_u32 s51, s51, s52
    s_lshl_b32 s51, s51, 10
    s_and_b32 s52, s12, 1
    s_lshl_b32 s52, s52, 8
    s_add_u32 s51, s51, s52
    s_add_u32 s57, s51, 10747904
    v_mul_u32_u24 v6, 160, v6
    v_lshl_add_u32 v6, v5, 3, v6
    v_add_u32 v12, s56, v6
    v_add_u32 v13, 0, v2
    v_add_u32 v14, 61440, v2
    v_add_u32 v15, 122880, v2
    s_mul_i32 s53, s48, 55296
    s_add_u32 s53, s53, 13893632
    s_and_b32 s51, s12, 1
    s_mul_i32 s52, s51, 5120
    v_add_u32 v13, s52, v2
    v_add_u32 v14, 61440, v13
    v_add_u32 v15, 122880, v13
    s_lshl_b32 s51, s51, 10
    s_add_u32 s51, s51, 13893632
    s_mul_i32 s53, s48, 55296
    s_add_u32 s53, s53, s51
    s_xor_b32 s59, s48, 1
    s_mul_i32 s59, s59, 55296
    s_add_u32 s59, s59, s51
    s_mul_i32 s51, s12, 5120
    v_add_u32 v200, s51, v2
    s_xor_b32 s51, s12, 1
    s_mul_i32 s51, s51, 5120
    v_add_u32 v201, s51, v2
    s_lshr_b32 s15, s48, 3
    s_lshl_b32 s15, s15, 11
    s_add_u32 s15, s15, 13565952
    s_waitcnt vmcnt(0)
    s_barrier
    s_cmp_lg_u32 s12, 0
    s_cbranch_scc1 L_sequential_preLN__softmax_full_mha__swiglu_ffn__prompt_kernel_ns0_45
    v_mov_b32 v5, 1
    v_mov_b32 v6, 0
    s_mov_b64 exec, 1
    buffer_store_dword v5, v6, s[8:11], s14 offen sc1
    s_mov_b64 exec, -1
L_sequential_preLN__softmax_full_mha__swiglu_ffn__prompt_kernel_ns0_45:
    s_mul_i32 s51, s13, 2560
    s_add_u32 s51, s51, 152576
    v_add_u32 v20, s51, v2
    ds_read_b128 v[44:47], v20 offset:0
    ds_read_b128 v[48:51], v20 offset:1024
    ds_read_b128 v[52:55], v20 offset:2048
    s_waitcnt lgkmcnt(0)
    v_permlane32_swap_b32 v44, v46
    v_permlane32_swap_b32 v45, v47
    v_permlane32_swap_b32 v48, v50
    v_permlane32_swap_b32 v49, v51
    v_permlane32_swap_b32 v52, v54
    v_permlane32_swap_b32 v53, v55
    v_lshlrev_b32 v24, 16, v44
    v_and_b32 v25, 0xffff0000, v44
    v_lshlrev_b32 v26, 16, v45
    v_and_b32 v27, 0xffff0000, v45
    v_lshlrev_b32 v28, 16, v46
    v_and_b32 v29, 0xffff0000, v46
    v_lshlrev_b32 v30, 16, v47
    v_and_b32 v31, 0xffff0000, v47
    v_lshlrev_b32 v32, 16, v48
    v_and_b32 v33, 0xffff0000, v48
    v_lshlrev_b32 v34, 16, v49
    v_and_b32 v35, 0xffff0000, v49
    v_lshlrev_b32 v36, 16, v50
    v_and_b32 v37, 0xffff0000, v50
    v_lshlrev_b32 v38, 16, v51
    v_and_b32 v39, 0xffff0000, v51
    v_lshlrev_b32 v40, 16, v52
    v_and_b32 v41, 0xffff0000, v52
    v_lshlrev_b32 v42, 16, v53
    v_and_b32 v43, 0xffff0000, v53
    s_cmp_lg_u32 s12, 0
    s_cbranch_scc1 L_sequential_preLN__softmax_full_mha__swiglu_ffn__prompt_kernel_nw0_44
    v_and_b32 v5, 15, v1
    v_lshlrev_b32 v5, 6, v5
    s_mov_b32 s50, 0
L_sequential_preLN__softmax_full_mha__swiglu_ffn__prompt_kernel_poll_46:
    buffer_load_dword v6, v5, s[8:11], s15 offen sc1
    s_waitcnt vmcnt(0)
    v_cmp_ne_u32 vcc, 0, v6
    s_nop 0
    s_cmp_eq_u64 vcc, -1
    s_cbranch_scc1 L_sequential_preLN__softmax_full_mha__swiglu_ffn__prompt_kernel_pollx_47
    s_add_u32 s50, s50, 1
    s_cmp_lt_u32 s50, 0x40000
    s_cbranch_scc1 L_sequential_preLN__softmax_full_mha__swiglu_ffn__prompt_kernel_poll_46
L_sequential_preLN__softmax_full_mha__swiglu_ffn__prompt_kernel_pollx_47:
L_sequential_preLN__softmax_full_mha__swiglu_ffn__prompt_kernel_nw0_44:
    s_barrier
    buffer_load_dwordx4 v[116:119], v2, s[8:11], s53 offen offset:0
    buffer_load_dwordx4 v[120:123], v2, s[8:11], s59 offen offset:0
    buffer_load_dwordx4 v[124:127], v2, s[8:11], s53 offen offset:2048
    s_add_u32 s53, s53, 4096
    buffer_load_dwordx4 v[128:131], v2, s[8:11], s59 offen offset:2048
    s_add_u32 s59, s59, 4096
    buffer_load_dwordx4 v[132:135], v2, s[8:11], s53 offen offset:0
    buffer_load_dwordx4 v[136:139], v2, s[8:11], s59 offen offset:0
    buffer_load_dwordx4 v[140:143], v2, s[8:11], s53 offen offset:2048
    s_add_u32 s53, s53, 4096
    buffer_load_dwordx4 v[144:147], v2, s[8:11], s59 offen offset:2048
    s_add_u32 s59, s59, 4096
    ds_read_b128 v[44:47], v13 offset:0
    ds_read_b128 v[48:51], v13 offset:1024
    ds_read_b128 v[52:55], v13 offset:2048
    ds_read_b128 v[56:59], v13 offset:3072
    ds_read_b128 v[60:63], v13 offset:4096
    s_waitcnt vmcnt(6) lgkmcnt(0)
    v_mfma_f32_16x16x32_bf16 v[180:183], v[44:47], v[120:123], 0
    ds_read_b128 v[64:67], v13 offset:10240
    v_mfma_f32_16x16x32_bf16 v[24:27], v[44:47], v[116:119], v[24:27]
    ds_read_b128 v[68:71], v13 offset:11264
    v_mfma_f32_16x16x32_bf16 v[184:187], v[48:51], v[120:123], 0
    ds_read_b128 v[72:75], v13 offset:12288
    v_mfma_f32_16x16x32_bf16 v[28:31], v[48:51], v[116:119], v[28:31]
    ds_read_b128 v[76:79], v13 offset:13312
    v_mfma_f32_16x16x32_bf16 v[188:191], v[52:55], v[120:123], 0
    ds_read_b128 v[80:83], v13 offset:14336
    v_mfma_f32_16x16x32_bf16 v[32:35], v[52:55], v[116:119], v[32:35]
    buffer_load_dwordx4 v[148:151], v2, s[8:11], s53 offen offset:0
    v_mfma_f32_16x16x32_bf16 v[192:195], v[56:59], v[120:123], 0
    buffer_load_dwordx4 v[152:155], v2, s[8:11], s59 offen offset:0
    v_mfma_f32_16x16x32_bf16 v[36:39], v[56:59], v[116:119], v[36:39]
    buffer_load_dwordx4 v[156:159], v2, s[8:11], s53 offen offset:2048
    s_add_u32 s53, s53, 4096
    v_mfma_f32_16x16x32_bf16 v[196:199], v[60:63], v[120:123], 0
    buffer_load_dwordx4 v[160:163], v2, s[8:11], s59 offen offset:2048
    s_add_u32 s59, s59, 4096
    v_mfma_f32_16x16x32_bf16 v[40:43], v[60:63], v[116:119], v[40:43]
    s_waitcnt vmcnt(8) lgkmcnt(0)
    v_mfma_f32_16x16x32_bf16 v[180:183], v[64:67], v[128:131], v[180:183]
    ds_read_b128 v[44:47], v13 offset:20480
    v_mfma_f32_16x16x32_bf16 v[24:27], v[64:67], v[124:127], v[24:27]
    ds_read_b128 v[48:51], v13 offset:21504
    v_mfma_f32_16x16x32_bf16 v[184:187], v[68:71], v[128:131], v[184:187]
    ds_read_b128 v[52:55], v13 offset:22528
    v_mfma_f32_16x16x32_bf16 v[28:31], v[68:71], v[124:127], v[28:31]
    ds_read_b128 v[56:59], v13 offset:23552
    v_mfma_f32_16x16x32_bf16 v[188:191], v[72:75], v[128:131], v[188:191]
    ds_read_b128 v[60:63], v13 offset:24576
    v_mfma_f32_16x16x32_bf16 v[32:35], v[72:75], v[124:127], v[32:35]
    buffer_load_dwordx4 v[164:167], v2, s[8:11], s53 offen offset:0
    v_mfma_f32_16x16x32_bf16 v[192:195], v[76:79], v[128:131], v[192:195]
    buffer_load_dwordx4 v[168:171], v2, s[8:11], s59 offen offset:0
    v_mfma_f32_16x16x32_bf16 v[36:39], v[76:79], v[124:127], v[36:39]
    buffer_load_dwordx4 v[172:175], v2, s[8:11], s53 offen offset:2048
    s_add_u32 s53, s53, 4096
    v_mfma_f32_16x16x32_bf16 v[196:199], v[80:83], v[128:131], v[196:199]
    buffer_load_dwordx4 v[176:179], v2, s[8:11], s59 offen offset:2048
    s_add_u32 s59, s59, 4096
    v_mfma_f32_16x16x32_bf16 v[40:43], v[80:83], v[124:127], v[40:43]
    s_waitcnt vmcnt(10) lgkmcnt(0)
    v_mfma_f32_16x16x32_bf16 v[180:183], v[44:47], v[136:139], v[180:183]
    ds_read_b128 v[64:67], v13 offset:30720
    v_mfma_f32_16x16x32_bf16 v[24:27], v[44:47], v[132:135], v[24:27]
    ds_read_b128 v[68:71], v13 offset:31744
    v_mfma_f32_16x16x32_bf16 v[184:187], v[48:51], v[136:139], v[184:187]
    ds_read_b128 v[72:75], v13 offset:32768
    v_mfma_f32_16x16x32_bf16 v[28:31], v[48:51], v[132:135], v[28:31]
    ds_read_b128 v[76:79], v13 offset:33792
    v_mfma_f32_16x16x32_bf16 v[188:191], v[52:55], v[136:139], v[188:191]
    ds_read_b128 v[80:83], v13 offset:34816
    v_mfma_f32_16x16x32_bf16 v[32:35], v[52:55], v[132:135], v[32:35]
    buffer_load_dwordx4 v[116:119], v2, s[8:11], s53 offen offset:0
    v_mfma_f32_16x16x32_bf16 v[192:195], v[56:59], v[136:139], v[192:195]
    buffer_load_dwordx4 v[120:123], v2, s[8:11], s59 offen offset:0
    v_mfma_f32_16x16x32_bf16 v[36:39], v[56:59], v[132:135], v[36:39]
    buffer_load_dwordx4 v[124:127], v2, s[8:11], s53 offen offset:2048
    s_add_u32 s53, s53, 4096
    v_mfma_f32_16x16x32_bf16 v[196:199], v[60:63], v[136:139], v[196:199]
    v_mfma_f32_16x16x32_bf16 v[40:43], v[60:63], v[132:135], v[40:43]
    s_waitcnt vmcnt(11) lgkmcnt(0)
    v_mfma_f32_16x16x32_bf16 v[180:183], v[64:67], v[144:147], v[180:183]
    v_mfma_f32_16x16x32_bf16 v[24:27], v[64:67], v[140:143], v[24:27]
    s_barrier
    ds_read_b128 v[44:47], v13 offset:40960
    v_mfma_f32_16x16x32_bf16 v[184:187], v[68:71], v[144:147], v[184:187]
    ds_read_b128 v[48:51], v13 offset:41984
    v_mfma_f32_16x16x32_bf16 v[28:31], v[68:71], v[140:143], v[28:31]
    ds_read_b128 v[52:55], v13 offset:43008
    v_mfma_f32_16x16x32_bf16 v[188:191], v[72:75], v[144:147], v[188:191]
    ds_read_b128 v[56:59], v13 offset:44032
    v_mfma_f32_16x16x32_bf16 v[32:35], v[72:75], v[140:143], v[32:35]
    ds_read_b128 v[60:63], v13 offset:45056
    buffer_load_dwordx4 v[128:131], v2, s[8:11], s59 offen offset:2048
    s_add_u32 s59, s59, 4096
    v_mfma_f32_16x16x32_bf16 v[192:195], v[76:79], v[144:147], v[192:195]
    v_mfma_f32_16x16x32_bf16 v[36:39], v[76:79], v[140:143], v[36:39]
    buffer_load_dwordx4 v[132:135], v2, s[8:11], s53 offen offset:0
    v_mfma_f32_16x16x32_bf16 v[196:199], v[80:83], v[144:147], v[196:199]
    v_mfma_f32_16x16x32_bf16 v[40:43], v[80:83], v[140:143], v[40:43]
    s_waitcnt vmcnt(11) lgkmcnt(0)
    v_mfma_f32_16x16x32_bf16 v[180:183], v[44:47], v[152:155], v[180:183]
    ds_read_b128 v[64:67], v13 offset:51200
    v_mfma_f32_16x16x32_bf16 v[24:27], v[44:47], v[148:151], v[24:27]
    ds_read_b128 v[68:71], v13 offset:52224
    v_mfma_f32_16x16x32_bf16 v[184:187], v[48:51], v[152:155], v[184:187]
    ds_read_b128 v[72:75], v13 offset:53248
    v_mfma_f32_16x16x32_bf16 v[28:31], v[48:51], v[148:151], v[28:31]
    ds_read_b128 v[76:79], v13 offset:54272
    v_mfma_f32_16x16x32_bf16 v[188:191], v[52:55], v[152:155], v[188:191]
    ds_read_b128 v[80:83], v13 offset:55296
    v_mfma_f32_16x16x32_bf16 v[32:35], v[52:55], v[148:151], v[32:35]
    buffer_load_dwordx4 v[136:139], v2, s[8:11], s59 offen offset:0
    v_mfma_f32_16x16x32_bf16 v[192:195], v[56:59], v[152:155], v[192:195]
    v_mfma_f32_16x16x32_bf16 v[36:39], v[56:59], v[148:151], v[36:39]
    buffer_load_dwordx4 v[140:143], v2, s[8:11], s53 offen offset:2048
    s_add_u32 s53, s53, 4096
    v_mfma_f32_16x16x32_bf16 v[196:199], v[60:63], v[152:155], v[196:199]
    v_mfma_f32_16x16x32_bf16 v[40:43], v[60:63], v[148:151], v[40:43]
    s_waitcnt vmcnt(11) lgkmcnt(0)
    v_mfma_f32_16x16x32_bf16 v[180:183], v[64:67], v[160:163], v[180:183]
    ds_read_b128 v[44:47], v14 offset:0
    v_mfma_f32_16x16x32_bf16 v[24:27], v[64:67], v[156:159], v[24:27]
    ds_read_b128 v[48:51], v14 offset:1024
    v_mfma_f32_16x16x32_bf16 v[184:187], v[68:71], v[160:163], v[184:187]
    ds_read_b128 v[52:55], v14 offset:2048
    v_mfma_f32_16x16x32_bf16 v[28:31], v[68:71], v[156:159], v[28:31]
    ds_read_b128 v[56:59], v14 offset:3072
    v_mfma_f32_16x16x32_bf16 v[188:191], v[72:75], v[160:163], v[188:191]
    ds_read_b128 v[60:63], v14 offset:4096
    v_mfma_f32_16x16x32_bf16 v[32:35], v[72:75], v[156:159], v[32:35]
    buffer_load_dwordx4 v[144:147], v2, s[8:11], s59 offen offset:2048
    s_add_u32 s59, s59, 4096
    v_mfma_f32_16x16x32_bf16 v[192:195], v[76:79], v[160:163], v[192:195]
    v_mfma_f32_16x16x32_bf16 v[36:39], v[76:79], v[156:159], v[36:39]
    buffer_load_dwordx4 v[148:151], v2, s[8:11], s53 offen offset:0
    v_mfma_f32_16x16x32_bf16 v[196:199], v[80:83], v[160:163], v[196:199]
    v_mfma_f32_16x16x32_bf16 v[40:43], v[80:83], v[156:159], v[40:43]
    s_waitcnt vmcnt(11) lgkmcnt(0)
    v_mfma_f32_16x16x32_bf16 v[180:183], v[44:47], v[168:171], v[180:183]
    ds_read_b128 v[64:67], v14 offset:10240
    v_mfma_f32_16x16x32_bf16 v[24:27], v[44:47], v[164:167], v[24:27]
    ds_read_b128 v[68:71], v14 offset:11264
    v_mfma_f32_16x16x32_bf16 v[184:187], v[48:51], v[168:171], v[184:187]
    ds_read_b128 v[72:75], v14 offset:12288
    v_mfma_f32_16x16x32_bf16 v[28:31], v[48:51], v[164:167], v[28:31]
    ds_read_b128 v[76:79], v14 offset:13312
    v_mfma_f32_16x16x32_bf16 v[188:191], v[52:55], v[168:171], v[188:191]
    ds_read_b128 v[80:83], v14 offset:14336
    v_mfma_f32_16x16x32_bf16 v[32:35], v[52:55], v[164:167], v[32:35]
    buffer_load_dwordx4 v[152:155], v2, s[8:11], s59 offen offset:0
    v_mfma_f32_16x16x32_bf16 v[192:195], v[56:59], v[168:171], v[192:195]
    v_mfma_f32_16x16x32_bf16 v[36:39], v[56:59], v[164:167], v[36:39]
    buffer_load_dwordx4 v[156:159], v2, s[8:11], s53 offen offset:2048
    s_add_u32 s53, s53, 4096
    v_mfma_f32_16x16x32_bf16 v[196:199], v[60:63], v[168:171], v[196:199]
    v_mfma_f32_16x16x32_bf16 v[40:43], v[60:63], v[164:167], v[40:43]
    s_waitcnt vmcnt(11) lgkmcnt(0)
    v_mfma_f32_16x16x32_bf16 v[180:183], v[64:67], v[176:179], v[180:183]
    v_mfma_f32_16x16x32_bf16 v[24:27], v[64:67], v[172:175], v[24:27]
    s_barrier
    ds_read_b128 v[44:47], v14 offset:20480
    v_mfma_f32_16x16x32_bf16 v[184:187], v[68:71], v[176:179], v[184:187]
    ds_read_b128 v[48:51], v14 offset:21504
    v_mfma_f32_16x16x32_bf16 v[28:31], v[68:71], v[172:175], v[28:31]
    ds_read_b128 v[52:55], v14 offset:22528
    v_mfma_f32_16x16x32_bf16 v[188:191], v[72:75], v[176:179], v[188:191]
    ds_read_b128 v[56:59], v14 offset:23552
    v_mfma_f32_16x16x32_bf16 v[32:35], v[72:75], v[172:175], v[32:35]
    ds_read_b128 v[60:63], v14 offset:24576
    buffer_load_dwordx4 v[160:163], v2, s[8:11], s59 offen offset:2048
    s_add_u32 s59, s59, 4096
    v_mfma_f32_16x16x32_bf16 v[192:195], v[76:79], v[176:179], v[192:195]
    v_mfma_f32_16x16x32_bf16 v[36:39], v[76:79], v[172:175], v[36:39]
    buffer_load_dwordx4 v[164:167], v2, s[8:11], s53 offen offset:0
    v_mfma_f32_16x16x32_bf16 v[196:199], v[80:83], v[176:179], v[196:199]
    v_mfma_f32_16x16x32_bf16 v[40:43], v[80:83], v[172:175], v[40:43]
    s_waitcnt vmcnt(11) lgkmcnt(0)
    v_mfma_f32_16x16x32_bf16 v[180:183], v[44:47], v[120:123], v[180:183]
    ds_read_b128 v[64:67], v14 offset:30720
    v_mfma_f32_16x16x32_bf16 v[24:27], v[44:47], v[116:119], v[24:27]
    ds_read_b128 v[68:71], v14 offset:31744
    v_mfma_f32_16x16x32_bf16 v[184:187], v[48:51], v[120:123], v[184:187]
    ds_read_b128 v[72:75], v14 offset:32768
    v_mfma_f32_16x16x32_bf16 v[28:31], v[48:51], v[116:119], v[28:31]
    ds_read_b128 v[76:79], v14 offset:33792
    v_mfma_f32_16x16x32_bf16 v[188:191], v[52:55], v[120:123], v[188:191]
    ds_read_b128 v[80:83], v14 offset:34816
    v_mfma_f32_16x16x32_bf16 v[32:35], v[52:55], v[116:119], v[32:35]
    buffer_load_dwordx4 v[168:171], v2, s[8:11], s59 offen offset:0
    v_mfma_f32_16x16x32_bf16 v[192:195], v[56:59], v[120:123], v[192:195]
    v_mfma_f32_16x16x32_bf16 v[36:39], v[56:59], v[116:119], v[36:39]
    buffer_load_dwordx4 v[172:175], v2, s[8:11], s53 offen offset:2048
    s_add_u32 s53, s53, 4096
    v_mfma_f32_16x16x32_bf16 v[196:199], v[60:63], v[120:123], v[196:199]
    v_mfma_f32_16x16x32_bf16 v[40:43], v[60:63], v[116:119], v[40:43]
    s_waitcnt vmcnt(11) lgkmcnt(0)
    v_mfma_f32_16x16x32_bf16 v[180:183], v[64:67], v[128:131], v[180:183]
    ds_read_b128 v[44:47], v14 offset:40960
    v_mfma_f32_16x16x32_bf16 v[24:27], v[64:67], v[124:127], v[24:27]
    ds_read_b128 v[48:51], v14 offset:41984
    v_mfma_f32_16x16x32_bf16 v[184:187], v[68:71], v[128:131], v[184:187]
    ds_read_b128 v[52:55], v14 offset:43008
    v_mfma_f32_16x16x32_bf16 v[28:31], v[68:71], v[124:127], v[28:31]
    ds_read_b128 v[56:59], v14 offset:44032
    v_mfma_f32_16x16x32_bf16 v[188:191], v[72:75], v[128:131], v[188:191]
    ds_read_b128 v[60:63], v14 offset:45056
    v_mfma_f32_16x16x32_bf16 v[32:35], v[72:75], v[124:127], v[32:35]
    buffer_load_dwordx4 v[176:179], v2, s[8:11], s59 offen offset:2048
    s_add_u32 s59, s59, 4096
    v_mfma_f32_16x16x32_bf16 v[192:195], v[76:79], v[128:131], v[192:195]
    v_mfma_f32_16x16x32_bf16 v[36:39], v[76:79], v[124:127], v[36:39]
    buffer_load_dwordx4 v[116:119], v2, s[8:11], s53 offen offset:0
    v_mfma_f32_16x16x32_bf16 v[196:199], v[80:83], v[128:131], v[196:199]
    v_mfma_f32_16x16x32_bf16 v[40:43], v[80:83], v[124:127], v[40:43]
    s_waitcnt vmcnt(11) lgkmcnt(0)
    v_mfma_f32_16x16x32_bf16 v[180:183], v[44:47], v[136:139], v[180:183]
    ds_read_b128 v[64:67], v14 offset:51200
    v_mfma_f32_16x16x32_bf16 v[24:27], v[44:47], v[132:135], v[24:27]
    ds_read_b128 v[68:71], v14 offset:52224
    v_mfma_f32_16x16x32_bf16 v[184:187], v[48:51], v[136:139], v[184:187]
    ds_read_b128 v[72:75], v14 offset:53248
    v_mfma_f32_16x16x32_bf16 v[28:31], v[48:51], v[132:135], v[28:31]
    ds_read_b128 v[76:79], v14 offset:54272
    v_mfma_f32_16x16x32_bf16 v[188:191], v[52:55], v[136:139], v[188:191]
    ds_read_b128 v[80:83], v14 offset:55296
    v_mfma_f32_16x16x32_bf16 v[32:35], v[52:55], v[132:135], v[32:35]
    buffer_load_dwordx4 v[120:123], v2, s[8:11], s59 offen offset:0
    v_mfma_f32_16x16x32_bf16 v[192:195], v[56:59], v[136:139], v[192:195]
    v_mfma_f32_16x16x32_bf16 v[36:39], v[56:59], v[132:135], v[36:39]
    buffer_load_dwordx4 v[124:127], v2, s[8:11], s53 offen offset:2048
    s_add_u32 s53, s53, 4096
    v_mfma_f32_16x16x32_bf16 v[196:199], v[60:63], v[136:139], v[196:199]
    v_mfma_f32_16x16x32_bf16 v[40:43], v[60:63], v[132:135], v[40:43]
    s_waitcnt vmcnt(11) lgkmcnt(0)
    v_mfma_f32_16x16x32_bf16 v[180:183], v[64:67], v[144:147], v[180:183]
    v_mfma_f32_16x16x32_bf16 v[24:27], v[64:67], v[140:143], v[24:27]
    s_barrier
    ds_read_b128 v[44:47], v15 offset:0
    v_mfma_f32_16x16x32_bf16 v[184:187], v[68:71], v[144:147], v[184:187]
    ds_read_b128 v[48:51], v15 offset:1024
    v_mfma_f32_16x16x32_bf16 v[28:31], v[68:71], v[140:143], v[28:31]
    ds_read_b128 v[52:55], v15 offset:2048
    v_mfma_f32_16x16x32_bf16 v[188:191], v[72:75], v[144:147], v[188:191]
    ds_read_b128 v[56:59], v15 offset:3072
    v_mfma_f32_16x16x32_bf16 v[32:35], v[72:75], v[140:143], v[32:35]
    ds_read_b128 v[60:63], v15 offset:4096
    buffer_load_dwordx4 v[128:131], v2, s[8:11], s59 offen offset:2048
    s_add_u32 s59, s59, 4096
    v_mfma_f32_16x16x32_bf16 v[192:195], v[76:79], v[144:147], v[192:195]
    v_mfma_f32_16x16x32_bf16 v[36:39], v[76:79], v[140:143], v[36:39]
    buffer_load_dwordx4 v[132:135], v2, s[8:11], s53 offen offset:0
    v_mfma_f32_16x16x32_bf16 v[196:199], v[80:83], v[144:147], v[196:199]
    v_mfma_f32_16x16x32_bf16 v[40:43], v[80:83], v[140:143], v[40:43]
    s_waitcnt vmcnt(11) lgkmcnt(0)
    v_mfma_f32_16x16x32_bf16 v[180:183], v[44:47], v[152:155], v[180:183]
    ds_read_b128 v[64:67], v15 offset:10240
    v_mfma_f32_16x16x32_bf16 v[24:27], v[44:47], v[148:151], v[24:27]
    ds_read_b128 v[68:71], v15 offset:11264
    v_mfma_f32_16x16x32_bf16 v[184:187], v[48:51], v[152:155], v[184:187]
    ds_read_b128 v[72:75], v15 offset:12288
    v_mfma_f32_16x16x32_bf16 v[28:31], v[48:51], v[148:151], v[28:31]
    ds_read_b128 v[76:79], v15 offset:13312
    v_mfma_f32_16x16x32_bf16 v[188:191], v[52:55], v[152:155], v[188:191]
    ds_read_b128 v[80:83], v15 offset:14336
    v_mfma_f32_16x16x32_bf16 v[32:35], v[52:55], v[148:151], v[32:35]
    buffer_load_dwordx4 v[136:139], v2, s[8:11], s59 offen offset:0
    v_mfma_f32_16x16x32_bf16 v[192:195], v[56:59], v[152:155], v[192:195]
    v_mfma_f32_16x16x32_bf16 v[36:39], v[56:59], v[148:151], v[36:39]
    buffer_load_dwordx4 v[140:143], v2, s[8:11], s53 offen offset:2048
    s_add_u32 s53, s53, 4096
    v_mfma_f32_16x16x32_bf16 v[196:199], v[60:63], v[152:155], v[196:199]
    v_mfma_f32_16x16x32_bf16 v[40:43], v[60:63], v[148:151], v[40:43]
    s_waitcnt vmcnt(11) lgkmcnt(0)
    v_mfma_f32_16x16x32_bf16 v[180:183], v[64:67], v[160:163], v[180:183]
    ds_read_b128 v[44:47], v13 offset:0
    v_mfma_f32_16x16x32_bf16 v[24:27], v[64:67], v[156:159], v[24:27]
    ds_read_b128 v[48:51], v13 offset:1024
    v_mfma_f32_16x16x32_bf16 v[184:187], v[68:71], v[160:163], v[184:187]
    ds_read_b128 v[52:55], v13 offset:2048
    v_mfma_f32_16x16x32_bf16 v[28:31], v[68:71], v[156:159], v[28:31]
    ds_read_b128 v[56:59], v13 offset:3072
    v_mfma_f32_16x16x32_bf16 v[188:191], v[72:75], v[160:163], v[188:191]
    ds_read_b128 v[60:63], v13 offset:4096
    v_mfma_f32_16x16x32_bf16 v[32:35], v[72:75], v[156:159], v[32:35]
    buffer_load_dwordx4 v[144:147], v2, s[8:11], s59 offen offset:2048
    s_add_u32 s59, s59, 4096
    v_mfma_f32_16x16x32_bf16 v[192:195], v[76:79], v[160:163], v[192:195]
    v_mfma_f32_16x16x32_bf16 v[36:39], v[76:79], v[156:159], v[36:39]
    buffer_load_dwordx4 v[148:151], v2, s[8:11], s53 offen offset:0
    v_mfma_f32_16x16x32_bf16 v[196:199], v[80:83], v[160:163], v[196:199]
    v_mfma_f32_16x16x32_bf16 v[40:43], v[80:83], v[156:159], v[40:43]
    s_waitcnt vmcnt(11) lgkmcnt(0)
    v_mfma_f32_16x16x32_bf16 v[180:183], v[44:47], v[168:171], v[180:183]
    ds_read_b128 v[64:67], v13 offset:10240
    v_mfma_f32_16x16x32_bf16 v[24:27], v[44:47], v[164:167], v[24:27]
    ds_read_b128 v[68:71], v13 offset:11264
    v_mfma_f32_16x16x32_bf16 v[184:187], v[48:51], v[168:171], v[184:187]
    ds_read_b128 v[72:75], v13 offset:12288
    v_mfma_f32_16x16x32_bf16 v[28:31], v[48:51], v[164:167], v[28:31]
    ds_read_b128 v[76:79], v13 offset:13312
    v_mfma_f32_16x16x32_bf16 v[188:191], v[52:55], v[168:171], v[188:191]
    ds_read_b128 v[80:83], v13 offset:14336
    v_mfma_f32_16x16x32_bf16 v[32:35], v[52:55], v[164:167], v[32:35]
    buffer_load_dwordx4 v[152:155], v2, s[8:11], s59 offen offset:0
    v_mfma_f32_16x16x32_bf16 v[192:195], v[56:59], v[168:171], v[192:195]
    v_mfma_f32_16x16x32_bf16 v[36:39], v[56:59], v[164:167], v[36:39]
    buffer_load_dwordx4 v[156:159], v2, s[8:11], s53 offen offset:2048
    s_add_u32 s53, s53, 4096
    v_mfma_f32_16x16x32_bf16 v[196:199], v[60:63], v[168:171], v[196:199]
    v_mfma_f32_16x16x32_bf16 v[40:43], v[60:63], v[164:167], v[40:43]
    s_waitcnt vmcnt(11) lgkmcnt(0)
    v_mfma_f32_16x16x32_bf16 v[180:183], v[64:67], v[176:179], v[180:183]
    v_mfma_f32_16x16x32_bf16 v[24:27], v[64:67], v[172:175], v[24:27]
    s_barrier
    ds_read_b128 v[44:47], v13 offset:20480
    v_mfma_f32_16x16x32_bf16 v[184:187], v[68:71], v[176:179], v[184:187]
    ds_read_b128 v[48:51], v13 offset:21504
    v_mfma_f32_16x16x32_bf16 v[28:31], v[68:71], v[172:175], v[28:31]
    ds_read_b128 v[52:55], v13 offset:22528
    v_mfma_f32_16x16x32_bf16 v[188:191], v[72:75], v[176:179], v[188:191]
    ds_read_b128 v[56:59], v13 offset:23552
    v_mfma_f32_16x16x32_bf16 v[32:35], v[72:75], v[172:175], v[32:35]
    ds_read_b128 v[60:63], v13 offset:24576
    buffer_load_dwordx4 v[160:163], v2, s[8:11], s59 offen offset:2048
    s_add_u32 s59, s59, 4096
    v_mfma_f32_16x16x32_bf16 v[192:195], v[76:79], v[176:179], v[192:195]
    v_mfma_f32_16x16x32_bf16 v[36:39], v[76:79], v[172:175], v[36:39]
    buffer_load_dwordx4 v[164:167], v2, s[8:11], s53 offen offset:0
    v_mfma_f32_16x16x32_bf16 v[196:199], v[80:83], v[176:179], v[196:199]
    v_mfma_f32_16x16x32_bf16 v[40:43], v[80:83], v[172:175], v[40:43]
    s_waitcnt vmcnt(11) lgkmcnt(0)
    v_mfma_f32_16x16x32_bf16 v[180:183], v[44:47], v[120:123], v[180:183]
    ds_read_b128 v[64:67], v13 offset:30720
    v_mfma_f32_16x16x32_bf16 v[24:27], v[44:47], v[116:119], v[24:27]
    ds_read_b128 v[68:71], v13 offset:31744
    v_mfma_f32_16x16x32_bf16 v[184:187], v[48:51], v[120:123], v[184:187]
    ds_read_b128 v[72:75], v13 offset:32768
    v_mfma_f32_16x16x32_bf16 v[28:31], v[48:51], v[116:119], v[28:31]
    ds_read_b128 v[76:79], v13 offset:33792
    v_mfma_f32_16x16x32_bf16 v[188:191], v[52:55], v[120:123], v[188:191]
    ds_read_b128 v[80:83], v13 offset:34816
    v_mfma_f32_16x16x32_bf16 v[32:35], v[52:55], v[116:119], v[32:35]
    buffer_load_dwordx4 v[168:171], v2, s[8:11], s59 offen offset:0
    v_mfma_f32_16x16x32_bf16 v[192:195], v[56:59], v[120:123], v[192:195]
    v_mfma_f32_16x16x32_bf16 v[36:39], v[56:59], v[116:119], v[36:39]
    buffer_load_dwordx4 v[172:175], v2, s[8:11], s53 offen offset:2048
    s_add_u32 s53, s53, 4096
    v_mfma_f32_16x16x32_bf16 v[196:199], v[60:63], v[120:123], v[196:199]
    v_mfma_f32_16x16x32_bf16 v[40:43], v[60:63], v[116:119], v[40:43]
    s_waitcnt vmcnt(11) lgkmcnt(0)
    v_mfma_f32_16x16x32_bf16 v[180:183], v[64:67], v[128:131], v[180:183]
    ds_read_b128 v[44:47], v13 offset:40960
    v_mfma_f32_16x16x32_bf16 v[24:27], v[64:67], v[124:127], v[24:27]
    ds_read_b128 v[48:51], v13 offset:41984
    v_mfma_f32_16x16x32_bf16 v[184:187], v[68:71], v[128:131], v[184:187]
    ds_read_b128 v[52:55], v13 offset:43008
    v_mfma_f32_16x16x32_bf16 v[28:31], v[68:71], v[124:127], v[28:31]
    ds_read_b128 v[56:59], v13 offset:44032
    v_mfma_f32_16x16x32_bf16 v[188:191], v[72:75], v[128:131], v[188:191]
    ds_read_b128 v[60:63], v13 offset:45056
    v_mfma_f32_16x16x32_bf16 v[32:35], v[72:75], v[124:127], v[32:35]
    buffer_load_dwordx4 v[176:179], v2, s[8:11], s59 offen offset:2048
    s_add_u32 s59, s59, 4096
    v_mfma_f32_16x16x32_bf16 v[192:195], v[76:79], v[128:131], v[192:195]
    v_mfma_f32_16x16x32_bf16 v[36:39], v[76:79], v[124:127], v[36:39]
    buffer_load_dwordx4 v[116:119], v2, s[8:11], s53 offen offset:0
    v_mfma_f32_16x16x32_bf16 v[196:199], v[80:83], v[128:131], v[196:199]
    v_mfma_f32_16x16x32_bf16 v[40:43], v[80:83], v[124:127], v[40:43]
    s_waitcnt vmcnt(11) lgkmcnt(0)
    v_mfma_f32_16x16x32_bf16 v[180:183], v[44:47], v[136:139], v[180:183]
    ds_read_b128 v[64:67], v13 offset:51200
    v_mfma_f32_16x16x32_bf16 v[24:27], v[44:47], v[132:135], v[24:27]
    ds_read_b128 v[68:71], v13 offset:52224
    v_mfma_f32_16x16x32_bf16 v[184:187], v[48:51], v[136:139], v[184:187]
    ds_read_b128 v[72:75], v13 offset:53248
    v_mfma_f32_16x16x32_bf16 v[28:31], v[48:51], v[132:135], v[28:31]
    ds_read_b128 v[76:79], v13 offset:54272
    v_mfma_f32_16x16x32_bf16 v[188:191], v[52:55], v[136:139], v[188:191]
    ds_read_b128 v[80:83], v13 offset:55296
    v_mfma_f32_16x16x32_bf16 v[32:35], v[52:55], v[132:135], v[32:35]
    buffer_load_dwordx4 v[120:123], v2, s[8:11], s59 offen offset:0
    v_mfma_f32_16x16x32_bf16 v[192:195], v[56:59], v[136:139], v[192:195]
    v_mfma_f32_16x16x32_bf16 v[36:39], v[56:59], v[132:135], v[36:39]
    buffer_load_dwordx4 v[124:127], v2, s[8:11], s53 offen offset:2048
    s_add_u32 s53, s53, 4096
    v_mfma_f32_16x16x32_bf16 v[196:199], v[60:63], v[136:139], v[196:199]
    v_mfma_f32_16x16x32_bf16 v[40:43], v[60:63], v[132:135], v[40:43]
    s_waitcnt vmcnt(11) lgkmcnt(0)
    v_mfma_f32_16x16x32_bf16 v[180:183], v[64:67], v[144:147], v[180:183]
    v_mfma_f32_16x16x32_bf16 v[24:27], v[64:67], v[140:143], v[24:27]
    s_barrier
    ds_read_b128 v[44:47], v14 offset:0
    v_mfma_f32_16x16x32_bf16 v[184:187], v[68:71], v[144:147], v[184:187]
    ds_read_b128 v[48:51], v14 offset:1024
    v_mfma_f32_16x16x32_bf16 v[28:31], v[68:71], v[140:143], v[28:31]
    ds_read_b128 v[52:55], v14 offset:2048
    v_mfma_f32_16x16x32_bf16 v[188:191], v[72:75], v[144:147], v[188:191]
    ds_read_b128 v[56:59], v14 offset:3072
    v_mfma_f32_16x16x32_bf16 v[32:35], v[72:75], v[140:143], v[32:35]
    ds_read_b128 v[60:63], v14 offset:4096
    buffer_load_dwordx4 v[128:131], v2, s[8:11], s59 offen offset:2048
    s_add_u32 s59, s59, 4096
    v_mfma_f32_16x16x32_bf16 v[192:195], v[76:79], v[144:147], v[192:195]
    v_mfma_f32_16x16x32_bf16 v[36:39], v[76:79], v[140:143], v[36:39]
    buffer_load_dwordx4 v[132:135], v2, s[8:11], s53 offen offset:0
    v_mfma_f32_16x16x32_bf16 v[196:199], v[80:83], v[144:147], v[196:199]
    v_mfma_f32_16x16x32_bf16 v[40:43], v[80:83], v[140:143], v[40:43]
    s_waitcnt vmcnt(11) lgkmcnt(0)
    v_mfma_f32_16x16x32_bf16 v[180:183], v[44:47], v[152:155], v[180:183]
    ds_read_b128 v[64:67], v14 offset:10240
    v_mfma_f32_16x16x32_bf16 v[24:27], v[44:47], v[148:151], v[24:27]
    ds_read_b128 v[68:71], v14 offset:11264
    v_mfma_f32_16x16x32_bf16 v[184:187], v[48:51], v[152:155], v[184:187]
    ds_read_b128 v[72:75], v14 offset:12288
    v_mfma_f32_16x16x32_bf16 v[28:31], v[48:51], v[148:151], v[28:31]
    ds_read_b128 v[76:79], v14 offset:13312
    v_mfma_f32_16x16x32_bf16 v[188:191], v[52:55], v[152:155], v[188:191]
    ds_read_b128 v[80:83], v14 offset:14336
    v_mfma_f32_16x16x32_bf16 v[32:35], v[52:55], v[148:151], v[32:35]
    buffer_load_dwordx4 v[136:139], v2, s[8:11], s59 offen offset:0
    v_mfma_f32_16x16x32_bf16 v[192:195], v[56:59], v[152:155], v[192:195]
    v_mfma_f32_16x16x32_bf16 v[36:39], v[56:59], v[148:151], v[36:39]
    v_mfma_f32_16x16x32_bf16 v[196:199], v[60:63], v[152:155], v[196:199]
    v_mfma_f32_16x16x32_bf16 v[40:43], v[60:63], v[148:151], v[40:43]
    s_waitcnt vmcnt(10) lgkmcnt(0)
    v_mfma_f32_16x16x32_bf16 v[180:183], v[64:67], v[160:163], v[180:183]
    ds_read_b128 v[44:47], v14 offset:20480
    v_mfma_f32_16x16x32_bf16 v[24:27], v[64:67], v[156:159], v[24:27]
    ds_read_b128 v[48:51], v14 offset:21504
    v_mfma_f32_16x16x32_bf16 v[184:187], v[68:71], v[160:163], v[184:187]
    ds_read_b128 v[52:55], v14 offset:22528
    v_mfma_f32_16x16x32_bf16 v[28:31], v[68:71], v[156:159], v[28:31]
    ds_read_b128 v[56:59], v14 offset:23552
    v_mfma_f32_16x16x32_bf16 v[188:191], v[72:75], v[160:163], v[188:191]
    ds_read_b128 v[60:63], v14 offset:24576
    v_mfma_f32_16x16x32_bf16 v[32:35], v[72:75], v[156:159], v[32:35]
    v_mfma_f32_16x16x32_bf16 v[192:195], v[76:79], v[160:163], v[192:195]
    v_mfma_f32_16x16x32_bf16 v[36:39], v[76:79], v[156:159], v[36:39]
    v_mfma_f32_16x16x32_bf16 v[196:199], v[80:83], v[160:163], v[196:199]
    v_mfma_f32_16x16x32_bf16 v[40:43], v[80:83], v[156:159], v[40:43]
    s_waitcnt vmcnt(8) lgkmcnt(0)
    v_mfma_f32_16x16x32_bf16 v[180:183], v[44:47], v[168:171], v[180:183]
    ds_read_b128 v[64:67], v14 offset:30720
    v_mfma_f32_16x16x32_bf16 v[24:27], v[44:47], v[164:167], v[24:27]
    ds_read_b128 v[68:71], v14 offset:31744
    v_mfma_f32_16x16x32_bf16 v[184:187], v[48:51], v[168:171], v[184:187]
    ds_read_b128 v[72:75], v14 offset:32768
    v_mfma_f32_16x16x32_bf16 v[28:31], v[48:51], v[164:167], v[28:31]
    ds_read_b128 v[76:79], v14 offset:33792
    v_mfma_f32_16x16x32_bf16 v[188:191], v[52:55], v[168:171], v[188:191]
    ds_read_b128 v[80:83], v14 offset:34816
    v_mfma_f32_16x16x32_bf16 v[32:35], v[52:55], v[164:167], v[32:35]
    v_mfma_f32_16x16x32_bf16 v[192:195], v[56:59], v[168:171], v[192:195]
    v_mfma_f32_16x16x32_bf16 v[36:39], v[56:59], v[164:167], v[36:39]
    v_mfma_f32_16x16x32_bf16 v[196:199], v[60:63], v[168:171], v[196:199]
    v_mfma_f32_16x16x32_bf16 v[40:43], v[60:63], v[164:167], v[40:43]
    s_waitcnt vmcnt(6) lgkmcnt(0)
    v_mfma_f32_16x16x32_bf16 v[180:183], v[64:67], v[176:179], v[180:183]
    v_mfma_f32_16x16x32_bf16 v[24:27], v[64:67], v[172:175], v[24:27]
    s_barrier
    ds_read_b128 v[44:47], v14 offset:40960
    v_mfma_f32_16x16x32_bf16 v[184:187], v[68:71], v[176:179], v[184:187]
    ds_read_b128 v[48:51], v14 offset:41984
    v_mfma_f32_16x16x32_bf16 v[28:31], v[68:71], v[172:175], v[28:31]
    ds_read_b128 v[52:55], v14 offset:43008
    v_mfma_f32_16x16x32_bf16 v[188:191], v[72:75], v[176:179], v[188:191]
    ds_read_b128 v[56:59], v14 offset:44032
    v_mfma_f32_16x16x32_bf16 v[32:35], v[72:75], v[172:175], v[32:35]
    ds_read_b128 v[60:63], v14 offset:45056
    v_mfma_f32_16x16x32_bf16 v[192:195], v[76:79], v[176:179], v[192:195]
    v_mfma_f32_16x16x32_bf16 v[36:39], v[76:79], v[172:175], v[36:39]
    v_mfma_f32_16x16x32_bf16 v[196:199], v[80:83], v[176:179], v[196:199]
    v_mfma_f32_16x16x32_bf16 v[40:43], v[80:83], v[172:175], v[40:43]
    s_waitcnt vmcnt(4) lgkmcnt(0)
    v_mfma_f32_16x16x32_bf16 v[180:183], v[44:47], v[120:123], v[180:183]
    ds_read_b128 v[64:67], v14 offset:51200
    v_mfma_f32_16x16x32_bf16 v[24:27], v[44:47], v[116:119], v[24:27]
    ds_read_b128 v[68:71], v14 offset:52224
    v_mfma_f32_16x16x32_bf16 v[184:187], v[48:51], v[120:123], v[184:187]
    ds_read_b128 v[72:75], v14 offset:53248
    v_mfma_f32_16x16x32_bf16 v[28:31], v[48:51], v[116:119], v[28:31]
    ds_read_b128 v[76:79], v14 offset:54272
    v_mfma_f32_16x16x32_bf16 v[188:191], v[52:55], v[120:123], v[188:191]
    ds_read_b128 v[80:83], v14 offset:55296
    v_mfma_f32_16x16x32_bf16 v[32:35], v[52:55], v[116:119], v[32:35]
    v_mfma_f32_16x16x32_bf16 v[192:195], v[56:59], v[120:123], v[192:195]
    v_mfma_f32_16x16x32_bf16 v[36:39], v[56:59], v[116:119], v[36:39]
    v_mfma_f32_16x16x32_bf16 v[196:199], v[60:63], v[120:123], v[196:199]
    v_mfma_f32_16x16x32_bf16 v[40:43], v[60:63], v[116:119], v[40:43]
    s_waitcnt vmcnt(2) lgkmcnt(0)
    v_mfma_f32_16x16x32_bf16 v[180:183], v[64:67], v[128:131], v[180:183]
    ds_read_b128 v[44:47], v15 offset:0
    v_mfma_f32_16x16x32_bf16 v[24:27], v[64:67], v[124:127], v[24:27]
    ds_read_b128 v[48:51], v15 offset:1024
    v_mfma_f32_16x16x32_bf16 v[184:187], v[68:71], v[128:131], v[184:187]
    ds_read_b128 v[52:55], v15 offset:2048
    v_mfma_f32_16x16x32_bf16 v[28:31], v[68:71], v[124:127], v[28:31]
    ds_read_b128 v[56:59], v15 offset:3072
    v_mfma_f32_16x16x32_bf16 v[188:191], v[72:75], v[128:131], v[188:191]
    ds_read_b128 v[60:63], v15 offset:4096
    v_mfma_f32_16x16x32_bf16 v[32:35], v[72:75], v[124:127], v[32:35]
    v_mfma_f32_16x16x32_bf16 v[192:195], v[76:79], v[128:131], v[192:195]
    v_mfma_f32_16x16x32_bf16 v[36:39], v[76:79], v[124:127], v[36:39]
    v_mfma_f32_16x16x32_bf16 v[196:199], v[80:83], v[128:131], v[196:199]
    v_mfma_f32_16x16x32_bf16 v[40:43], v[80:83], v[124:127], v[40:43]
    s_waitcnt vmcnt(0) lgkmcnt(0)
    v_mfma_f32_16x16x32_bf16 v[180:183], v[44:47], v[136:139], v[180:183]
    v_mfma_f32_16x16x32_bf16 v[184:187], v[48:51], v[136:139], v[184:187]
    v_mfma_f32_16x16x32_bf16 v[188:191], v[52:55], v[136:139], v[188:191]
    v_mfma_f32_16x16x32_bf16 v[192:195], v[56:59], v[136:139], v[192:195]
    v_mfma_f32_16x16x32_bf16 v[196:199], v[60:63], v[136:139], v[196:199]
    v_mfma_f32_16x16x32_bf16 v[24:27], v[44:47], v[132:135], v[24:27]
    v_mfma_f32_16x16x32_bf16 v[28:31], v[48:51], v[132:135], v[28:31]
    v_mfma_f32_16x16x32_bf16 v[32:35], v[52:55], v[132:135], v[32:35]
    v_mfma_f32_16x16x32_bf16 v[36:39], v[56:59], v[132:135], v[36:39]
    v_mfma_f32_16x16x32_bf16 v[40:43], v[60:63], v[132:135], v[40:43]
    ds_write_b128 v200, v[180:183] offset:0
    ds_write_b128 v200, v[184:187] offset:1024
    ds_write_b128 v200, v[188:191] offset:2048
    ds_write_b128 v200, v[192:195] offset:3072
    ds_write_b128 v200, v[196:199] offset:4096
    s_waitcnt lgkmcnt(0)
    s_barrier
    ds_read_b128 v[116:119], v201 offset:0
    ds_read_b128 v[120:123], v201 offset:1024
    ds_read_b128 v[124:127], v201 offset:2048
    ds_read_b128 v[128:131], v201 offset:3072
    ds_read_b128 v[132:135], v201 offset:4096
    s_waitcnt lgkmcnt(4)
    v_pk_add_f32 v[24:25], v[24:25], v[116:117]
    v_pk_add_f32 v[26:27], v[26:27], v[118:119]
    s_waitcnt lgkmcnt(3)
    v_pk_add_f32 v[28:29], v[28:29], v[120:121]
    v_pk_add_f32 v[30:31], v[30:31], v[122:123]
    s_waitcnt lgkmcnt(2)
    v_pk_add_f32 v[32:33], v[32:33], v[124:125]
    v_pk_add_f32 v[34:35], v[34:35], v[126:127]
    s_waitcnt lgkmcnt(1)
    v_pk_add_f32 v[36:37], v[36:37], v[128:129]
    v_pk_add_f32 v[38:39], v[38:39], v[130:131]
    s_waitcnt lgkmcnt(0)
    v_pk_add_f32 v[40:41], v[40:41], v[132:133]
    v_pk_add_f32 v[42:43], v[42:43], v[134:135]
    v_cvt_pk_bf16_f32 v64, v24, v25
    v_cvt_pk_bf16_f32 v65, v26, v27
    v_cvt_pk_bf16_f32 v66, v28, v29
    v_cvt_pk_bf16_f32 v67, v30, v31
    v_cvt_pk_bf16_f32 v68, v32, v33
    v_cvt_pk_bf16_f32 v69, v34, v35
    v_cvt_pk_bf16_f32 v70, v36, v37
    v_cvt_pk_bf16_f32 v71, v38, v39
    v_cvt_pk_bf16_f32 v72, v40, v41
    v_cvt_pk_bf16_f32 v73, v42, v43
    ds_write_b64 v12, v[64:65] offset:0
    ds_write_b64 v12, v[66:67] offset:32
    ds_write_b64 v12, v[68:69] offset:64
    ds_write_b64 v12, v[70:71] offset:96
    ds_write_b64 v12, v[72:73] offset:128
    v_add_u32 v5, s56, v2
    s_waitcnt lgkmcnt(0)
    ds_read_b128 v[44:47], v5 offset:0
    ds_read_b128 v[48:51], v5 offset:1024
    ds_read_b128 v[52:55], v5 offset:2048
    s_waitcnt lgkmcnt(2)
    buffer_store_dwordx4 v[44:47], v16, s[44:47], 0 offen
    s_waitcnt lgkmcnt(1)
    buffer_store_dwordx4 v[48:51], v17, s[44:47], 0 offen
    s_waitcnt lgkmcnt(0)
    s_mov_b32 exec_hi, 0
    buffer_store_dwordx4 v[52:55], v18, s[44:47], 0 offen
    s_mov_b32 exec_hi, -1
L_sequential_preLN__softmax_full_mha__swiglu_ffn__prompt_kernel_end_1:
    s_endpgm
L_sequential_preLN__softmax_full_mha__swiglu_ffn__prompt_kernel_ld_35:
    s_mul_i32 s54, s13, 8
    s_add_u32 s54, s54, s49
    s_mul_i32 s54, s54, 5120
    s_add_u32 s54, s54, 20971520
    s_mul_i32 s55, s13, 5120
    s_add_u32 s54, s54, 655360
    s_waitcnt vmcnt(0)
    s_barrier
    s_add_u32 m0, s55, 0
    s_add_u32 s52, s54, 4096
    buffer_load_dwordx4 v2, s[8:11], s54 offen offset:0 lds
    buffer_load_dwordx4 v2, s[8:11], s54 offen offset:1024 lds
    buffer_load_dwordx4 v2, s[8:11], s54 offen offset:2048 lds
    buffer_load_dwordx4 v2, s[8:11], s54 offen offset:3072 lds
    s_add_u32 m0, m0, 4096
    s_add_u32 s54, s54, 163840
    buffer_load_dwordx4 v2, s[8:11], s52 offen lds
    s_waitcnt vmcnt(0)
    s_barrier
    s_and_b32 s39, s2, 1
    s_lshl_b32 s39, s39, 3
    s_bfe_u32 s40, s2, 0x30003
    s_add_u32 s37, s39, s40
    s_lshl_b32 s37, s37, 2
    s_add_u32 s37, s37, s13
    s_bfe_u32 s39, s2, 0x20001
    s_lshl_b32 s39, s39, 2
    s_lshr_b32 s40, s2, 6
    s_add_u32 s38, s39, s40
    s_mul_i32 s43, s13, 16
    s_add_u32 s43, s43, s38
    s_mul_i32 s43, s43, 7168
    s_add_u32 s43, s43, 21889024
    s_mul_i32 s44, s13, 7168
    s_barrier
    s_add_u32 m0, s44, 0
    s_add_u32 s41, s43, 4096
    buffer_load_dwordx4 v2, s[8:11], s43 offen offset:0 lds
    buffer_load_dwordx4 v2, s[8:11], s43 offen offset:1024 lds
    buffer_load_dwordx4 v2, s[8:11], s43 offen offset:2048 lds
    buffer_load_dwordx4 v2, s[8:11], s43 offen offset:3072 lds
    s_add_u32 m0, m0, 4096
    s_add_u32 s43, s43, 458752
    buffer_load_dwordx4 v2, s[8:11], s41 offen offset:0 lds
    buffer_load_dwordx4 v2, s[8:11], s41 offen offset:1024 lds
    buffer_load_dwordx4 v2, s[8:11], s41 offen offset:2048 lds
    s_add_u32 m0, s44, 28672
    s_add_u32 s41, s43, 4096
    buffer_load_dwordx4 v2, s[8:11], s43 offen offset:0 lds
    buffer_load_dwordx4 v2, s[8:11], s43 offen offset:1024 lds
    buffer_load_dwordx4 v2, s[8:11], s43 offen offset:2048 lds
    buffer_load_dwordx4 v2, s[8:11], s43 offen offset:3072 lds
    s_add_u32 m0, m0, 4096
    s_add_u32 s43, s43, 458752
    buffer_load_dwordx4 v2, s[8:11], s41 offen offset:0 lds
    buffer_load_dwordx4 v2, s[8:11], s41 offen offset:1024 lds
    buffer_load_dwordx4 v2, s[8:11], s41 offen offset:2048 lds
    s_barrier
    s_add_u32 m0, s44, 57344
    s_add_u32 s41, s43, 4096
    buffer_load_dwordx4 v2, s[8:11], s43 offen offset:0 lds
    buffer_load_dwordx4 v2, s[8:11], s43 offen offset:1024 lds
    buffer_load_dwordx4 v2, s[8:11], s43 offen offset:2048 lds
    buffer_load_dwordx4 v2, s[8:11], s43 offen offset:3072 lds
    s_add_u32 m0, m0, 4096
    s_add_u32 s43, s43, 458752
    buffer_load_dwordx4 v2, s[8:11], s41 offen offset:0 lds
    buffer_load_dwordx4 v2, s[8:11], s41 offen offset:1024 lds
    buffer_load_dwordx4 v2, s[8:11], s41 offen offset:2048 lds
    s_add_u32 m0, s44, 86016
    s_add_u32 s41, s43, 4096
    buffer_load_dwordx4 v2, s[8:11], s43 offen offset:0 lds
    buffer_load_dwordx4 v2, s[8:11], s43 offen offset:1024 lds
    buffer_load_dwordx4 v2, s[8:11], s43 offen offset:2048 lds
    buffer_load_dwordx4 v2, s[8:11], s43 offen offset:3072 lds
    s_add_u32 m0, m0, 4096
    s_add_u32 s43, s43, 458752
    buffer_load_dwordx4 v2, s[8:11], s41 offen offset:0 lds
    buffer_load_dwordx4 v2, s[8:11], s41 offen offset:1024 lds
    buffer_load_dwordx4 v2, s[8:11], s41 offen offset:2048 lds
    s_add_u32 m0, s44, 114688
    s_add_u32 s41, s43, 4096
    buffer_load_dwordx4 v2, s[8:11], s43 offen offset:0 lds
    buffer_load_dwordx4 v2, s[8:11], s43 offen offset:1024 lds
    buffer_load_dwordx4 v2, s[8:11], s43 offen offset:2048 lds
    buffer_load_dwordx4 v2, s[8:11], s43 offen offset:3072 lds
    s_add_u32 m0, m0, 4096
    s_add_u32 s43, s43, 458752
    buffer_load_dwordx4 v2, s[8:11], s41 offen offset:0 lds
    buffer_load_dwordx4 v2, s[8:11], s41 offen offset:1024 lds
    buffer_load_dwordx4 v2, s[8:11], s41 offen offset:2048 lds
    s_mul_i32 s41, s38, 896
    s_mov_b32 m0, 143360
    s_add_u32 s41, s41, 13500416
    buffer_load_dwordx4 v2, s[8:11], s41 offen lds
    s_waitcnt vmcnt(29)
    s_barrier
    s_lshr_b32 s39, s37, 2
    s_lshl_b32 s39, s39, 10
    s_lshl_b32 s40, s13, 15
    s_add_u32 s39, s39, s40
    s_add_u32 s39, s39, 13369344
    s_lshl_b32 s40, s13, 11
    s_add_u32 m0, s40, 144384
    s_add_u32 s40, s39, 15360
    buffer_load_dwordx4 v2, s[8:11], s39 offen lds
    buffer_load_dwordx4 v2, s[8:11], s40 offen offset:1024 lds
    s_waitcnt vmcnt(21)
    s_barrier
    s_add_u32 m0, s44, 0
    s_add_u32 s41, s43, 4096
    buffer_load_dwordx4 v2, s[8:11], s43 offen offset:0 lds
    buffer_load_dwordx4 v2, s[8:11], s43 offen offset:1024 lds
    buffer_load_dwordx4 v2, s[8:11], s43 offen offset:2048 lds
    buffer_load_dwordx4 v2, s[8:11], s43 offen offset:3072 lds
    s_add_u32 m0, m0, 4096
    s_add_u32 s43, s43, 458752
    buffer_load_dwordx4 v2, s[8:11], s41 offen offset:0 lds
    buffer_load_dwordx4 v2, s[8:11], s41 offen offset:1024 lds
    buffer_load_dwordx4 v2, s[8:11], s41 offen offset:2048 lds
    s_waitcnt vmcnt(21)
    s_barrier
    s_add_u32 m0, s44, 28672
    s_add_u32 s41, s43, 4096
    buffer_load_dwordx4 v2, s[8:11], s43 offen offset:0 lds
    buffer_load_dwordx4 v2, s[8:11], s43 offen offset:1024 lds
    buffer_load_dwordx4 v2, s[8:11], s43 offen offset:2048 lds
    buffer_load_dwordx4 v2, s[8:11], s43 offen offset:3072 lds
    s_add_u32 m0, m0, 4096
    s_add_u32 s43, s43, 458752
    buffer_load_dwordx4 v2, s[8:11], s41 offen offset:0 lds
    buffer_load_dwordx4 v2, s[8:11], s41 offen offset:1024 lds
    buffer_load_dwordx4 v2, s[8:11], s41 offen offset:2048 lds
    s_waitcnt vmcnt(21)
    s_barrier
    s_add_u32 m0, s44, 57344
    s_add_u32 s41, s43, 4096
    buffer_load_dwordx4 v2, s[8:11], s43 offen offset:0 lds
    buffer_load_dwordx4 v2, s[8:11], s43 offen offset:1024 lds
    buffer_load_dwordx4 v2, s[8:11], s43 offen offset:2048 lds
    buffer_load_dwordx4 v2, s[8:11], s43 offen offset:3072 lds
    s_add_u32 m0, m0, 4096
    s_add_u32 s43, s43, 458752
    buffer_load_dwordx4 v2, s[8:11], s41 offen offset:0 lds
    buffer_load_dwordx4 v2, s[8:11], s41 offen offset:1024 lds
    buffer_load_dwordx4 v2, s[8:11], s41 offen offset:2048 lds
    s_waitcnt vmcnt(21)
    s_barrier
    s_add_u32 m0, s44, 86016
    s_add_u32 s41, s43, 4096
    buffer_load_dwordx4 v2, s[8:11], s43 offen offset:0 lds
    buffer_load_dwordx4 v2, s[8:11], s43 offen offset:1024 lds
    buffer_load_dwordx4 v2, s[8:11], s43 offen offset:2048 lds
    buffer_load_dwordx4 v2, s[8:11], s43 offen offset:3072 lds
    s_add_u32 m0, m0, 4096
    s_add_u32 s43, s43, 458752
    buffer_load_dwordx4 v2, s[8:11], s41 offen offset:0 lds
    buffer_load_dwordx4 v2, s[8:11], s41 offen offset:1024 lds
    buffer_load_dwordx4 v2, s[8:11], s41 offen offset:2048 lds
    s_waitcnt vmcnt(21)
    s_barrier
    s_add_u32 m0, s44, 114688
    s_add_u32 s41, s43, 4096
    buffer_load_dwordx4 v2, s[8:11], s43 offen offset:0 lds
    buffer_load_dwordx4 v2, s[8:11], s43 offen offset:1024 lds
    buffer_load_dwordx4 v2, s[8:11], s43 offen offset:2048 lds
    buffer_load_dwordx4 v2, s[8:11], s43 offen offset:3072 lds
    s_add_u32 m0, m0, 4096
    s_add_u32 s43, s43, 458752
    buffer_load_dwordx4 v2, s[8:11], s41 offen offset:0 lds
    buffer_load_dwordx4 v2, s[8:11], s41 offen offset:1024 lds
    buffer_load_dwordx4 v2, s[8:11], s41 offen offset:2048 lds
    s_lshr_b32 s39, s2, 5
    s_lshl_b32 s40, s13, 3
    s_add_u32 s39, s39, s40
    s_mul_i32 s39, s39, 5120
    s_add_u32 s39, s39, 27623424
    s_waitcnt vmcnt(21)
    s_barrier
    s_add_u32 s40, s39, 4096
    buffer_load_dwordx4 v[20:23], v2, s[8:11], s39 offen offset:0
    buffer_load_dwordx4 v[24:27], v2, s[8:11], s39 offen offset:1024
    buffer_load_dwordx4 v[28:31], v2, s[8:11], s39 offen offset:2048
    buffer_load_dwordx4 v[32:35], v2, s[8:11], s39 offen offset:3072
    buffer_load_dwordx4 v[36:39], v2, s[8:11], s40 offen offset:0
    s_add_u32 s39, s39, 163840
    s_add_u32 s40, s39, 4096
    buffer_load_dwordx4 v[40:43], v2, s[8:11], s39 offen offset:0
    buffer_load_dwordx4 v[44:47], v2, s[8:11], s39 offen offset:1024
    buffer_load_dwordx4 v[48:51], v2, s[8:11], s39 offen offset:2048
    buffer_load_dwordx4 v[52:55], v2, s[8:11], s39 offen offset:3072
    buffer_load_dwordx4 v[56:59], v2, s[8:11], s40 offen offset:0
    s_add_u32 s39, s39, 163840
    s_waitcnt vmcnt(24)
    s_barrier
    s_add_u32 s40, s39, 4096
    buffer_load_dwordx4 v[60:63], v2, s[8:11], s39 offen offset:0
    buffer_load_dwordx4 v[64:67], v2, s[8:11], s39 offen offset:1024
    buffer_load_dwordx4 v[68:71], v2, s[8:11], s39 offen offset:2048
    buffer_load_dwordx4 v[72:75], v2, s[8:11], s39 offen offset:3072
    buffer_load_dwordx4 v[76:79], v2, s[8:11], s40 offen offset:0
    s_add_u32 s39, s39, 163840
    s_add_u32 s40, s39, 4096
    buffer_load_dwordx4 v[80:83], v2, s[8:11], s39 offen offset:0
    buffer_load_dwordx4 v[84:87], v2, s[8:11], s39 offen offset:1024
    buffer_load_dwordx4 v[88:91], v2, s[8:11], s39 offen offset:2048
    buffer_load_dwordx4 v[92:95], v2, s[8:11], s39 offen offset:3072
    buffer_load_dwordx4 v[96:99], v2, s[8:11], s40 offen offset:0
    s_add_u32 s39, s39, 163840
    s_waitcnt vmcnt(20)
    s_barrier
    s_mov_b32 s15, s39
    s_and_b32 s50, s2, 7
    s_lshl_b32 s50, s50, 2
    s_bfe_u32 s51, s2, 0x20003
    s_add_u32 s48, s50, s51
    s_lshl_b32 s48, s48, 2
    s_add_u32 s48, s48, s13
    s_lshr_b32 s49, s2, 5
    s_mul_i32 s54, s13, 8
    s_add_u32 s54, s54, s49
    s_mul_i32 s54, s54, 5120
    s_add_u32 s54, s54, 26476544
    s_mul_i32 s55, s13, 5120
    v_add_u32 v8, s55, v2
    v_add_u32 v9, 61440, v8
    v_add_u32 v10, 122880, v8
    s_add_u32 s14, s15, 4096
    buffer_load_dwordx4 v[100:103], v2, s[8:11], s15 offen offset:0
    buffer_load_dwordx4 v[104:107], v2, s[8:11], s15 offen offset:1024
    buffer_load_dwordx4 v[108:111], v2, s[8:11], s15 offen offset:2048
    buffer_load_dwordx4 v[112:115], v2, s[8:11], s15 offen offset:3072
    buffer_load_dwordx4 v[116:119], v2, s[8:11], s14 offen offset:0
    s_add_u32 s15, s15, 163840
    s_add_u32 s14, s15, 4096
    buffer_load_dwordx4 v[120:123], v2, s[8:11], s15 offen offset:0
    buffer_load_dwordx4 v[124:127], v2, s[8:11], s15 offen offset:1024
    buffer_load_dwordx4 v[128:131], v2, s[8:11], s15 offen offset:2048
    buffer_load_dwordx4 v[132:135], v2, s[8:11], s15 offen offset:3072
    buffer_load_dwordx4 v[136:139], v2, s[8:11], s14 offen offset:0
    s_add_u32 s15, s15, 163840
    s_add_u32 s14, s15, 4096
    buffer_load_dwordx4 v[140:143], v2, s[8:11], s15 offen offset:0
    buffer_load_dwordx4 v[144:147], v2, s[8:11], s15 offen offset:1024
    buffer_load_dwordx4 v[148:151], v2, s[8:11], s15 offen offset:2048
    buffer_load_dwordx4 v[152:155], v2, s[8:11], s15 offen offset:3072
    buffer_load_dwordx4 v[156:159], v2, s[8:11], s14 offen offset:0
    s_add_u32 s15, s15, 163840
    s_add_u32 m0, s55, 0
    s_add_u32 s52, s54, 4096
    buffer_load_dwordx4 v2, s[8:11], s54 offen offset:0 lds
    buffer_load_dwordx4 v2, s[8:11], s54 offen offset:1024 lds
    buffer_load_dwordx4 v2, s[8:11], s54 offen offset:2048 lds
    buffer_load_dwordx4 v2, s[8:11], s54 offen offset:3072 lds
    s_add_u32 m0, m0, 4096
    s_add_u32 s54, s54, 163840
    buffer_load_dwordx4 v2, s[8:11], s52 offen lds
    s_add_u32 m0, s55, 20480
    s_add_u32 s52, s54, 4096
    buffer_load_dwordx4 v2, s[8:11], s54 offen offset:0 lds
    buffer_load_dwordx4 v2, s[8:11], s54 offen offset:1024 lds
    buffer_load_dwordx4 v2, s[8:11], s54 offen offset:2048 lds
    buffer_load_dwordx4 v2, s[8:11], s54 offen offset:3072 lds
    s_add_u32 m0, m0, 4096
    s_add_u32 s54, s54, 163840
    buffer_load_dwordx4 v2, s[8:11], s52 offen lds
    s_add_u32 m0, s55, 40960
    s_add_u32 s52, s54, 4096
    buffer_load_dwordx4 v2, s[8:11], s54 offen offset:0 lds
    buffer_load_dwordx4 v2, s[8:11], s54 offen offset:1024 lds
    buffer_load_dwordx4 v2, s[8:11], s54 offen offset:2048 lds
    buffer_load_dwordx4 v2, s[8:11], s54 offen offset:3072 lds
    s_add_u32 m0, m0, 4096
    s_add_u32 s54, s54, 163840
    buffer_load_dwordx4 v2, s[8:11], s52 offen lds
    s_add_u32 m0, s55, 61440
    s_add_u32 s52, s54, 4096
    buffer_load_dwordx4 v2, s[8:11], s54 offen offset:0 lds
    buffer_load_dwordx4 v2, s[8:11], s54 offen offset:1024 lds
    buffer_load_dwordx4 v2, s[8:11], s54 offen offset:2048 lds
    buffer_load_dwordx4 v2, s[8:11], s54 offen offset:3072 lds
    s_add_u32 m0, m0, 4096
    s_add_u32 s54, s54, 163840
    buffer_load_dwordx4 v2, s[8:11], s52 offen lds
    s_barrier
    s_add_u32 m0, s55, 81920
    s_add_u32 s52, s54, 4096
    buffer_load_dwordx4 v2, s[8:11], s54 offen offset:0 lds
    buffer_load_dwordx4 v2, s[8:11], s54 offen offset:1024 lds
    buffer_load_dwordx4 v2, s[8:11], s54 offen offset:2048 lds
    buffer_load_dwordx4 v2, s[8:11], s54 offen offset:3072 lds
    s_add_u32 m0, m0, 4096
    s_add_u32 s54, s54, 163840
    buffer_load_dwordx4 v2, s[8:11], s52 offen lds
    s_add_u32 m0, s55, 102400
    s_add_u32 s52, s54, 4096
    buffer_load_dwordx4 v2, s[8:11], s54 offen offset:0 lds
    buffer_load_dwordx4 v2, s[8:11], s54 offen offset:1024 lds
    buffer_load_dwordx4 v2, s[8:11], s54 offen offset:2048 lds
    buffer_load_dwordx4 v2, s[8:11], s54 offen offset:3072 lds
    s_add_u32 m0, m0, 4096
    s_add_u32 s54, s54, 163840
    buffer_load_dwordx4 v2, s[8:11], s52 offen lds
    s_add_u32 m0, s55, 122880
    s_add_u32 s52, s54, 4096
    buffer_load_dwordx4 v2, s[8:11], s54 offen offset:0 lds
    buffer_load_dwordx4 v2, s[8:11], s54 offen offset:1024 lds
    buffer_load_dwordx4 v2, s[8:11], s54 offen offset:2048 lds
    buffer_load_dwordx4 v2, s[8:11], s54 offen offset:3072 lds
    s_add_u32 m0, m0, 4096
    s_add_u32 s54, s54, 163840
    buffer_load_dwordx4 v2, s[8:11], s52 offen lds
    s_waitcnt vmcnt(25)
    s_barrier
    s_waitcnt vmcnt(15) lgkmcnt(0)
    s_barrier
    ds_write_b128 v8, v[20:23] offset:0
    ds_write_b128 v8, v[24:27] offset:1024
    ds_write_b128 v8, v[28:31] offset:2048
    ds_write_b128 v8, v[32:35] offset:3072
    ds_write_b128 v8, v[36:39] offset:4096
    ds_write_b128 v8, v[40:43] offset:20480
    ds_write_b128 v8, v[44:47] offset:21504
    ds_write_b128 v8, v[48:51] offset:22528
    ds_write_b128 v8, v[52:55] offset:23552
    ds_write_b128 v8, v[56:59] offset:24576
    s_waitcnt vmcnt(5) lgkmcnt(0)
    s_barrier
    ds_write_b128 v8, v[60:63] offset:40960
    ds_write_b128 v8, v[64:67] offset:41984
    ds_write_b128 v8, v[68:71] offset:43008
    ds_write_b128 v8, v[72:75] offset:44032
    ds_write_b128 v8, v[76:79] offset:45056
    ds_write_b128 v9, v[80:83] offset:0
    ds_write_b128 v9, v[84:87] offset:1024
    ds_write_b128 v9, v[88:91] offset:2048
    ds_write_b128 v9, v[92:95] offset:3072
    ds_write_b128 v9, v[96:99] offset:4096
    s_waitcnt vmcnt(0) lgkmcnt(0)
    s_barrier
    ds_write_b128 v9, v[100:103] offset:20480
    ds_write_b128 v9, v[104:107] offset:21504
    ds_write_b128 v9, v[108:111] offset:22528
    ds_write_b128 v9, v[112:115] offset:23552
    ds_write_b128 v9, v[116:119] offset:24576
    ds_write_b128 v9, v[120:123] offset:40960
    ds_write_b128 v9, v[124:127] offset:41984
    ds_write_b128 v9, v[128:131] offset:43008
    ds_write_b128 v9, v[132:135] offset:44032
    ds_write_b128 v9, v[136:139] offset:45056
    s_waitcnt vmcnt(0) lgkmcnt(0)
    s_barrier
    ds_write_b128 v10, v[140:143] offset:0
    ds_write_b128 v10, v[144:147] offset:1024
    ds_write_b128 v10, v[148:151] offset:2048
    ds_write_b128 v10, v[152:155] offset:3072
    ds_write_b128 v10, v[156:159] offset:4096
    s_waitcnt vmcnt(0) lgkmcnt(0)
    s_barrier
    s_waitcnt vmcnt(0) lgkmcnt(0)
    s_barrier
    s_endpgm
L_sequential_preLN__softmax_full_mha__swiglu_ffn__prompt_kernel_slow_17:
    s_lshl_b32 s46, s41, 4
    s_add_u32 s46, s46, s39
    s_add_u32 s46, s46, s40
    v_mov_b32 v132, 0
    v_mov_b32 v133, 0
    s_mov_b32 exec_hi, 0
    buffer_load_dwordx2 v[132:133], v6, s[8:11], s46 offen
    s_mov_b32 exec_hi, -1
    s_add_u32 s46, s38, 2621440
    s_add_u32 s47, s39, 2621440
    s_add_u32 s47, s47, s40
    v_mov_b32 v8, 0xff800000
    s_mov_b32 s45, 0
L_sequential_preLN__softmax_full_mha__swiglu_ffn__prompt_kernel_mx_33:
    buffer_load_dwordx4 v[136:139], v5, s[8:11], s46 offen
    buffer_load_dwordx2 v[140:141], v6, s[8:11], s47 offen
    s_add_u32 s46, s46, 512
    s_add_u32 s47, s47, 512
    s_waitcnt vmcnt(0)
    v_mfma_f32_32x32x8_bf16 v[20:35], v[140:141], v[132:133], 0
    v_mfma_f32_32x32x16_bf16 v[20:35], v[136:139], v[124:127], v[20:35]
    s_nop 11
    v_max3_f32 v8, v20, v21, v8
    v_max3_f32 v8, v22, v23, v8
    v_max3_f32 v8, v24, v25, v8
    v_max3_f32 v8, v26, v27, v8
    v_max3_f32 v8, v28, v29, v8
    v_max3_f32 v8, v30, v31, v8
    v_max3_f32 v8, v32, v33, v8
    v_max3_f32 v8, v34, v35, v8
    s_add_u32 s45, s45, 1
    s_cmp_lt_u32 s45, 64
    s_cbranch_scc1 L_sequential_preLN__softmax_full_mha__swiglu_ffn__prompt_kernel_mx_33
    v_mov_b32 v12, v8
    s_nop 1
    v_permlane32_swap_b32 v12, v8
    v_max_f32 v8, v8, v12
    v_sub_f32 v52, 0, v8
    v_mov_b32 v84, 0
    v_sub_f32 v53, 0, v8
    v_mov_b32 v85, 0
    v_sub_f32 v54, 0, v8
    v_mov_b32 v86, 0
    v_sub_f32 v55, 0, v8
    v_mov_b32 v87, 0
    v_sub_f32 v56, 0, v8
    v_mov_b32 v88, 0
    v_sub_f32 v57, 0, v8
    v_mov_b32 v89, 0
    v_sub_f32 v58, 0, v8
    v_mov_b32 v90, 0
    v_sub_f32 v59, 0, v8
    v_mov_b32 v91, 0
    v_sub_f32 v60, 0, v8
    v_mov_b32 v92, 0
    v_sub_f32 v61, 0, v8
    v_mov_b32 v93, 0
    v_sub_f32 v62, 0, v8
    v_mov_b32 v94, 0
    v_sub_f32 v63, 0, v8
    v_mov_b32 v95, 0
    v_sub_f32 v64, 0, v8
    v_mov_b32 v96, 0
    v_sub_f32 v65, 0, v8
    v_mov_b32 v97, 0
    v_sub_f32 v66, 0, v8
    v_mov_b32 v98, 0
    v_sub_f32 v67, 0, v8
    v_mov_b32 v99, 0
    s_add_u32 s46, s38, 2621440
    s_add_u32 s47, s39, 2621440
    s_add_u32 s47, s47, s40
    s_mul_i32 s48, s37, 320
    s_add_u32 s48, s48, 5242880
    v_lshrrev_b32 v7, 5, v1
    v_mul_u32_u24 v7, 10240, v7
    v_add3_u32 v7, v7, v6, s48
    v_add_u32 v217, 20480, v7
    v_cmp_gt_u32 vcc, 320, v6
    v_mov_b32 v218, 7929856
    v_mov_b32 v219, 40960
    v_cndmask_b32 v7, v218, v7, vcc
    v_cndmask_b32 v217, v218, v217, vcc
    v_cndmask_b32 v219, 0, v219, vcc
    s_mov_b32 s45, 0
L_sequential_preLN__softmax_full_mha__swiglu_ffn__prompt_kernel_pv_34:
    buffer_load_dwordx4 v[136:139], v5, s[8:11], s46 offen
    buffer_load_dwordx2 v[140:141], v6, s[8:11], s47 offen
    buffer_load_dwordx4 v[144:147], v7, s[8:11], 0 offen
    buffer_load_dwordx4 v[148:151], v217, s[8:11], 0 offen
    s_add_u32 s46, s46, 512
    s_add_u32 s47, s47, 512
    v_add_u32 v7, v7, v219
    v_add_u32 v217, v217, v219
    s_waitcnt vmcnt(0)
    v_mfma_f32_32x32x8_bf16 v[20:35], v[140:141], v[132:133], v[52:67]
    v_mfma_f32_32x32x16_bf16 v[20:35], v[136:139], v[124:127], v[20:35]
    s_nop 11
    v_exp_f32 v20, v20
    v_exp_f32 v21, v21
    v_exp_f32 v22, v22
    v_exp_f32 v23, v23
    v_exp_f32 v24, v24
    v_exp_f32 v25, v25
    v_exp_f32 v26, v26
    v_exp_f32 v27, v27
    v_exp_f32 v28, v28
    v_exp_f32 v29, v29
    v_exp_f32 v30, v30
    v_exp_f32 v31, v31
    v_exp_f32 v32, v32
    v_exp_f32 v33, v33
    v_exp_f32 v34, v34
    v_exp_f32 v35, v35
    v_cvt_pk_bf16_f32 v116, v20, v21
    v_cvt_pk_bf16_f32 v117, v22, v23
    v_cvt_pk_bf16_f32 v118, v24, v25
    v_cvt_pk_bf16_f32 v119, v26, v27
    v_cvt_pk_bf16_f32 v120, v28, v29
    v_cvt_pk_bf16_f32 v121, v30, v31
    v_cvt_pk_bf16_f32 v122, v32, v33
    v_cvt_pk_bf16_f32 v123, v34, v35
    v_mfma_f32_32x32x16_bf16 v[84:99], v[144:147], v[116:119], v[84:99]
    s_nop 0
    v_mfma_f32_32x32x16_bf16 v[84:99], v[148:151], v[120:123], v[84:99]
    s_add_u32 s45, s45, 1
    s_cmp_lt_u32 s45, 64
    s_cbranch_scc1 L_sequential_preLN__softmax_full_mha__swiglu_ffn__prompt_kernel_pv_34
    s_nop 8
    v_mov_b32 v12, v92
    v_mov_b32 v13, v92
    s_nop 1
    v_permlane32_swap_b32 v12, v13
    s_branch L_sequential_preLN__softmax_full_mha__swiglu_ffn__prompt_kernel_store_18
L_sequential_preLN__softmax_full_mha__swiglu_ffn__prompt_kernel_spare_2:
    v_lshrrev_b32 v5, 3, v1
    v_lshl_add_u32 v5, s12, 4, v5
    v_mul_u32_u24 v5, 1280, v5
    v_and_b32 v7, 7, v1
    v_lshl_add_u32 v17, v7, 4, v5
    v_add_u32 v18, 10240, v17
    s_mul_i32 s58, s56, 163840
    s_mov_b32 s26, 163840
    s_mov_b32 s27, 0x20000
    s_waitcnt lgkmcnt(0)
    s_add_u32 s24, s40, s58
    s_addc_u32 s25, s41, 0
    buffer_load_dwordx4 v[28:31], v17, s[24:27], 0 offen offset:0
    buffer_load_dwordx4 v[32:35], v17, s[24:27], 0 offen offset:128
    buffer_load_dwordx4 v[36:39], v17, s[24:27], 0 offen offset:256
    buffer_load_dwordx4 v[40:43], v17, s[24:27], 0 offen offset:384
    buffer_load_dwordx4 v[44:47], v17, s[24:27], 0 offen offset:512
    buffer_load_dwordx4 v[48:51], v17, s[24:27], 0 offen offset:640
    buffer_load_dwordx4 v[52:55], v17, s[24:27], 0 offen offset:768
    buffer_load_dwordx4 v[56:59], v17, s[24:27], 0 offen offset:896
    buffer_load_dwordx4 v[60:63], v17, s[24:27], 0 offen offset:1024
    buffer_load_dwordx4 v[64:67], v17, s[24:27], 0 offen offset:1152
    buffer_load_dwordx4 v[68:71], v18, s[24:27], 0 offen offset:0
    buffer_load_dwordx4 v[72:75], v18, s[24:27], 0 offen offset:128
    buffer_load_dwordx4 v[76:79], v18, s[24:27], 0 offen offset:256
    buffer_load_dwordx4 v[80:83], v18, s[24:27], 0 offen offset:384
    buffer_load_dwordx4 v[84:87], v18, s[24:27], 0 offen offset:512
    buffer_load_dwordx4 v[88:91], v18, s[24:27], 0 offen offset:640
    buffer_load_dwordx4 v[92:95], v18, s[24:27], 0 offen offset:768
    buffer_load_dwordx4 v[96:99], v18, s[24:27], 0 offen offset:896
    buffer_load_dwordx4 v[100:103], v18, s[24:27], 0 offen offset:1024
    buffer_load_dwordx4 v[104:107], v18, s[24:27], 0 offen offset:1152
    s_mov_b64 s[4:5], s[18:19]
    s_movk_i32 s18, 256
    s_mov_b32 s19, 0x20000
    v_lshlrev_b32 v2, 4, v1
    s_mov_b32 s8, s4
    s_mov_b32 s9, s5
    s_mov_b32 s10, 29884416
    s_mov_b32 s11, 0x20000
    s_load_dwordx8 s[44:51], s[0:1], 16
    s_load_dwordx2 s[52:53], s[0:1], 48
    s_mov_b32 s28, s4
    s_mov_b32 s29, s5
    s_mov_b32 s30, 13633536
    s_mov_b32 s31, 0x20000
    s_mov_b32 s58, 7929856
    v_and_b32 v5, 0x70, v2
    v_lshlrev_b32 v6, 4, v0
    s_lshl_b32 s36, s56, 13
    s_add_u32 s36, s36, 13500416
    s_mov_b32 s63, 0x3f803f80
    v_mov_b32 v108, 0x3f803f80
    v_mov_b32 v112, 0
    v_mov_b32 v109, 0x3f803f80
    v_mov_b32 v113, 0
    v_mov_b32 v110, 0x3f803f80
    v_mov_b32 v114, 0
    v_mov_b32 v111, 0x3f803f80
    v_mov_b32 v115, 0
    buffer_store_dwordx4 v[112:115], v6, s[28:31], s36 offen sc1
    s_add_u32 s36, s36, 131072
    buffer_store_dwordx4 v[112:115], v6, s[28:31], s36 offen sc1
    s_add_u32 s36, s36, 131072
    s_mov_b64 exec, 0xff
    buffer_store_dwordx4 v[108:111], v5, s[8:11], s58 offen sc1
    s_mov_b64 exec, -1
    v_mov_b32 v116, 0
    v_mov_b32 v117, 0
    v_mov_b32 v118, 0
    v_mov_b32 v119, 0
    s_waitcnt vmcnt(22)
    v_dot2c_f32_bf16 v116, s63, v28
    v_dot2c_f32_bf16 v117, v28, v28
    v_dot2c_f32_bf16 v116, s63, v29
    v_dot2c_f32_bf16 v117, v29, v29
    v_dot2c_f32_bf16 v116, s63, v30
    v_dot2c_f32_bf16 v117, v30, v30
    v_dot2c_f32_bf16 v116, s63, v31
    v_dot2c_f32_bf16 v117, v31, v31
    s_waitcnt vmcnt(21)
    v_dot2c_f32_bf16 v116, s63, v32
    v_dot2c_f32_bf16 v117, v32, v32
    v_dot2c_f32_bf16 v116, s63, v33
    v_dot2c_f32_bf16 v117, v33, v33
    v_dot2c_f32_bf16 v116, s63, v34
    v_dot2c_f32_bf16 v117, v34, v34
    v_dot2c_f32_bf16 v116, s63, v35
    v_dot2c_f32_bf16 v117, v35, v35
    s_waitcnt vmcnt(20)
    v_dot2c_f32_bf16 v116, s63, v36
    v_dot2c_f32_bf16 v117, v36, v36
    v_dot2c_f32_bf16 v116, s63, v37
    v_dot2c_f32_bf16 v117, v37, v37
    v_dot2c_f32_bf16 v116, s63, v38
    v_dot2c_f32_bf16 v117, v38, v38
    v_dot2c_f32_bf16 v116, s63, v39
    v_dot2c_f32_bf16 v117, v39, v39
    s_waitcnt vmcnt(19)
    v_dot2c_f32_bf16 v116, s63, v40
    v_dot2c_f32_bf16 v117, v40, v40
    v_dot2c_f32_bf16 v116, s63, v41
    v_dot2c_f32_bf16 v117, v41, v41
    v_dot2c_f32_bf16 v116, s63, v42
    v_dot2c_f32_bf16 v117, v42, v42
    v_dot2c_f32_bf16 v116, s63, v43
    v_dot2c_f32_bf16 v117, v43, v43
    s_waitcnt vmcnt(18)
    v_dot2c_f32_bf16 v116, s63, v44
    v_dot2c_f32_bf16 v117, v44, v44
    v_dot2c_f32_bf16 v116, s63, v45
    v_dot2c_f32_bf16 v117, v45, v45
    v_dot2c_f32_bf16 v116, s63, v46
    v_dot2c_f32_bf16 v117, v46, v46
    v_dot2c_f32_bf16 v116, s63, v47
    v_dot2c_f32_bf16 v117, v47, v47
    s_waitcnt vmcnt(17)
    v_dot2c_f32_bf16 v116, s63, v48
    v_dot2c_f32_bf16 v117, v48, v48
    v_dot2c_f32_bf16 v116, s63, v49
    v_dot2c_f32_bf16 v117, v49, v49
    v_dot2c_f32_bf16 v116, s63, v50
    v_dot2c_f32_bf16 v117, v50, v50
    v_dot2c_f32_bf16 v116, s63, v51
    v_dot2c_f32_bf16 v117, v51, v51
    s_waitcnt vmcnt(16)
    v_dot2c_f32_bf16 v116, s63, v52
    v_dot2c_f32_bf16 v117, v52, v52
    v_dot2c_f32_bf16 v116, s63, v53
    v_dot2c_f32_bf16 v117, v53, v53
    v_dot2c_f32_bf16 v116, s63, v54
    v_dot2c_f32_bf16 v117, v54, v54
    v_dot2c_f32_bf16 v116, s63, v55
    v_dot2c_f32_bf16 v117, v55, v55
    s_waitcnt vmcnt(15)
    v_dot2c_f32_bf16 v116, s63, v56
    v_dot2c_f32_bf16 v117, v56, v56
    v_dot2c_f32_bf16 v116, s63, v57
    v_dot2c_f32_bf16 v117, v57, v57
    v_dot2c_f32_bf16 v116, s63, v58
    v_dot2c_f32_bf16 v117, v58, v58
    v_dot2c_f32_bf16 v116, s63, v59
    v_dot2c_f32_bf16 v117, v59, v59
    s_waitcnt vmcnt(14)
    v_dot2c_f32_bf16 v116, s63, v60
    v_dot2c_f32_bf16 v117, v60, v60
    v_dot2c_f32_bf16 v116, s63, v61
    v_dot2c_f32_bf16 v117, v61, v61
    v_dot2c_f32_bf16 v116, s63, v62
    v_dot2c_f32_bf16 v117, v62, v62
    v_dot2c_f32_bf16 v116, s63, v63
    v_dot2c_f32_bf16 v117, v63, v63
    s_waitcnt vmcnt(13)
    v_dot2c_f32_bf16 v116, s63, v64
    v_dot2c_f32_bf16 v117, v64, v64
    v_dot2c_f32_bf16 v116, s63, v65
    v_dot2c_f32_bf16 v117, v65, v65
    v_dot2c_f32_bf16 v116, s63, v66
    v_dot2c_f32_bf16 v117, v66, v66
    v_dot2c_f32_bf16 v116, s63, v67
    v_dot2c_f32_bf16 v117, v67, v67
    s_waitcnt vmcnt(12)
    v_dot2c_f32_bf16 v118, s63, v68
    v_dot2c_f32_bf16 v119, v68, v68
    v_dot2c_f32_bf16 v118, s63, v69
    v_dot2c_f32_bf16 v119, v69, v69
    v_dot2c_f32_bf16 v118, s63, v70
    v_dot2c_f32_bf16 v119, v70, v70
    v_dot2c_f32_bf16 v118, s63, v71
    v_dot2c_f32_bf16 v119, v71, v71
    s_waitcnt vmcnt(11)
    v_dot2c_f32_bf16 v118, s63, v72
    v_dot2c_f32_bf16 v119, v72, v72
    v_dot2c_f32_bf16 v118, s63, v73
    v_dot2c_f32_bf16 v119, v73, v73
    v_dot2c_f32_bf16 v118, s63, v74
    v_dot2c_f32_bf16 v119, v74, v74
    v_dot2c_f32_bf16 v118, s63, v75
    v_dot2c_f32_bf16 v119, v75, v75
    s_waitcnt vmcnt(10)
    v_dot2c_f32_bf16 v118, s63, v76
    v_dot2c_f32_bf16 v119, v76, v76
    v_dot2c_f32_bf16 v118, s63, v77
    v_dot2c_f32_bf16 v119, v77, v77
    v_dot2c_f32_bf16 v118, s63, v78
    v_dot2c_f32_bf16 v119, v78, v78
    v_dot2c_f32_bf16 v118, s63, v79
    v_dot2c_f32_bf16 v119, v79, v79
    s_waitcnt vmcnt(9)
    v_dot2c_f32_bf16 v118, s63, v80
    v_dot2c_f32_bf16 v119, v80, v80
    v_dot2c_f32_bf16 v118, s63, v81
    v_dot2c_f32_bf16 v119, v81, v81
    v_dot2c_f32_bf16 v118, s63, v82
    v_dot2c_f32_bf16 v119, v82, v82
    v_dot2c_f32_bf16 v118, s63, v83
    v_dot2c_f32_bf16 v119, v83, v83
    s_waitcnt vmcnt(8)
    v_dot2c_f32_bf16 v118, s63, v84
    v_dot2c_f32_bf16 v119, v84, v84
    v_dot2c_f32_bf16 v118, s63, v85
    v_dot2c_f32_bf16 v119, v85, v85
    v_dot2c_f32_bf16 v118, s63, v86
    v_dot2c_f32_bf16 v119, v86, v86
    v_dot2c_f32_bf16 v118, s63, v87
    v_dot2c_f32_bf16 v119, v87, v87
    s_waitcnt vmcnt(7)
    v_dot2c_f32_bf16 v118, s63, v88
    v_dot2c_f32_bf16 v119, v88, v88
    v_dot2c_f32_bf16 v118, s63, v89
    v_dot2c_f32_bf16 v119, v89, v89
    v_dot2c_f32_bf16 v118, s63, v90
    v_dot2c_f32_bf16 v119, v90, v90
    v_dot2c_f32_bf16 v118, s63, v91
    v_dot2c_f32_bf16 v119, v91, v91
    s_waitcnt vmcnt(6)
    v_dot2c_f32_bf16 v118, s63, v92
    v_dot2c_f32_bf16 v119, v92, v92
    v_dot2c_f32_bf16 v118, s63, v93
    v_dot2c_f32_bf16 v119, v93, v93
    v_dot2c_f32_bf16 v118, s63, v94
    v_dot2c_f32_bf16 v119, v94, v94
    v_dot2c_f32_bf16 v118, s63, v95
    v_dot2c_f32_bf16 v119, v95, v95
    s_waitcnt vmcnt(5)
    v_dot2c_f32_bf16 v118, s63, v96
    v_dot2c_f32_bf16 v119, v96, v96
    v_dot2c_f32_bf16 v118, s63, v97
    v_dot2c_f32_bf16 v119, v97, v97
    v_dot2c_f32_bf16 v118, s63, v98
    v_dot2c_f32_bf16 v119, v98, v98
    v_dot2c_f32_bf16 v118, s63, v99
    v_dot2c_f32_bf16 v119, v99, v99
    s_waitcnt vmcnt(4)
    v_dot2c_f32_bf16 v118, s63, v100
    v_dot2c_f32_bf16 v119, v100, v100
    v_dot2c_f32_bf16 v118, s63, v101
    v_dot2c_f32_bf16 v119, v101, v101
    v_dot2c_f32_bf16 v118, s63, v102
    v_dot2c_f32_bf16 v119, v102, v102
    v_dot2c_f32_bf16 v118, s63, v103
    v_dot2c_f32_bf16 v119, v103, v103
    s_waitcnt vmcnt(3)
    v_dot2c_f32_bf16 v118, s63, v104
    v_dot2c_f32_bf16 v119, v104, v104
    v_dot2c_f32_bf16 v118, s63, v105
    v_dot2c_f32_bf16 v119, v105, v105
    v_dot2c_f32_bf16 v118, s63, v106
    v_dot2c_f32_bf16 v119, v106, v106
    v_dot2c_f32_bf16 v118, s63, v107
    v_dot2c_f32_bf16 v119, v107, v107
    v_add_f32_dpp v116, v116, v116 quad_perm:[1,0,3,2] row_mask:0xf bank_mask:0xf
    v_add_f32_dpp v117, v117, v117 quad_perm:[1,0,3,2] row_mask:0xf bank_mask:0xf
    v_add_f32_dpp v118, v118, v118 quad_perm:[1,0,3,2] row_mask:0xf bank_mask:0xf
    v_add_f32_dpp v119, v119, v119 quad_perm:[1,0,3,2] row_mask:0xf bank_mask:0xf
    v_add_f32_dpp v116, v116, v116 quad_perm:[2,3,0,1] row_mask:0xf bank_mask:0xf
    v_add_f32_dpp v117, v117, v117 quad_perm:[2,3,0,1] row_mask:0xf bank_mask:0xf
    v_add_f32_dpp v118, v118, v118 quad_perm:[2,3,0,1] row_mask:0xf bank_mask:0xf
    v_add_f32_dpp v119, v119, v119 quad_perm:[2,3,0,1] row_mask:0xf bank_mask:0xf
    v_add_f32_dpp v116, v116, v116 row_half_mirror row_mask:0xf bank_mask:0xf
    v_add_f32_dpp v117, v117, v117 row_half_mirror row_mask:0xf bank_mask:0xf
    v_add_f32_dpp v118, v118, v118 row_half_mirror row_mask:0xf bank_mask:0xf
    v_add_f32_dpp v119, v119, v119 row_half_mirror row_mask:0xf bank_mask:0xf
    v_and_b32 v7, 1, v1
    v_cmp_eq_u32 vcc, 1, v7
    v_lshrrev_b32 v8, 3, v1
    v_lshl_add_u32 v8, v7, 3, v8
    v_cndmask_b32 v116, v116, v118, vcc
    v_cndmask_b32 v117, v117, v119, vcc
    v_lshlrev_b32 v8, 2, v8
    v_mul_f32 v116, 0xbacccccd, v116
    v_mul_f32 v117, 0x3acccccd, v117
    v_fma_f32 v117, -v116, v116, v117
    v_max_f32 v117, 0, v117
    v_add_f32 v117, 0x3727c5ac, v117
    v_rsq_f32 v117, v117
    s_lshl_b32 s36, s12, 6
    v_add_u32 v8, s36, v8
    ds_write_b32 v8, v116
    ds_write_b32 v8, v117 offset:512
    s_waitcnt vmcnt(0) lgkmcnt(0)
    s_barrier
    s_cmp_lg_u32 s12, 4
    s_cbranch_scc1 L_sequential_preLN__softmax_full_mha__swiglu_ffn__prompt_kernel_sn_16
    ds_read_b128 v[116:119], v2
    s_lshl_b32 s58, s56, 10
    s_add_u32 s58, s58, 13828096
    s_waitcnt lgkmcnt(0)
    buffer_store_dwordx4 v[116:119], v2, s[8:11], s58 offen sc1
    s_waitcnt vmcnt(0)
    s_lshl_b32 s58, s56, 4
    v_mov_b32 v7, 1
    v_mov_b32 v8, 0
    s_mov_b64 exec, 1
    buffer_store_dword v7, v8, s[16:19], s58 offen sc1
    s_mov_b64 exec, -1
L_sequential_preLN__softmax_full_mha__swiglu_ffn__prompt_kernel_sn_16:
    s_branch L_sequential_preLN__softmax_full_mha__swiglu_ffn__prompt_kernel_J0_4
L_code_end:
.section .rodata,"a"
.p2align 6
.amdhsa_kernel sequential_preLN__softmax_full_mha__swiglu_ffn__prompt_kernel
  .amdhsa_next_free_vgpr 256
  .amdhsa_next_free_sgpr 64
  .amdhsa_accum_offset 256
  .amdhsa_group_segment_fixed_size 0
  .amdhsa_kernarg_size 80
  .amdhsa_user_sgpr_count 2
  .amdhsa_user_sgpr_kernarg_segment_ptr 1
  .amdhsa_system_sgpr_workgroup_id_x 1
.end_amdhsa_kernel
```
